```python
import torch

def _softmax(x, axis=-1):
    return torch.softmax(x, dim=axis)
def _gelu(x):
    return torch.nn.functional.gelu(x, approximate="tanh")
def _silu(x):
    return torch.nn.functional.silu(x)
def _sigmoid(x):
    return torch.sigmoid(x)
def _layernorm(x, axis=-1, eps=1e-5):
    m = x.mean(dim=axis, keepdim=True)
    v = x.var(dim=axis, keepdim=True, unbiased=False)
    return (x - m) / torch.sqrt(v + eps)
def _scatter_add(tgt, idx, src, axis=0):
    return tgt.clone().index_add_(axis, idx, src)
def _segment_sum(src, seg, n):
    out = torch.zeros((n,) + src.shape[1:], dtype=src.dtype)
    return out.index_add_(0, seg, src)
def _pad(x, pw):
    flat = tuple(v for pair in reversed(pw) for v in pair)
    return torch.nn.functional.pad(x, flat)

kernel_name = 'sequential_preLN__gqa_block_cached__geglu_ffn__decode'

def setup_inputs():

    _w = (lambda a: (lambda t: t.to(torch.bfloat16) if t.is_floating_point() else t)(torch.as_tensor(a)))
    def _A_setup():
        B, Sq, D = 4, 1, 640
        Hq, Hkv, Sk, Dh = 32, 32, 4096, 128
        assert Hq % Hkv == 0, (Hq, Hkv)
        return {
            "x": _w((lambda *s: torch.randn(*s, dtype=torch.bfloat16) * 0.05)(B, Sq, D)),
            "k_cache": _w((lambda *s: torch.randn(*s, dtype=torch.bfloat16) * 3.2)(B, Hkv, Sk, Dh)),
            "v_cache": _w((lambda *s: torch.randn(*s, dtype=torch.bfloat16) * 0.4)(B, Hkv, Sk, Dh)),
            "wq": _w((lambda *s: torch.randn(*s, dtype=torch.bfloat16) * 3.2)(D, Hq * Dh) * (D ** -0.5)),
            "wo": _w((lambda *s: torch.randn(*s, dtype=torch.bfloat16) * 0.4)(Hq * Dh, D) * ((Hq * Dh) ** -0.5)),
        }
    _A_in = _A_setup()

    def _B_setup():
        B, S, D, F = 4, 1, 640, 1728
        return {
            "x": _w((lambda *s: torch.randn(*s, dtype=torch.bfloat16) * 0.05)(B, S, D)),
            "w_gate": _w((lambda *s: torch.randn(*s, dtype=torch.bfloat16) * 0.05)(D, F)),
            "w_up": _w((lambda *s: torch.randn(*s, dtype=torch.bfloat16) * 0.05)(D, F)),
            "w_down": _w((lambda *s: torch.randn(*s, dtype=torch.bfloat16) * 0.05)(F, D)),
        }
    _B_in = _B_setup()

    return {
        "A_x": _A_in["x"],
        "A_k_cache": _A_in["k_cache"],
        "A_v_cache": _A_in["v_cache"],
        "A_wq": _A_in["wq"],
        "A_wo": _A_in["wo"],
        "B_x": _B_in["x"],
        "B_w_gate": _B_in["w_gate"],
        "B_w_up": _B_in["w_up"],
        "B_w_down": _B_in["w_down"],
    }

def reference(A_x, A_k_cache, A_v_cache, A_wq, A_wo, B_x, B_w_gate, B_w_up, B_w_down):
    def _A_ref(x, k_cache, v_cache, wq, wo):
        B, Sq, D = x.shape
        Hq, Dh = 32, 128
        Hkv = k_cache.shape[1]
        rep = Hq // Hkv
        q = (lambda x, *d: x.permute(*d))((x @ wq).reshape(B, Sq, Hq, Dh), 0, 2, 1, 3)
        k = (lambda x, n, axis: torch.repeat_interleave(x, n, dim=axis))(k_cache, rep, axis=1)
        v = (lambda x, n, axis: torch.repeat_interleave(x, n, dim=axis))(v_cache, rep, axis=1)
        scores = torch.einsum("bhqd,bhkd->bhqk", q, k) * (Dh ** -0.5)
        p = _softmax(scores, axis=-1)
        o = torch.einsum("bhqk,bhkd->bhqd", p, v)
        return (lambda x, *d: x.permute(*d))(o, 0, 2, 1, 3).reshape(B, Sq, Hq * Dh) @ wo

    def _B_ref(x, w_gate, w_up, w_down):
        return (_gelu(x @ w_gate) * (x @ w_up)) @ w_down

    x = A_x
    h = x + _A_ref(_layernorm(x, axis=-1), A_k_cache, A_v_cache, A_wq, A_wo)
    h2 = h + _B_ref(_layernorm(h, axis=-1), B_w_gate, B_w_up, B_w_down)
    return h2
```

```asm
; @launch grid=(256,1,1) block=(1024,1,1) lds=83968
.amdgcn_target "amdgcn-amd-amdhsa--gfx950"
.text
.globl sequential_preLN__gqa_block_cached__geglu_ffn__decode_kernel
.p2align 8
.type sequential_preLN__gqa_block_cached__geglu_ffn__decode_kernel,@function
sequential_preLN__gqa_block_cached__geglu_ffn__decode_kernel:
  s_cmp_ge_u32 s2, 256
  s_cbranch_scc1 L_end
  s_load_dwordx16 s[64:79], s[0:1], 0
  s_load_dwordx8 s[80:87], s[0:1], 64
  v_lshrrev_b32 v1, 6, v0
  v_and_b32 v0, 63, v0
  v_readfirstlane_b32 s3, v1
  s_and_b32 s4, s2, 1
  s_bfe_u32 s52, s2, 0x20001
  s_lshr_b32 s53, s2, 3
  s_and_b32 s5, s53, 7
  s_lshl_b32 s52, s52, 3
  s_add_u32 s5, s5, s52
  s_lshr_b32 s6, s53, 3
  s_lshl_b32 s7, s6, 5
  s_add_u32 s7, s7, s5
  s_and_b32 s52, s2, 7
  s_mul_i32 s62, s52, 27
  s_add_u32 s62, s62, s53
  s_mul_i32 s63, s52, 5
  s_add_u32 s63, s63, s53
  s_sub_u32 s63, s63, 27
  s_mov_b32 s55, 0x3db504f3
  s_mov_b32 s56, 0x3fb8aa3b
  s_mov_b32 s57, 0x3f803f80
  s_mov_b32 s58, 0xff00ff00
  s_mov_b32 s59, 0xff00ff00
  s_mov_b32 s61, 0
  v_lshlrev_b32 v1, 4, v0
  v_mov_b32 v24, 0
  v_mov_b32 v25, 0
  v_mov_b32 v26, 0
  v_mov_b32 v27, 0
  v_mov_b32 v28, 2816
  ds_write_b128 v28, v[24:27]
  ds_write_b128 v28, v[24:27] offset:16
  ds_write_b128 v28, v[24:27] offset:32
  v_and_b32 v24, 1, v0
  v_lshlrev_b32 v24, 4, v24
  v_mov_b32 v25, 0xffff
  v_lshlrev_b32 v25, v24, v25
  v_bfe_u32 v26, v0, 1, 2
  v_cmp_eq_u32 vcc, 0, v26
  s_nop 1
  v_cndmask_b32 v2, 0, v25, vcc
  v_cmp_eq_u32 vcc, 1, v26
  s_nop 1
  v_cndmask_b32 v3, 0, v25, vcc
  v_cmp_eq_u32 vcc, 2, v26
  s_nop 1
  v_cndmask_b32 v4, 0, v25, vcc
  v_cmp_eq_u32 vcc, 3, v26
  s_nop 1
  v_cndmask_b32 v5, 0, v25, vcc
  s_cmp_eq_u32 s4, 1
  s_cselect_b32 s52, 31, 33
  s_cselect_b32 s53, 540672, 0
  s_mul_i32 s52, s52, s3
  s_lshl_b32 s52, s52, 10
  s_lshl_b32 s54, s7, 20
  s_add_u32 s54, s54, s53
  s_add_u32 s54, s54, s52
  s_waitcnt lgkmcnt(0)
  s_mov_b32 s36, s64
  s_mov_b32 s37, s65
  s_mov_b32 s38, 5120
  s_mov_b32 s39, 0x20000
  s_mov_b32 s8, s66
  s_mov_b32 s9, s67
  s_mov_b32 s10, 134217728
  s_mov_b32 s11, 0x20000
  s_mov_b32 s16, s70
  s_mov_b32 s17, s71
  s_mov_b32 s18, 5242880
  s_mov_b32 s19, 0x20000
  s_cmp_ge_u32 s3, 4
  s_cbranch_scc1 L_x_1
  v_lshlrev_b32 v31, 2, v0
  s_mul_i32 s52, s3, 1280
  buffer_load_dword v24, v31, s[36:39], s52 offen offset:0
  buffer_load_dword v25, v31, s[36:39], s52 offen offset:256
  buffer_load_dword v26, v31, s[36:39], s52 offen offset:512
  buffer_load_dword v27, v31, s[36:39], s52 offen offset:768
  buffer_load_dword v28, v31, s[36:39], s52 offen offset:1024
L_x_1:
  s_mov_b32 s12, s68
  s_mov_b32 s13, s69
  s_mov_b32 s14, 134217728
  s_mov_b32 s15, 0x20000
  s_mov_b32 s20, s72
  s_mov_b32 s21, s73
  s_mov_b32 s22, 5242880
  s_mov_b32 s23, 0x20000
  s_mov_b32 s24, s76
  s_mov_b32 s25, s77
  s_mov_b32 s26, 2211840
  s_mov_b32 s27, 0x20000
  s_mov_b32 s28, s78
  s_mov_b32 s29, s79
  s_mov_b32 s30, 2211840
  s_mov_b32 s31, 0x20000
  s_mov_b32 s32, s80
  s_mov_b32 s33, s81
  s_mov_b32 s34, 2211840
  s_mov_b32 s35, 0x20000
  s_mov_b32 s40, s82
  s_mov_b32 s41, s83
  s_mov_b32 s42, 5120
  s_mov_b32 s43, 0x20000
  s_mov_b32 s44, s84
  s_mov_b32 s45, s85
  s_mov_b32 s46, 256
  s_mov_b32 s47, 0x20000
  s_mov_b32 s48, s86
  s_mov_b32 s49, s87
  s_mov_b32 s50, 536870912
  s_mov_b32 s51, 0x20000
  s_sub_u32 s64, s2, 136
  s_mul_i32 s65, s64, 205
  s_lshr_b32 s65, s65, 12
  s_mul_i32 s66, s65, 20
  s_sub_u32 s66, s64, s66
  s_lshl_b32 s52, s7, 1
  s_add_u32 s52, s52, s4
  s_lshl_b32 s52, s52, 4
  s_add_u32 s52, s52, s3
  s_lshl_b32 s67, s52, 3
  s_mul_i32 s68, s6, 20
  s_lshl_b32 s52, s3, 1
  s_add_u32 s68, s68, s52
  s_lshl_b32 s68, s68, 13
  s_lshl_b32 s52, s5, 1
  s_add_u32 s52, s52, s4
  s_lshl_b32 s52, s52, 7
  s_add_u32 s68, s68, s52
  s_add_u32 s68, s68, 65536
  s_mul_i32 s69, s65, 1280
  s_lshl_b32 s52, s66, 6
  s_add_u32 s69, s69, s52
  s_add_u32 s69, s69, 720896
  s_sub_u32 s71, s3, 12
  s_cmp_eq_u32 s3, 11
  s_cselect_b32 s71, 0, s71
  s_lshr_b32 s60, s62, 4
  s_lshl_b32 s60, s60, 10
  s_and_b32 s52, s62, 3
  s_lshl_b32 s52, s52, 8
  s_add_u32 s60, s60, s52
  s_bfe_u32 s52, s62, 0x20002
  s_lshl_b32 s52, s52, 6
  s_add_u32 s60, s60, s52
  s_add_u32 s60, s60, 786432
  s_lshl_b32 s70, s71, 4
  s_add_u32 s70, s70, s60
  s_mov_b32 s72, 4
  s_cmp_lt_u32 s3, 10
  s_cselect_b32 s72, 0, s72
  s_cmp_lt_u32 s3, 10
  s_cbranch_scc1 L_role_2z
  s_cmp_eq_u32 s3, 10
  s_cbranch_scc1 L_role_2a
  s_cmp_eq_u32 s3, 12
  s_cbranch_scc1 L_role_2z
  s_cmp_lt_u32 s2, 216
  s_cselect_b32 s72, 2, 3
  s_branch L_role_2z
L_role_2a:
  s_cmp_lt_u32 s64, 80
  s_cselect_b32 s72, 1, s72
L_role_2z:
  s_lshl_b32 s83, s6, 1
  s_add_u32 s83, s83, s4
  s_lshl_b32 s82, s5, 14
  s_lshl_b32 s52, s83, 9
  s_add_u32 s82, s82, s52
  s_add_u32 s82, s82, 851968
  s_cmp_lg_u32 s3, 4
  s_cbranch_scc1 L_clr_3z
  v_mov_b32 v32, -1
  v_mov_b32 v33, -1
  v_mov_b32 v34, -1
  v_mov_b32 v35, -1
  v_lshlrev_b32 v36, 3, v0
  v_lshrrev_b32 v37, 3, v0
  v_lshlrev_b32 v37, 13, v37
  v_and_b32 v38, 7, v0
  v_lshl_add_u32 v37, v38, 4, v37
  v_lshrrev_b32 v39, 5, v0
  v_lshlrev_b32 v39, 12, v39
  v_and_b32 v38, 31, v0
  v_lshl_add_u32 v39, v38, 4, v39
  buffer_store_dwordx4 v[32:35], v39, s[48:51], s82 offen sc1
  s_add_u32 s52, s82, 0x2000
  buffer_store_dwordx4 v[32:35], v39, s[48:51], s52 offen sc1
  s_sub_u32 s52, s67, 32
  s_mov_b64 exec, 0xffff
  buffer_store_dwordx2 v[32:33], v36, s[48:51], s52 offen sc1
  s_mov_b64 exec, -1
  s_sub_u32 s53, s68, 65536
  buffer_store_dwordx4 v[32:35], v37, s[48:51], s53 offen sc1
  s_add_u32 s52, s53, 0x10000
  buffer_store_dwordx4 v[32:35], v37, s[48:51], s52 offen sc1
  s_add_u32 s52, s53, 0x20000
  s_mov_b32 exec_hi, 0
  buffer_store_dwordx4 v[32:35], v37, s[48:51], s52 offen sc1
  s_cmp_ge_u32 s64, 80
  s_nop 0
  s_cbranch_scc1 L_clr_3a
  v_lshrrev_b32 v36, 2, v0
  v_lshlrev_b32 v36, 13, v36
  v_and_b32 v38, 3, v0
  v_lshl_add_u32 v36, v38, 4, v36
  s_mov_b32 exec_lo, -1
  s_mov_b32 exec_hi, 0
  buffer_store_dwordx4 v[32:35], v36, s[48:51], s69 offen sc1
  s_nop 1
L_clr_3a:
  s_cmp_ge_u32 s2, 216
  s_cbranch_scc1 L_clr_3b
  s_mov_b64 exec, -1
  v_and_b32 v36, 3, v0
  v_lshlrev_b32 v36, 4, v36
  v_lshrrev_b32 v38, 2, v0
  v_lshl_add_u32 v36, v38, 14, v36
  s_mov_b32 s52, s60
  s_mov_b64 exec, 0xffff
  buffer_store_dwordx4 v[32:35], v36, s[48:51], s52 offen sc1
  s_nop 1
L_clr_3b:
  s_mov_b64 exec, -1
L_clr_3z:
  s_waitcnt lgkmcnt(0)
  s_barrier
  s_cmp_lg_u32 s3, 4
  s_cbranch_scc1 L_clr2_4z
  s_waitcnt vmcnt(0)
  v_mov_b32 v36, 1
  s_and_b32 s52, s2, 3
  s_lshl_b32 s52, s52, 6
  s_mov_b64 exec, 1
  buffer_atomic_add v36, off, s[44:47], s52 sc1
  s_mov_b64 exec, -1
  v_mov_b32 v36, 1
  v_mov_b32 v37, 2848
  s_mov_b64 exec, 1
  ds_add_u32 v37, v36
  s_mov_b64 exec, -1
L_clr2_4z:
  v_lshrrev_b32 v23, 4, v0
  v_lshlrev_b32 v23, 13, v23
  v_and_b32 v41, 15, v0
  v_lshl_add_u32 v23, v41, 4, v23
  s_lshl_b32 s73, s83, 2
  s_add_u32 s73, s73, s3
  s_mul_i32 s84, s73, 80
  s_mul_i32 s73, s73, 163840
  s_lshl_b32 s52, s5, 8
  s_add_u32 s73, s73, s52
  s_cmp_ge_u32 s3, 4
  s_cselect_b32 s52, 2, 0
  s_add_u32 s52, s52, s4
  s_cmp_eq_u32 s52, 1
  s_cbranch_scc1 L_path1
  s_cmp_eq_u32 s52, 2
  s_cbranch_scc1 L_path2
  s_cmp_eq_u32 s52, 3
  s_cbranch_scc1 L_path3
  s_add_u32 s52, s73, 0
  buffer_load_dwordx4 v[56:59], v23, s[16:19], s52 offen
  s_add_u32 s52, s73, 32768
  buffer_load_dwordx4 v[60:63], v23, s[16:19], s52 offen
  s_add_u32 s52, s73, 65536
  buffer_load_dwordx4 v[64:67], v23, s[16:19], s52 offen
  s_add_u32 s52, s73, 98304
  buffer_load_dwordx4 v[68:71], v23, s[16:19], s52 offen
  s_add_u32 s52, s73, 131072
  buffer_load_dwordx4 v[72:75], v23, s[16:19], s52 offen
  s_waitcnt vmcnt(5)
  v_dot2_f32_bf16 v29, v24, s57, 0
  v_dot2_f32_bf16 v29, v25, s57, v29
  v_dot2_f32_bf16 v29, v26, s57, v29
  v_dot2_f32_bf16 v29, v27, s57, v29
  v_dot2_f32_bf16 v29, v28, s57, v29
  v_lshlrev_b32 v42, 16, v24
  v_and_b32 v43, 0xffff0000, v24
  v_lshlrev_b32 v44, 16, v25
  v_and_b32 v45, 0xffff0000, v25
  v_lshlrev_b32 v46, 16, v26
  v_and_b32 v47, 0xffff0000, v26
  v_lshlrev_b32 v48, 16, v27
  v_and_b32 v49, 0xffff0000, v27
  v_lshlrev_b32 v50, 16, v28
  v_and_b32 v51, 0xffff0000, v28
  v_add_f32_dpp v29, v29, v29 row_ror:8 row_mask:0xf bank_mask:0xf
  s_nop 1
  v_add_f32_dpp v29, v29, v29 row_ror:4 row_mask:0xf bank_mask:0xf
  s_nop 1
  v_add_f32_dpp v29, v29, v29 row_ror:2 row_mask:0xf bank_mask:0xf
  s_nop 1
  v_add_f32_dpp v29, v29, v29 row_ror:1 row_mask:0xf bank_mask:0xf
  v_mov_b32 v30, v29
  s_nop 1
  v_permlane16_swap_b32 v29, v30
  v_add_f32 v29, v29, v30
  v_mov_b32 v30, v29
  s_nop 1
  v_permlane32_swap_b32 v29, v30
  v_add_f32 v29, v29, v30
  v_mul_f32 v29, 0x3acccccd, v29
  v_cvt_pk_bf16_f32 v30, v29, v29
  v_and_b32 v30, 0xffff0000, v30
  v_sub_f32 v29, v29, v30
  v_sub_f32 v42, v42, v30
  v_sub_f32 v43, v43, v30
  v_sub_f32 v44, v44, v30
  v_sub_f32 v45, v45, v30
  v_sub_f32 v46, v46, v30
  v_sub_f32 v47, v47, v30
  v_sub_f32 v48, v48, v30
  v_sub_f32 v49, v49, v30
  v_sub_f32 v50, v50, v30
  v_sub_f32 v51, v51, v30
  v_mul_f32 v31, v42, v42
  v_mul_f32 v41, v43, v43
  v_fmac_f32 v31, v44, v44
  v_fmac_f32 v41, v45, v45
  v_fmac_f32 v31, v46, v46
  v_fmac_f32 v41, v47, v47
  v_fmac_f32 v31, v48, v48
  v_fmac_f32 v41, v49, v49
  v_fmac_f32 v31, v50, v50
  v_fmac_f32 v41, v51, v51
  v_add_f32 v31, v31, v41
  v_cvt_pk_bf16_f32 v24, v42, v43
  v_cvt_pk_bf16_f32 v25, v44, v45
  v_cvt_pk_bf16_f32 v26, v46, v47
  v_cvt_pk_bf16_f32 v27, v48, v49
  v_cvt_pk_bf16_f32 v28, v50, v51
  v_add_f32_dpp v31, v31, v31 row_ror:8 row_mask:0xf bank_mask:0xf
  s_nop 1
  v_add_f32_dpp v31, v31, v31 row_ror:4 row_mask:0xf bank_mask:0xf
  s_nop 1
  v_add_f32_dpp v31, v31, v31 row_ror:2 row_mask:0xf bank_mask:0xf
  s_nop 1
  v_add_f32_dpp v31, v31, v31 row_ror:1 row_mask:0xf bank_mask:0xf
  v_mov_b32 v30, v31
  s_nop 1
  v_permlane16_swap_b32 v31, v30
  v_add_f32 v31, v31, v30
  v_mov_b32 v30, v31
  s_nop 1
  v_permlane32_swap_b32 v31, v30
  v_add_f32 v31, v31, v30
  v_mul_f32 v31, 0x3acccccd, v31
  v_fma_f32 v31, -v29, v29, v31
  v_max_f32 v31, 0, v31
  v_cvt_pk_bf16_f32 v31, v31, v31
  v_and_b32 v31, 0xffff0000, v31
  v_add_f32 v31, 0x3727c5ac, v31
  v_cvt_pk_bf16_f32 v31, v31, v31
  v_and_b32 v31, 0xffff0000, v31
  v_sqrt_f32 v31, v31
  v_lshlrev_b32 v42, 16, v24
  v_and_b32 v43, 0xffff0000, v24
  v_lshlrev_b32 v44, 16, v25
  v_and_b32 v45, 0xffff0000, v25
  v_lshlrev_b32 v46, 16, v26
  v_and_b32 v47, 0xffff0000, v26
  v_lshlrev_b32 v48, 16, v27
  v_and_b32 v49, 0xffff0000, v27
  v_lshlrev_b32 v50, 16, v28
  v_and_b32 v51, 0xffff0000, v28
  v_cvt_pk_bf16_f32 v31, v31, v31
  v_and_b32 v31, 0xffff0000, v31
  v_rcp_f32 v31, v31
  s_nop 0
  v_mul_f32 v42, v42, v31
  v_mul_f32 v43, v43, v31
  v_mul_f32 v44, v44, v31
  v_mul_f32 v45, v45, v31
  v_mul_f32 v46, v46, v31
  v_mul_f32 v47, v47, v31
  v_mul_f32 v48, v48, v31
  v_mul_f32 v49, v49, v31
  v_mul_f32 v50, v50, v31
  v_mul_f32 v51, v51, v31
  s_mul_i32 s52, s3, 2560
  v_lshl_add_u32 v31, v0, 3, s52
  v_cvt_pk_bf16_f32 v24, v42, v42
  v_cvt_pk_bf16_f32 v25, v43, v43
  ds_write_b64 v31, v[24:25] offset:18432
  v_cvt_pk_bf16_f32 v26, v44, v44
  v_cvt_pk_bf16_f32 v27, v45, v45
  ds_write_b64 v31, v[26:27] offset:18944
  v_cvt_pk_bf16_f32 v24, v46, v46
  v_cvt_pk_bf16_f32 v25, v47, v47
  ds_write_b64 v31, v[24:25] offset:19456
  v_cvt_pk_bf16_f32 v26, v48, v48
  v_cvt_pk_bf16_f32 v27, v49, v49
  ds_write_b64 v31, v[26:27] offset:19968
  v_cvt_pk_bf16_f32 v24, v50, v50
  v_cvt_pk_bf16_f32 v25, v51, v51
  ds_write_b64 v31, v[24:25] offset:20480
  s_waitcnt lgkmcnt(0)
  v_mov_b32 v24, 1
  v_mov_b32 v25, 2844
  s_mov_b64 exec, 1
  ds_add_u32 v25, v24
  s_mov_b64 exec, -1
  v_mov_b32 v25, 2844
  s_mov_b32 s61, 0
  s_nop 0
L_lw_5r:
  ds_read_b32 v24, v25
  s_waitcnt lgkmcnt(0)
  v_readfirstlane_b32 s52, v24
  s_cmp_ge_u32 s52, 4
  s_nop 3
  s_cbranch_scc1 L_lw_5o
  s_sleep 1
  s_add_u32 s61, s61, 1
  s_cmp_lt_u32 s61, 4800000
  s_cbranch_scc1 L_lw_5r
L_lw_5o:
  v_lshrrev_b32 v24, 4, v0
  v_lshl_add_u32 v24, v24, 2, s84
  ds_read_b32 v32, v24 offset:18432
  ds_read_b32 v33, v24 offset:20992
  ds_read_b32 v34, v24 offset:23552
  ds_read_b32 v35, v24 offset:26112
  ds_read_b32 v36, v24 offset:18448
  ds_read_b32 v37, v24 offset:21008
  ds_read_b32 v38, v24 offset:23568
  ds_read_b32 v39, v24 offset:26128
  ds_read_b32 v40, v24 offset:18464
  ds_read_b32 v41, v24 offset:21024
  ds_read_b32 v42, v24 offset:23584
  ds_read_b32 v43, v24 offset:26144
  s_waitcnt lgkmcnt(0)
  ds_read_b32 v44, v24 offset:18480
  ds_read_b32 v45, v24 offset:21040
  ds_read_b32 v46, v24 offset:23600
  ds_read_b32 v47, v24 offset:26160
  ds_read_b32 v48, v24 offset:18496
  ds_read_b32 v49, v24 offset:21056
  ds_read_b32 v50, v24 offset:23616
  ds_read_b32 v51, v24 offset:26176
  v_mov_b32 v52, 0
  v_mov_b32 v53, 0
  v_mov_b32 v54, 0
  v_mov_b32 v55, 0
  v_mov_b32 v76, 0
  v_mov_b32 v77, 0
  v_mov_b32 v78, 0
  v_mov_b32 v79, 0
  v_mov_b32 v80, 0
  v_mov_b32 v81, 0
  v_mov_b32 v82, 0
  v_mov_b32 v83, 0
  v_mov_b32 v84, 0
  v_mov_b32 v85, 0
  v_mov_b32 v86, 0
  v_mov_b32 v87, 0
  s_waitcnt lgkmcnt(0)
  s_waitcnt vmcnt(4)
  v_cndmask_b32 v32, v32, 0, s[58:59]
  v_and_b32 v16, v32, v2
  v_and_b32 v17, v32, v3
  v_and_b32 v18, v32, v4
  v_and_b32 v19, v32, v5
  s_nop 1
  v_mfma_f32_16x16x32_bf16 v[52:55], v[16:19], v[56:59], v[52:55]
  v_cndmask_b32 v33, v33, 0, s[58:59]
  v_and_b32 v24, v33, v2
  v_and_b32 v25, v33, v3
  v_and_b32 v26, v33, v4
  v_and_b32 v27, v33, v5
  s_nop 1
  v_mfma_f32_16x16x32_bf16 v[76:79], v[24:27], v[56:59], v[76:79]
  v_cndmask_b32 v34, v34, 0, s[58:59]
  v_and_b32 v28, v34, v2
  v_and_b32 v29, v34, v3
  v_and_b32 v30, v34, v4
  v_and_b32 v31, v34, v5
  s_nop 1
  v_mfma_f32_16x16x32_bf16 v[80:83], v[28:31], v[56:59], v[80:83]
  v_cndmask_b32 v35, v35, 0, s[58:59]
  v_and_b32 v16, v35, v2
  v_and_b32 v17, v35, v3
  v_and_b32 v18, v35, v4
  v_and_b32 v19, v35, v5
  s_nop 1
  v_mfma_f32_16x16x32_bf16 v[84:87], v[16:19], v[56:59], v[84:87]
  s_waitcnt vmcnt(3)
  v_cndmask_b32 v36, v36, 0, s[58:59]
  v_and_b32 v24, v36, v2
  v_and_b32 v25, v36, v3
  v_and_b32 v26, v36, v4
  v_and_b32 v27, v36, v5
  s_nop 1
  v_mfma_f32_16x16x32_bf16 v[52:55], v[24:27], v[60:63], v[52:55]
  v_cndmask_b32 v37, v37, 0, s[58:59]
  v_and_b32 v28, v37, v2
  v_and_b32 v29, v37, v3
  v_and_b32 v30, v37, v4
  v_and_b32 v31, v37, v5
  s_nop 1
  v_mfma_f32_16x16x32_bf16 v[76:79], v[28:31], v[60:63], v[76:79]
  v_cndmask_b32 v38, v38, 0, s[58:59]
  v_and_b32 v16, v38, v2
  v_and_b32 v17, v38, v3
  v_and_b32 v18, v38, v4
  v_and_b32 v19, v38, v5
  s_nop 1
  v_mfma_f32_16x16x32_bf16 v[80:83], v[16:19], v[60:63], v[80:83]
  v_cndmask_b32 v39, v39, 0, s[58:59]
  v_and_b32 v24, v39, v2
  v_and_b32 v25, v39, v3
  v_and_b32 v26, v39, v4
  v_and_b32 v27, v39, v5
  s_nop 1
  v_mfma_f32_16x16x32_bf16 v[84:87], v[24:27], v[60:63], v[84:87]
  s_waitcnt vmcnt(2)
  v_cndmask_b32 v40, v40, 0, s[58:59]
  v_and_b32 v28, v40, v2
  v_and_b32 v29, v40, v3
  v_and_b32 v30, v40, v4
  v_and_b32 v31, v40, v5
  s_nop 1
  v_mfma_f32_16x16x32_bf16 v[52:55], v[28:31], v[64:67], v[52:55]
  v_cndmask_b32 v41, v41, 0, s[58:59]
  v_and_b32 v16, v41, v2
  v_and_b32 v17, v41, v3
  v_and_b32 v18, v41, v4
  v_and_b32 v19, v41, v5
  s_nop 1
  v_mfma_f32_16x16x32_bf16 v[76:79], v[16:19], v[64:67], v[76:79]
  v_cndmask_b32 v42, v42, 0, s[58:59]
  v_and_b32 v24, v42, v2
  v_and_b32 v25, v42, v3
  v_and_b32 v26, v42, v4
  v_and_b32 v27, v42, v5
  s_nop 1
  v_mfma_f32_16x16x32_bf16 v[80:83], v[24:27], v[64:67], v[80:83]
  v_cndmask_b32 v43, v43, 0, s[58:59]
  v_and_b32 v28, v43, v2
  v_and_b32 v29, v43, v3
  v_and_b32 v30, v43, v4
  v_and_b32 v31, v43, v5
  s_nop 1
  v_mfma_f32_16x16x32_bf16 v[84:87], v[28:31], v[64:67], v[84:87]
  s_waitcnt vmcnt(1)
  v_cndmask_b32 v44, v44, 0, s[58:59]
  v_and_b32 v16, v44, v2
  v_and_b32 v17, v44, v3
  v_and_b32 v18, v44, v4
  v_and_b32 v19, v44, v5
  s_nop 1
  v_mfma_f32_16x16x32_bf16 v[52:55], v[16:19], v[68:71], v[52:55]
  v_cndmask_b32 v45, v45, 0, s[58:59]
  v_and_b32 v24, v45, v2
  v_and_b32 v25, v45, v3
  v_and_b32 v26, v45, v4
  v_and_b32 v27, v45, v5
  s_nop 1
  v_mfma_f32_16x16x32_bf16 v[76:79], v[24:27], v[68:71], v[76:79]
  v_cndmask_b32 v46, v46, 0, s[58:59]
  v_and_b32 v28, v46, v2
  v_and_b32 v29, v46, v3
  v_and_b32 v30, v46, v4
  v_and_b32 v31, v46, v5
  s_nop 1
  v_mfma_f32_16x16x32_bf16 v[80:83], v[28:31], v[68:71], v[80:83]
  v_cndmask_b32 v47, v47, 0, s[58:59]
  v_and_b32 v16, v47, v2
  v_and_b32 v17, v47, v3
  v_and_b32 v18, v47, v4
  v_and_b32 v19, v47, v5
  s_nop 1
  v_mfma_f32_16x16x32_bf16 v[84:87], v[16:19], v[68:71], v[84:87]
  s_waitcnt vmcnt(0)
  v_cndmask_b32 v48, v48, 0, s[58:59]
  v_and_b32 v24, v48, v2
  v_and_b32 v25, v48, v3
  v_and_b32 v26, v48, v4
  v_and_b32 v27, v48, v5
  s_nop 1
  v_mfma_f32_16x16x32_bf16 v[52:55], v[24:27], v[72:75], v[52:55]
  v_cndmask_b32 v49, v49, 0, s[58:59]
  v_and_b32 v28, v49, v2
  v_and_b32 v29, v49, v3
  v_and_b32 v30, v49, v4
  v_and_b32 v31, v49, v5
  s_nop 1
  v_mfma_f32_16x16x32_bf16 v[76:79], v[28:31], v[72:75], v[76:79]
  v_cndmask_b32 v50, v50, 0, s[58:59]
  v_and_b32 v16, v50, v2
  v_and_b32 v17, v50, v3
  v_and_b32 v18, v50, v4
  v_and_b32 v19, v50, v5
  s_nop 1
  v_mfma_f32_16x16x32_bf16 v[80:83], v[16:19], v[72:75], v[80:83]
  v_cndmask_b32 v51, v51, 0, s[58:59]
  v_and_b32 v24, v51, v2
  v_and_b32 v25, v51, v3
  v_and_b32 v26, v51, v4
  v_and_b32 v27, v51, v5
  s_nop 1
  v_mfma_f32_16x16x32_bf16 v[84:87], v[24:27], v[72:75], v[84:87]
  v_and_b32 v32, 15, v0
  v_lshlrev_b32 v32, 5, v32
  v_lshrrev_b32 v33, 4, v0
  v_lshl_add_u32 v32, v33, 4, v32
  s_lshl_b32 s52, s3, 11
  v_add_u32 v32, s52, v32
  s_mov_b32 exec_hi, 0
  ds_write_b128 v32, v[52:55] offset:4096
  ds_write_b128 v32, v[76:79] offset:4608
  ds_write_b128 v32, v[80:83] offset:5120
  ds_write_b128 v32, v[84:87] offset:5632
  s_mov_b32 exec_hi, -1
  s_waitcnt lgkmcnt(0)
  v_mov_b32 v24, 1
  v_mov_b32 v25, 2820
  s_mov_b64 exec, 1
  ds_add_u32 v25, v24
  s_mov_b64 exec, -1
  v_mov_b32 v25, 2820
  s_mov_b32 s61, 0
  s_nop 0
L_lw_6r:
  ds_read_b32 v24, v25
  s_waitcnt lgkmcnt(0)
  v_readfirstlane_b32 s52, v24
  s_cmp_ge_u32 s52, 4
  s_nop 3
  s_cbranch_scc1 L_lw_6o
  s_sleep 1
  s_add_u32 s61, s61, 1
  s_cmp_lt_u32 s61, 4800000
  s_cbranch_scc1 L_lw_6r
L_lw_6o:
  s_lshl_b32 s52, s3, 9
  v_lshl_add_u32 v32, v0, 3, s52
  ds_read_b64 v[34:35], v32 offset:4096
  ds_read_b64 v[36:37], v32 offset:6144
  ds_read_b64 v[38:39], v32 offset:8192
  ds_read_b64 v[40:41], v32 offset:10240
  v_mov_b32 v25, 2848
  s_mov_b32 s61, 0
  s_nop 0
L_lw_7r:
  ds_read_b32 v24, v25
  s_waitcnt lgkmcnt(0)
  v_readfirstlane_b32 s52, v24
  s_cmp_ge_u32 s52, 1
  s_nop 3
  s_cbranch_scc1 L_lw_7o
  s_sleep 1
  s_add_u32 s61, s61, 1
  s_cmp_lt_u32 s61, 4800000
  s_cbranch_scc1 L_lw_7r
L_lw_7o:
  v_add_f32 v34, v34, v36
  v_add_f32 v35, v35, v37
  v_add_f32 v34, v34, v38
  v_add_f32 v35, v35, v39
  v_add_f32 v34, v34, v40
  v_add_f32 v35, v35, v41
  v_min_u32 v34, 0xfffffffe, v34
  v_min_u32 v35, 0xfffffffe, v35
  v_lshlrev_b32 v33, 3, v0
  s_lshl_b32 s52, s3, 12
  s_add_u32 s52, s52, s82
  buffer_store_dwordx2 v[34:35], v33, s[48:51], s52 offen sc1
  s_cmp_lg_u32 s3, 0
  s_cbranch_scc1 L_q_8
  v_and_b32 v33, 3, v0
  v_lshlrev_b32 v33, 6, v33
  s_mov_b32 s61, 0
  s_nop 0
L_cchk_9r:
  buffer_load_dword v34, v33, s[44:47], 0 offen sc1
  s_waitcnt vmcnt(0)
  v_cmp_gt_u32 vcc, 64, v34
  s_nop 4
  s_cbranch_vccz L_cchk_9o
  s_sleep 8
  s_add_u32 s61, s61, 1
  s_cmp_lt_u32 s61, 300000
  s_cbranch_scc1 L_cchk_9r
L_cchk_9o:
  s_lshl_b32 s52, s5, 14
  s_lshl_b32 s53, s6, 12
  s_add_u32 s53, s53, s52
  s_add_u32 s53, s53, 851968
  s_mov_b32 s61, 0
L_qp_10r:
  buffer_load_dwordx4 v[32:35], v1, s[48:51], s53 offen offset:0 sc1
  buffer_load_dwordx4 v[36:39], v1, s[48:51], s53 offen offset:1024 sc1
  buffer_load_dwordx4 v[40:43], v1, s[48:51], s53 offen offset:2048 sc1
  buffer_load_dwordx4 v[44:47], v1, s[48:51], s53 offen offset:3072 sc1
  s_waitcnt vmcnt(0)
  v_max3_u32 v48, v32, v33, v34
  v_max3_u32 v48, v48, v35, v36
  v_max3_u32 v48, v48, v37, v38
  v_max3_u32 v48, v48, v39, v40
  v_max3_u32 v48, v48, v41, v42
  v_max3_u32 v48, v48, v43, v44
  v_max3_u32 v48, v48, v45, v46
  v_max_u32 v48, v48, v47
  v_cmp_eq_u32 vcc, -1, v48
  s_nop 4
  s_cbranch_vccz L_qp_10o
  s_sleep 2
  s_add_u32 s61, s61, 1
  s_cmp_lt_u32 s61, 300000
  s_cbranch_scc1 L_qp_10r
L_qp_10o:
  v_add_f32 v32, v32, v36
  v_add_f32 v33, v33, v37
  v_add_f32 v34, v34, v38
  v_add_f32 v35, v35, v39
  v_add_f32 v32, v32, v40
  v_add_f32 v33, v33, v41
  v_add_f32 v34, v34, v42
  v_add_f32 v35, v35, v43
  v_add_f32 v32, v32, v44
  v_add_f32 v33, v33, v45
  v_add_f32 v34, v34, v46
  v_add_f32 v35, v35, v47
  v_mov_b32 v36, v32
  v_mov_b32 v37, v33
  v_mov_b32 v38, v34
  v_mov_b32 v39, v35
  v_permlane32_swap_b32 v32, v36
  v_permlane32_swap_b32 v33, v37
  v_permlane32_swap_b32 v34, v38
  v_permlane32_swap_b32 v35, v39
  v_add_f32 v32, v32, v36
  v_add_f32 v33, v33, v37
  v_add_f32 v34, v34, v38
  v_add_f32 v35, v35, v39
  v_cvt_pk_bf16_f32 v32, v32, v33
  v_cvt_pk_bf16_f32 v33, v34, v35
  v_and_b32 v34, 31, v0
  v_lshlrev_b32 v34, 3, v34
  ds_write_b64 v34, v[32:33] offset:2560
  s_waitcnt lgkmcnt(0)
  v_mov_b32 v24, 1
  v_mov_b32 v25, 2824
  s_mov_b64 exec, 1
  ds_add_u32 v25, v24
  s_mov_b64 exec, -1
L_q_8:
  s_add_u32 s52, s54, 0
  buffer_load_dwordx4 v[76:79], v1, s[8:11], s52 offen offset:0 nt
  s_add_u32 s52, s54, 0
  buffer_load_dwordx4 v[80:83], v1, s[8:11], s52 offen offset:1024 nt
  s_add_u32 s52, s54, 0
  buffer_load_dwordx4 v[84:87], v1, s[8:11], s52 offen offset:2048 nt
  s_add_u32 s52, s54, 0
  buffer_load_dwordx4 v[88:91], v1, s[8:11], s52 offen offset:3072 nt
  s_add_u32 s52, s54, 4096
  buffer_load_dwordx4 v[92:95], v1, s[8:11], s52 offen offset:0 nt
  s_add_u32 s52, s54, 4096
  buffer_load_dwordx4 v[96:99], v1, s[8:11], s52 offen offset:1024 nt
  s_add_u32 s52, s54, 4096
  buffer_load_dwordx4 v[52:55], v1, s[8:11], s52 offen offset:2048 nt
  s_add_u32 s52, s54, 4096
  buffer_load_dwordx4 v[56:59], v1, s[8:11], s52 offen offset:3072 nt
  s_add_u32 s52, s54, 8192
  buffer_load_dwordx4 v[60:63], v1, s[8:11], s52 offen offset:0 nt
  s_add_u32 s52, s54, 8192
  buffer_load_dwordx4 v[64:67], v1, s[8:11], s52 offen offset:1024 nt
  s_add_u32 s52, s54, 8192
  buffer_load_dwordx4 v[68:71], v1, s[8:11], s52 offen offset:2048 nt
  s_add_u32 s52, s54, 8192
  buffer_load_dwordx4 v[72:75], v1, s[8:11], s52 offen offset:3072 nt
  v_mov_b32 v25, 2824
  s_mov_b32 s61, 0
  s_nop 0
L_lw_11r:
  ds_read_b32 v24, v25
  s_waitcnt lgkmcnt(0)
  v_readfirstlane_b32 s52, v24
  s_cmp_ge_u32 s52, 1
  s_nop 3
  s_cbranch_scc1 L_lw_11o
  s_sleep 4
  s_add_u32 s61, s61, 1
  s_cmp_lt_u32 s61, 1200000
  s_cbranch_scc1 L_lw_11r
L_lw_11o:
  v_and_b32 v24, 15, v0
  v_lshlrev_b32 v24, 4, v24
  ds_read_b128 v[6:9], v24 offset:2560
  v_mov_b32 v14, 0xff800000
  v_mov_b32 v10, 0
  v_mov_b32 v11, 0
  v_mov_b32 v12, 0
  v_mov_b32 v13, 0
  s_waitcnt lgkmcnt(0)
  s_waitcnt vmcnt(11)
  v_dot2_f32_bf16 v24, v76, v6, 0
  v_dot2_f32_bf16 v24, v77, v7, v24
  v_dot2_f32_bf16 v24, v78, v8, v24
  v_dot2_f32_bf16 v24, v79, v9, v24
  s_add_u32 s52, s54, 12288
  buffer_load_dwordx4 v[76:79], v1, s[8:11], s52 offen offset:0 nt
  s_nop 0
  v_add_f32_dpp v24, v24, v24 row_ror:8 row_mask:0xf bank_mask:0xf
  s_nop 1
  v_add_f32_dpp v24, v24, v24 row_ror:4 row_mask:0xf bank_mask:0xf
  s_nop 1
  v_add_f32_dpp v24, v24, v24 row_ror:2 row_mask:0xf bank_mask:0xf
  s_nop 1
  v_add_f32_dpp v24, v24, v24 row_ror:1 row_mask:0xf bank_mask:0xf
  v_cvt_pk_bf16_f32 v28, v24, v24
  v_and_b32 v29, 0xffff0000, v28
  v_lshlrev_b32 v28, 16, v28
  v_mul_f32 v29, s55, v29
  v_mul_f32 v28, s55, v28
  v_max3_f32 v14, v14, v28, v29
  v_cvt_pk_bf16_f32 v48, v28, v29
  s_waitcnt vmcnt(11)
  v_dot2_f32_bf16 v24, v80, v6, 0
  v_dot2_f32_bf16 v24, v81, v7, v24
  v_dot2_f32_bf16 v24, v82, v8, v24
  v_dot2_f32_bf16 v24, v83, v9, v24
  s_add_u32 s52, s54, 12288
  buffer_load_dwordx4 v[80:83], v1, s[8:11], s52 offen offset:1024 nt
  s_waitcnt vmcnt(11)
  v_dot2_f32_bf16 v25, v84, v6, 0
  v_dot2_f32_bf16 v25, v85, v7, v25
  v_dot2_f32_bf16 v25, v86, v8, v25
  v_dot2_f32_bf16 v25, v87, v9, v25
  s_add_u32 s52, s54, 12288
  buffer_load_dwordx4 v[84:87], v1, s[8:11], s52 offen offset:2048 nt
  s_waitcnt vmcnt(11)
  v_dot2_f32_bf16 v26, v88, v6, 0
  v_dot2_f32_bf16 v26, v89, v7, v26
  v_dot2_f32_bf16 v26, v90, v8, v26
  v_dot2_f32_bf16 v26, v91, v9, v26
  s_add_u32 s52, s54, 12288
  buffer_load_dwordx4 v[88:91], v1, s[8:11], s52 offen offset:3072 nt
  s_waitcnt vmcnt(11)
  v_dot2_f32_bf16 v27, v92, v6, 0
  v_dot2_f32_bf16 v27, v93, v7, v27
  v_dot2_f32_bf16 v27, v94, v8, v27
  v_dot2_f32_bf16 v27, v95, v9, v27
  s_add_u32 s52, s54, 16384
  buffer_load_dwordx4 v[92:95], v1, s[8:11], s52 offen offset:0 nt
  v_add_f32_dpp v24, v24, v24 row_ror:8 row_mask:0xf bank_mask:0xf
  v_add_f32_dpp v25, v25, v25 row_ror:8 row_mask:0xf bank_mask:0xf
  v_add_f32_dpp v26, v26, v26 row_ror:8 row_mask:0xf bank_mask:0xf
  v_add_f32_dpp v27, v27, v27 row_ror:8 row_mask:0xf bank_mask:0xf
  v_add_f32_dpp v24, v24, v24 row_ror:4 row_mask:0xf bank_mask:0xf
  v_add_f32_dpp v25, v25, v25 row_ror:4 row_mask:0xf bank_mask:0xf
  v_add_f32_dpp v26, v26, v26 row_ror:4 row_mask:0xf bank_mask:0xf
  v_add_f32_dpp v27, v27, v27 row_ror:4 row_mask:0xf bank_mask:0xf
  v_add_f32_dpp v24, v24, v24 row_ror:2 row_mask:0xf bank_mask:0xf
  v_add_f32_dpp v25, v25, v25 row_ror:2 row_mask:0xf bank_mask:0xf
  v_add_f32_dpp v26, v26, v26 row_ror:2 row_mask:0xf bank_mask:0xf
  v_add_f32_dpp v27, v27, v27 row_ror:2 row_mask:0xf bank_mask:0xf
  v_add_f32_dpp v24, v24, v24 row_ror:1 row_mask:0xf bank_mask:0xf
  v_add_f32_dpp v25, v25, v25 row_ror:1 row_mask:0xf bank_mask:0xf
  v_add_f32_dpp v26, v26, v26 row_ror:1 row_mask:0xf bank_mask:0xf
  v_add_f32_dpp v27, v27, v27 row_ror:1 row_mask:0xf bank_mask:0xf
  v_cvt_pk_bf16_f32 v28, v25, v24
  v_and_b32 v29, 0xffff0000, v28
  v_lshlrev_b32 v28, 16, v28
  v_mul_f32 v29, s55, v29
  v_mul_f32 v28, s55, v28
  v_max3_f32 v14, v14, v28, v29
  v_cvt_pk_bf16_f32 v47, v28, v29
  v_cvt_pk_bf16_f32 v30, v27, v26
  v_and_b32 v31, 0xffff0000, v30
  v_lshlrev_b32 v30, 16, v30
  v_mul_f32 v31, s55, v31
  v_mul_f32 v30, s55, v30
  v_max3_f32 v14, v14, v30, v31
  v_cvt_pk_bf16_f32 v46, v30, v31
  s_waitcnt vmcnt(11)
  v_dot2_f32_bf16 v24, v96, v6, 0
  v_dot2_f32_bf16 v24, v97, v7, v24
  v_dot2_f32_bf16 v24, v98, v8, v24
  v_dot2_f32_bf16 v24, v99, v9, v24
  s_add_u32 s52, s54, 16384
  buffer_load_dwordx4 v[96:99], v1, s[8:11], s52 offen offset:1024 nt
  s_waitcnt vmcnt(11)
  v_dot2_f32_bf16 v25, v52, v6, 0
  v_dot2_f32_bf16 v25, v53, v7, v25
  v_dot2_f32_bf16 v25, v54, v8, v25
  v_dot2_f32_bf16 v25, v55, v9, v25
  s_add_u32 s52, s54, 16384
  buffer_load_dwordx4 v[52:55], v1, s[8:11], s52 offen offset:2048 nt
  s_waitcnt vmcnt(11)
  v_dot2_f32_bf16 v26, v56, v6, 0
  v_dot2_f32_bf16 v26, v57, v7, v26
  v_dot2_f32_bf16 v26, v58, v8, v26
  v_dot2_f32_bf16 v26, v59, v9, v26
  s_add_u32 s52, s54, 16384
  buffer_load_dwordx4 v[56:59], v1, s[8:11], s52 offen offset:3072 nt
  s_waitcnt vmcnt(11)
  v_dot2_f32_bf16 v27, v60, v6, 0
  v_dot2_f32_bf16 v27, v61, v7, v27
  v_dot2_f32_bf16 v27, v62, v8, v27
  v_dot2_f32_bf16 v27, v63, v9, v27
  s_add_u32 s52, s54, 20480
  buffer_load_dwordx4 v[60:63], v1, s[8:11], s52 offen offset:0 nt
  v_add_f32_dpp v24, v24, v24 row_ror:8 row_mask:0xf bank_mask:0xf
  v_add_f32_dpp v25, v25, v25 row_ror:8 row_mask:0xf bank_mask:0xf
  v_add_f32_dpp v26, v26, v26 row_ror:8 row_mask:0xf bank_mask:0xf
  v_add_f32_dpp v27, v27, v27 row_ror:8 row_mask:0xf bank_mask:0xf
  v_add_f32_dpp v24, v24, v24 row_ror:4 row_mask:0xf bank_mask:0xf
  v_add_f32_dpp v25, v25, v25 row_ror:4 row_mask:0xf bank_mask:0xf
  v_add_f32_dpp v26, v26, v26 row_ror:4 row_mask:0xf bank_mask:0xf
  v_add_f32_dpp v27, v27, v27 row_ror:4 row_mask:0xf bank_mask:0xf
  v_add_f32_dpp v24, v24, v24 row_ror:2 row_mask:0xf bank_mask:0xf
  v_add_f32_dpp v25, v25, v25 row_ror:2 row_mask:0xf bank_mask:0xf
  v_add_f32_dpp v26, v26, v26 row_ror:2 row_mask:0xf bank_mask:0xf
  v_add_f32_dpp v27, v27, v27 row_ror:2 row_mask:0xf bank_mask:0xf
  v_add_f32_dpp v24, v24, v24 row_ror:1 row_mask:0xf bank_mask:0xf
  v_add_f32_dpp v25, v25, v25 row_ror:1 row_mask:0xf bank_mask:0xf
  v_add_f32_dpp v26, v26, v26 row_ror:1 row_mask:0xf bank_mask:0xf
  v_add_f32_dpp v27, v27, v27 row_ror:1 row_mask:0xf bank_mask:0xf
  v_cvt_pk_bf16_f32 v28, v25, v24
  v_and_b32 v29, 0xffff0000, v28
  v_lshlrev_b32 v28, 16, v28
  v_mul_f32 v29, s55, v29
  v_mul_f32 v28, s55, v28
  v_max3_f32 v14, v14, v28, v29
  v_cvt_pk_bf16_f32 v45, v28, v29
  v_cvt_pk_bf16_f32 v30, v27, v26
  v_and_b32 v31, 0xffff0000, v30
  v_lshlrev_b32 v30, 16, v30
  v_mul_f32 v31, s55, v31
  v_mul_f32 v30, s55, v30
  v_max3_f32 v14, v14, v30, v31
  v_cvt_pk_bf16_f32 v44, v30, v31
  s_waitcnt vmcnt(11)
  v_dot2_f32_bf16 v24, v64, v6, 0
  v_dot2_f32_bf16 v24, v65, v7, v24
  v_dot2_f32_bf16 v24, v66, v8, v24
  v_dot2_f32_bf16 v24, v67, v9, v24
  s_add_u32 s52, s54, 20480
  buffer_load_dwordx4 v[64:67], v1, s[8:11], s52 offen offset:1024 nt
  s_waitcnt vmcnt(11)
  v_dot2_f32_bf16 v25, v68, v6, 0
  v_dot2_f32_bf16 v25, v69, v7, v25
  v_dot2_f32_bf16 v25, v70, v8, v25
  v_dot2_f32_bf16 v25, v71, v9, v25
  s_add_u32 s52, s54, 20480
  buffer_load_dwordx4 v[68:71], v1, s[8:11], s52 offen offset:2048 nt
  s_waitcnt vmcnt(11)
  v_dot2_f32_bf16 v26, v72, v6, 0
  v_dot2_f32_bf16 v26, v73, v7, v26
  v_dot2_f32_bf16 v26, v74, v8, v26
  v_dot2_f32_bf16 v26, v75, v9, v26
  s_add_u32 s52, s54, 20480
  buffer_load_dwordx4 v[72:75], v1, s[8:11], s52 offen offset:3072 nt
  s_waitcnt vmcnt(11)
  v_dot2_f32_bf16 v27, v76, v6, 0
  v_dot2_f32_bf16 v27, v77, v7, v27
  v_dot2_f32_bf16 v27, v78, v8, v27
  v_dot2_f32_bf16 v27, v79, v9, v27
  s_add_u32 s52, s54, 24576
  buffer_load_dwordx4 v[76:79], v1, s[8:11], s52 offen offset:0 nt
  v_add_f32_dpp v24, v24, v24 row_ror:8 row_mask:0xf bank_mask:0xf
  v_add_f32_dpp v25, v25, v25 row_ror:8 row_mask:0xf bank_mask:0xf
  v_add_f32_dpp v26, v26, v26 row_ror:8 row_mask:0xf bank_mask:0xf
  v_add_f32_dpp v27, v27, v27 row_ror:8 row_mask:0xf bank_mask:0xf
  v_add_f32_dpp v24, v24, v24 row_ror:4 row_mask:0xf bank_mask:0xf
  v_add_f32_dpp v25, v25, v25 row_ror:4 row_mask:0xf bank_mask:0xf
  v_add_f32_dpp v26, v26, v26 row_ror:4 row_mask:0xf bank_mask:0xf
  v_add_f32_dpp v27, v27, v27 row_ror:4 row_mask:0xf bank_mask:0xf
  v_add_f32_dpp v24, v24, v24 row_ror:2 row_mask:0xf bank_mask:0xf
  v_add_f32_dpp v25, v25, v25 row_ror:2 row_mask:0xf bank_mask:0xf
  v_add_f32_dpp v26, v26, v26 row_ror:2 row_mask:0xf bank_mask:0xf
  v_add_f32_dpp v27, v27, v27 row_ror:2 row_mask:0xf bank_mask:0xf
  v_add_f32_dpp v24, v24, v24 row_ror:1 row_mask:0xf bank_mask:0xf
  v_add_f32_dpp v25, v25, v25 row_ror:1 row_mask:0xf bank_mask:0xf
  v_add_f32_dpp v26, v26, v26 row_ror:1 row_mask:0xf bank_mask:0xf
  v_add_f32_dpp v27, v27, v27 row_ror:1 row_mask:0xf bank_mask:0xf
  v_cvt_pk_bf16_f32 v28, v25, v24
  v_and_b32 v29, 0xffff0000, v28
  v_lshlrev_b32 v28, 16, v28
  v_mul_f32 v29, s55, v29
  v_mul_f32 v28, s55, v28
  v_max3_f32 v14, v14, v28, v29
  v_cvt_pk_bf16_f32 v43, v28, v29
  v_cvt_pk_bf16_f32 v30, v27, v26
  v_and_b32 v31, 0xffff0000, v30
  v_lshlrev_b32 v30, 16, v30
  v_mul_f32 v31, s55, v31
  v_mul_f32 v30, s55, v30
  v_max3_f32 v14, v14, v30, v31
  v_cvt_pk_bf16_f32 v42, v30, v31
  s_waitcnt vmcnt(11)
  v_dot2_f32_bf16 v24, v80, v6, 0
  v_dot2_f32_bf16 v24, v81, v7, v24
  v_dot2_f32_bf16 v24, v82, v8, v24
  v_dot2_f32_bf16 v24, v83, v9, v24
  s_add_u32 s52, s54, 24576
  buffer_load_dwordx4 v[80:83], v1, s[8:11], s52 offen offset:1024 nt
  s_waitcnt vmcnt(11)
  v_dot2_f32_bf16 v25, v84, v6, 0
  v_dot2_f32_bf16 v25, v85, v7, v25
  v_dot2_f32_bf16 v25, v86, v8, v25
  v_dot2_f32_bf16 v25, v87, v9, v25
  s_add_u32 s52, s54, 24576
  buffer_load_dwordx4 v[84:87], v1, s[8:11], s52 offen offset:2048 nt
  s_waitcnt vmcnt(11)
  v_dot2_f32_bf16 v26, v88, v6, 0
  v_dot2_f32_bf16 v26, v89, v7, v26
  v_dot2_f32_bf16 v26, v90, v8, v26
  v_dot2_f32_bf16 v26, v91, v9, v26
  s_add_u32 s52, s54, 24576
  buffer_load_dwordx4 v[88:91], v1, s[8:11], s52 offen offset:3072 nt
  s_waitcnt vmcnt(11)
  v_dot2_f32_bf16 v27, v92, v6, 0
  v_dot2_f32_bf16 v27, v93, v7, v27
  v_dot2_f32_bf16 v27, v94, v8, v27
  v_dot2_f32_bf16 v27, v95, v9, v27
  s_add_u32 s52, s54, 28672
  buffer_load_dwordx4 v[92:95], v1, s[8:11], s52 offen offset:0 nt
  v_add_f32_dpp v24, v24, v24 row_ror:8 row_mask:0xf bank_mask:0xf
  v_add_f32_dpp v25, v25, v25 row_ror:8 row_mask:0xf bank_mask:0xf
  v_add_f32_dpp v26, v26, v26 row_ror:8 row_mask:0xf bank_mask:0xf
  v_add_f32_dpp v27, v27, v27 row_ror:8 row_mask:0xf bank_mask:0xf
  v_add_f32_dpp v24, v24, v24 row_ror:4 row_mask:0xf bank_mask:0xf
  v_add_f32_dpp v25, v25, v25 row_ror:4 row_mask:0xf bank_mask:0xf
  v_add_f32_dpp v26, v26, v26 row_ror:4 row_mask:0xf bank_mask:0xf
  v_add_f32_dpp v27, v27, v27 row_ror:4 row_mask:0xf bank_mask:0xf
  v_add_f32_dpp v24, v24, v24 row_ror:2 row_mask:0xf bank_mask:0xf
  v_add_f32_dpp v25, v25, v25 row_ror:2 row_mask:0xf bank_mask:0xf
  v_add_f32_dpp v26, v26, v26 row_ror:2 row_mask:0xf bank_mask:0xf
  v_add_f32_dpp v27, v27, v27 row_ror:2 row_mask:0xf bank_mask:0xf
  v_add_f32_dpp v24, v24, v24 row_ror:1 row_mask:0xf bank_mask:0xf
  v_add_f32_dpp v25, v25, v25 row_ror:1 row_mask:0xf bank_mask:0xf
  v_add_f32_dpp v26, v26, v26 row_ror:1 row_mask:0xf bank_mask:0xf
  v_add_f32_dpp v27, v27, v27 row_ror:1 row_mask:0xf bank_mask:0xf
  v_cvt_pk_bf16_f32 v28, v25, v24
  v_and_b32 v29, 0xffff0000, v28
  v_lshlrev_b32 v28, 16, v28
  v_mul_f32 v29, s55, v29
  v_mul_f32 v28, s55, v28
  v_max3_f32 v14, v14, v28, v29
  v_cvt_pk_bf16_f32 v41, v28, v29
  v_cvt_pk_bf16_f32 v30, v27, v26
  v_and_b32 v31, 0xffff0000, v30
  v_lshlrev_b32 v30, 16, v30
  v_mul_f32 v31, s55, v31
  v_mul_f32 v30, s55, v30
  v_max3_f32 v14, v14, v30, v31
  v_cvt_pk_bf16_f32 v40, v30, v31
  s_waitcnt vmcnt(11)
  v_dot2_f32_bf16 v24, v96, v6, 0
  v_dot2_f32_bf16 v24, v97, v7, v24
  v_dot2_f32_bf16 v24, v98, v8, v24
  v_dot2_f32_bf16 v24, v99, v9, v24
  s_add_u32 s52, s54, 28672
  buffer_load_dwordx4 v[96:99], v1, s[8:11], s52 offen offset:1024 nt
  s_waitcnt vmcnt(11)
  v_dot2_f32_bf16 v25, v52, v6, 0
  v_dot2_f32_bf16 v25, v53, v7, v25
  v_dot2_f32_bf16 v25, v54, v8, v25
  v_dot2_f32_bf16 v25, v55, v9, v25
  s_add_u32 s52, s54, 28672
  buffer_load_dwordx4 v[52:55], v1, s[8:11], s52 offen offset:2048 nt
  s_waitcnt vmcnt(11)
  v_dot2_f32_bf16 v26, v56, v6, 0
  v_dot2_f32_bf16 v26, v57, v7, v26
  v_dot2_f32_bf16 v26, v58, v8, v26
  v_dot2_f32_bf16 v26, v59, v9, v26
  s_add_u32 s52, s54, 28672
  buffer_load_dwordx4 v[56:59], v1, s[8:11], s52 offen offset:3072 nt
  s_waitcnt vmcnt(11)
  v_dot2_f32_bf16 v27, v60, v6, 0
  v_dot2_f32_bf16 v27, v61, v7, v27
  v_dot2_f32_bf16 v27, v62, v8, v27
  v_dot2_f32_bf16 v27, v63, v9, v27
  s_add_u32 s52, s54, 32768
  buffer_load_dwordx4 v[60:63], v1, s[8:11], s52 offen offset:0 nt
  v_add_f32_dpp v24, v24, v24 row_ror:8 row_mask:0xf bank_mask:0xf
  v_add_f32_dpp v25, v25, v25 row_ror:8 row_mask:0xf bank_mask:0xf
  v_add_f32_dpp v26, v26, v26 row_ror:8 row_mask:0xf bank_mask:0xf
  v_add_f32_dpp v27, v27, v27 row_ror:8 row_mask:0xf bank_mask:0xf
  v_add_f32_dpp v24, v24, v24 row_ror:4 row_mask:0xf bank_mask:0xf
  v_add_f32_dpp v25, v25, v25 row_ror:4 row_mask:0xf bank_mask:0xf
  v_add_f32_dpp v26, v26, v26 row_ror:4 row_mask:0xf bank_mask:0xf
  v_add_f32_dpp v27, v27, v27 row_ror:4 row_mask:0xf bank_mask:0xf
  v_add_f32_dpp v24, v24, v24 row_ror:2 row_mask:0xf bank_mask:0xf
  v_add_f32_dpp v25, v25, v25 row_ror:2 row_mask:0xf bank_mask:0xf
  v_add_f32_dpp v26, v26, v26 row_ror:2 row_mask:0xf bank_mask:0xf
  v_add_f32_dpp v27, v27, v27 row_ror:2 row_mask:0xf bank_mask:0xf
  v_add_f32_dpp v24, v24, v24 row_ror:1 row_mask:0xf bank_mask:0xf
  v_add_f32_dpp v25, v25, v25 row_ror:1 row_mask:0xf bank_mask:0xf
  v_add_f32_dpp v26, v26, v26 row_ror:1 row_mask:0xf bank_mask:0xf
  v_add_f32_dpp v27, v27, v27 row_ror:1 row_mask:0xf bank_mask:0xf
  v_cvt_pk_bf16_f32 v28, v25, v24
  v_and_b32 v29, 0xffff0000, v28
  v_lshlrev_b32 v28, 16, v28
  v_mul_f32 v29, s55, v29
  v_mul_f32 v28, s55, v28
  v_max3_f32 v14, v14, v28, v29
  v_cvt_pk_bf16_f32 v39, v28, v29
  v_cvt_pk_bf16_f32 v30, v27, v26
  v_and_b32 v31, 0xffff0000, v30
  v_lshlrev_b32 v30, 16, v30
  v_mul_f32 v31, s55, v31
  v_mul_f32 v30, s55, v30
  v_max3_f32 v14, v14, v30, v31
  v_cvt_pk_bf16_f32 v38, v30, v31
  s_waitcnt vmcnt(11)
  v_dot2_f32_bf16 v24, v64, v6, 0
  v_dot2_f32_bf16 v24, v65, v7, v24
  v_dot2_f32_bf16 v24, v66, v8, v24
  v_dot2_f32_bf16 v24, v67, v9, v24
  s_add_u32 s52, s54, 0
  buffer_load_dwordx4 v[64:67], v1, s[12:15], s52 offen offset:0 nt
  s_waitcnt vmcnt(11)
  v_dot2_f32_bf16 v25, v68, v6, 0
  v_dot2_f32_bf16 v25, v69, v7, v25
  v_dot2_f32_bf16 v25, v70, v8, v25
  v_dot2_f32_bf16 v25, v71, v9, v25
  s_add_u32 s52, s54, 0
  buffer_load_dwordx4 v[68:71], v1, s[12:15], s52 offen offset:1024 nt
  s_waitcnt vmcnt(11)
  v_dot2_f32_bf16 v26, v72, v6, 0
  v_dot2_f32_bf16 v26, v73, v7, v26
  v_dot2_f32_bf16 v26, v74, v8, v26
  v_dot2_f32_bf16 v26, v75, v9, v26
  s_add_u32 s52, s54, 0
  buffer_load_dwordx4 v[72:75], v1, s[12:15], s52 offen offset:2048 nt
  s_waitcnt vmcnt(11)
  v_dot2_f32_bf16 v27, v76, v6, 0
  v_dot2_f32_bf16 v27, v77, v7, v27
  v_dot2_f32_bf16 v27, v78, v8, v27
  v_dot2_f32_bf16 v27, v79, v9, v27
  s_add_u32 s52, s54, 0
  buffer_load_dwordx4 v[76:79], v1, s[12:15], s52 offen offset:3072 nt
  v_add_f32_dpp v24, v24, v24 row_ror:8 row_mask:0xf bank_mask:0xf
  v_add_f32_dpp v25, v25, v25 row_ror:8 row_mask:0xf bank_mask:0xf
  v_add_f32_dpp v26, v26, v26 row_ror:8 row_mask:0xf bank_mask:0xf
  v_add_f32_dpp v27, v27, v27 row_ror:8 row_mask:0xf bank_mask:0xf
  v_add_f32_dpp v24, v24, v24 row_ror:4 row_mask:0xf bank_mask:0xf
  v_add_f32_dpp v25, v25, v25 row_ror:4 row_mask:0xf bank_mask:0xf
  v_add_f32_dpp v26, v26, v26 row_ror:4 row_mask:0xf bank_mask:0xf
  v_add_f32_dpp v27, v27, v27 row_ror:4 row_mask:0xf bank_mask:0xf
  v_add_f32_dpp v24, v24, v24 row_ror:2 row_mask:0xf bank_mask:0xf
  v_add_f32_dpp v25, v25, v25 row_ror:2 row_mask:0xf bank_mask:0xf
  v_add_f32_dpp v26, v26, v26 row_ror:2 row_mask:0xf bank_mask:0xf
  v_add_f32_dpp v27, v27, v27 row_ror:2 row_mask:0xf bank_mask:0xf
  v_add_f32_dpp v24, v24, v24 row_ror:1 row_mask:0xf bank_mask:0xf
  v_add_f32_dpp v25, v25, v25 row_ror:1 row_mask:0xf bank_mask:0xf
  v_add_f32_dpp v26, v26, v26 row_ror:1 row_mask:0xf bank_mask:0xf
  v_add_f32_dpp v27, v27, v27 row_ror:1 row_mask:0xf bank_mask:0xf
  v_cvt_pk_bf16_f32 v28, v25, v24
  v_and_b32 v29, 0xffff0000, v28
  v_lshlrev_b32 v28, 16, v28
  v_mul_f32 v29, s55, v29
  v_mul_f32 v28, s55, v28
  v_max3_f32 v14, v14, v28, v29
  v_cvt_pk_bf16_f32 v37, v28, v29
  v_cvt_pk_bf16_f32 v30, v27, v26
  v_and_b32 v31, 0xffff0000, v30
  v_lshlrev_b32 v30, 16, v30
  v_mul_f32 v31, s55, v31
  v_mul_f32 v30, s55, v30
  v_max3_f32 v14, v14, v30, v31
  v_cvt_pk_bf16_f32 v36, v30, v31
  s_waitcnt vmcnt(11)
  v_dot2_f32_bf16 v24, v80, v6, 0
  v_dot2_f32_bf16 v24, v81, v7, v24
  v_dot2_f32_bf16 v24, v82, v8, v24
  v_dot2_f32_bf16 v24, v83, v9, v24
  s_add_u32 s52, s54, 4096
  buffer_load_dwordx4 v[80:83], v1, s[12:15], s52 offen offset:0 nt
  s_waitcnt vmcnt(11)
  v_dot2_f32_bf16 v25, v84, v6, 0
  v_dot2_f32_bf16 v25, v85, v7, v25
  v_dot2_f32_bf16 v25, v86, v8, v25
  v_dot2_f32_bf16 v25, v87, v9, v25
  s_add_u32 s52, s54, 4096
  buffer_load_dwordx4 v[84:87], v1, s[12:15], s52 offen offset:1024 nt
  s_waitcnt vmcnt(11)
  v_dot2_f32_bf16 v26, v88, v6, 0
  v_dot2_f32_bf16 v26, v89, v7, v26
  v_dot2_f32_bf16 v26, v90, v8, v26
  v_dot2_f32_bf16 v26, v91, v9, v26
  s_add_u32 s52, s54, 4096
  buffer_load_dwordx4 v[88:91], v1, s[12:15], s52 offen offset:2048 nt
  s_waitcnt vmcnt(11)
  v_dot2_f32_bf16 v27, v92, v6, 0
  v_dot2_f32_bf16 v27, v93, v7, v27
  v_dot2_f32_bf16 v27, v94, v8, v27
  v_dot2_f32_bf16 v27, v95, v9, v27
  s_add_u32 s52, s54, 4096
  buffer_load_dwordx4 v[92:95], v1, s[12:15], s52 offen offset:3072 nt
  v_add_f32_dpp v24, v24, v24 row_ror:8 row_mask:0xf bank_mask:0xf
  v_add_f32_dpp v25, v25, v25 row_ror:8 row_mask:0xf bank_mask:0xf
  v_add_f32_dpp v26, v26, v26 row_ror:8 row_mask:0xf bank_mask:0xf
  v_add_f32_dpp v27, v27, v27 row_ror:8 row_mask:0xf bank_mask:0xf
  v_add_f32_dpp v24, v24, v24 row_ror:4 row_mask:0xf bank_mask:0xf
  v_add_f32_dpp v25, v25, v25 row_ror:4 row_mask:0xf bank_mask:0xf
  v_add_f32_dpp v26, v26, v26 row_ror:4 row_mask:0xf bank_mask:0xf
  v_add_f32_dpp v27, v27, v27 row_ror:4 row_mask:0xf bank_mask:0xf
  v_add_f32_dpp v24, v24, v24 row_ror:2 row_mask:0xf bank_mask:0xf
  v_add_f32_dpp v25, v25, v25 row_ror:2 row_mask:0xf bank_mask:0xf
  v_add_f32_dpp v26, v26, v26 row_ror:2 row_mask:0xf bank_mask:0xf
  v_add_f32_dpp v27, v27, v27 row_ror:2 row_mask:0xf bank_mask:0xf
  v_add_f32_dpp v24, v24, v24 row_ror:1 row_mask:0xf bank_mask:0xf
  v_add_f32_dpp v25, v25, v25 row_ror:1 row_mask:0xf bank_mask:0xf
  v_add_f32_dpp v26, v26, v26 row_ror:1 row_mask:0xf bank_mask:0xf
  v_add_f32_dpp v27, v27, v27 row_ror:1 row_mask:0xf bank_mask:0xf
  v_cvt_pk_bf16_f32 v28, v25, v24
  v_and_b32 v29, 0xffff0000, v28
  v_lshlrev_b32 v28, 16, v28
  v_mul_f32 v29, s55, v29
  v_mul_f32 v28, s55, v28
  v_max3_f32 v14, v14, v28, v29
  v_cvt_pk_bf16_f32 v35, v28, v29
  v_cvt_pk_bf16_f32 v30, v27, v26
  v_and_b32 v31, 0xffff0000, v30
  v_lshlrev_b32 v30, 16, v30
  v_mul_f32 v31, s55, v31
  v_mul_f32 v30, s55, v30
  v_max3_f32 v14, v14, v30, v31
  v_cvt_pk_bf16_f32 v34, v30, v31
  s_waitcnt vmcnt(11)
  v_dot2_f32_bf16 v24, v96, v6, 0
  v_dot2_f32_bf16 v24, v97, v7, v24
  v_dot2_f32_bf16 v24, v98, v8, v24
  v_dot2_f32_bf16 v24, v99, v9, v24
  s_add_u32 s52, s54, 8192
  buffer_load_dwordx4 v[96:99], v1, s[12:15], s52 offen offset:0 nt
  s_waitcnt vmcnt(11)
  v_dot2_f32_bf16 v25, v52, v6, 0
  v_dot2_f32_bf16 v25, v53, v7, v25
  v_dot2_f32_bf16 v25, v54, v8, v25
  v_dot2_f32_bf16 v25, v55, v9, v25
  s_add_u32 s52, s54, 8192
  buffer_load_dwordx4 v[52:55], v1, s[12:15], s52 offen offset:1024 nt
  s_waitcnt vmcnt(11)
  v_dot2_f32_bf16 v26, v56, v6, 0
  v_dot2_f32_bf16 v26, v57, v7, v26
  v_dot2_f32_bf16 v26, v58, v8, v26
  v_dot2_f32_bf16 v26, v59, v9, v26
  s_add_u32 s52, s54, 8192
  buffer_load_dwordx4 v[56:59], v1, s[12:15], s52 offen offset:2048 nt
  s_waitcnt vmcnt(11)
  v_dot2_f32_bf16 v27, v60, v6, 0
  v_dot2_f32_bf16 v27, v61, v7, v27
  v_dot2_f32_bf16 v27, v62, v8, v27
  v_dot2_f32_bf16 v27, v63, v9, v27
  s_add_u32 s52, s54, 8192
  buffer_load_dwordx4 v[60:63], v1, s[12:15], s52 offen offset:3072 nt
  v_add_f32_dpp v24, v24, v24 row_ror:8 row_mask:0xf bank_mask:0xf
  v_add_f32_dpp v25, v25, v25 row_ror:8 row_mask:0xf bank_mask:0xf
  v_add_f32_dpp v26, v26, v26 row_ror:8 row_mask:0xf bank_mask:0xf
  v_add_f32_dpp v27, v27, v27 row_ror:8 row_mask:0xf bank_mask:0xf
  v_add_f32_dpp v24, v24, v24 row_ror:4 row_mask:0xf bank_mask:0xf
  v_add_f32_dpp v25, v25, v25 row_ror:4 row_mask:0xf bank_mask:0xf
  v_add_f32_dpp v26, v26, v26 row_ror:4 row_mask:0xf bank_mask:0xf
  v_add_f32_dpp v27, v27, v27 row_ror:4 row_mask:0xf bank_mask:0xf
  v_add_f32_dpp v24, v24, v24 row_ror:2 row_mask:0xf bank_mask:0xf
  v_add_f32_dpp v25, v25, v25 row_ror:2 row_mask:0xf bank_mask:0xf
  v_add_f32_dpp v26, v26, v26 row_ror:2 row_mask:0xf bank_mask:0xf
  v_add_f32_dpp v27, v27, v27 row_ror:2 row_mask:0xf bank_mask:0xf
  v_add_f32_dpp v24, v24, v24 row_ror:1 row_mask:0xf bank_mask:0xf
  v_add_f32_dpp v25, v25, v25 row_ror:1 row_mask:0xf bank_mask:0xf
  v_add_f32_dpp v26, v26, v26 row_ror:1 row_mask:0xf bank_mask:0xf
  v_add_f32_dpp v27, v27, v27 row_ror:1 row_mask:0xf bank_mask:0xf
  v_cvt_pk_bf16_f32 v28, v25, v24
  v_and_b32 v29, 0xffff0000, v28
  v_lshlrev_b32 v28, 16, v28
  v_mul_f32 v29, s55, v29
  v_mul_f32 v28, s55, v28
  v_max3_f32 v14, v14, v28, v29
  v_cvt_pk_bf16_f32 v33, v28, v29
  v_cvt_pk_bf16_f32 v30, v27, v26
  v_and_b32 v31, 0xffff0000, v30
  v_lshlrev_b32 v30, 16, v30
  v_mul_f32 v31, s55, v31
  v_mul_f32 v30, s55, v30
  v_max3_f32 v14, v14, v30, v31
  v_cvt_pk_bf16_f32 v32, v30, v31
  v_mov_b32 v24, v14
  s_nop 1
  v_permlane16_swap_b32 v14, v24
  v_max_f32 v14, v14, v24
  v_mov_b32 v24, v14
  s_nop 1
  v_permlane32_swap_b32 v14, v24
  v_max_f32 v14, v14, v24
  v_cvt_pk_bf16_f32 v14, v14, v14
  v_and_b32 v14, 0xffff0000, v14
  v_mov_b32 v15, 0
  v_lshlrev_b32 v24, 16, v48
  v_and_b32 v25, 0xffff0000, v47
  v_lshlrev_b32 v26, 16, v47
  v_and_b32 v27, 0xffff0000, v46
  v_sub_f32 v24, v24, v14
  v_sub_f32 v25, v25, v14
  v_sub_f32 v26, v26, v14
  v_sub_f32 v27, v27, v14
  v_mul_f32 v24, s56, v24
  v_mul_f32 v25, s56, v25
  v_mul_f32 v26, s56, v26
  v_mul_f32 v27, s56, v27
  v_exp_f32 v24, v24
  v_exp_f32 v25, v25
  v_exp_f32 v26, v26
  v_exp_f32 v27, v27
  v_add_f32 v15, v15, v24
  v_add_f32 v15, v15, v25
  v_add_f32 v15, v15, v26
  v_add_f32 v15, v15, v27
  v_lshlrev_b32 v24, 16, v46
  v_and_b32 v25, 0xffff0000, v45
  v_lshlrev_b32 v26, 16, v45
  v_and_b32 v27, 0xffff0000, v44
  v_sub_f32 v24, v24, v14
  v_sub_f32 v25, v25, v14
  v_sub_f32 v26, v26, v14
  v_sub_f32 v27, v27, v14
  v_mul_f32 v24, s56, v24
  v_mul_f32 v25, s56, v25
  v_mul_f32 v26, s56, v26
  v_mul_f32 v27, s56, v27
  v_exp_f32 v24, v24
  v_exp_f32 v25, v25
  v_exp_f32 v26, v26
  v_exp_f32 v27, v27
  v_add_f32 v15, v15, v24
  v_add_f32 v15, v15, v25
  v_add_f32 v15, v15, v26
  v_add_f32 v15, v15, v27
  v_lshlrev_b32 v24, 16, v44
  v_and_b32 v25, 0xffff0000, v43
  v_lshlrev_b32 v26, 16, v43
  v_and_b32 v27, 0xffff0000, v42
  v_sub_f32 v24, v24, v14
  v_sub_f32 v25, v25, v14
  v_sub_f32 v26, v26, v14
  v_sub_f32 v27, v27, v14
  v_mul_f32 v24, s56, v24
  v_mul_f32 v25, s56, v25
  v_mul_f32 v26, s56, v26
  v_mul_f32 v27, s56, v27
  v_exp_f32 v24, v24
  v_exp_f32 v25, v25
  v_exp_f32 v26, v26
  v_exp_f32 v27, v27
  v_add_f32 v15, v15, v24
  v_add_f32 v15, v15, v25
  v_add_f32 v15, v15, v26
  v_add_f32 v15, v15, v27
  v_lshlrev_b32 v24, 16, v42
  v_and_b32 v25, 0xffff0000, v41
  v_lshlrev_b32 v26, 16, v41
  v_and_b32 v27, 0xffff0000, v40
  v_sub_f32 v24, v24, v14
  v_sub_f32 v25, v25, v14
  v_sub_f32 v26, v26, v14
  v_sub_f32 v27, v27, v14
  v_mul_f32 v24, s56, v24
  v_mul_f32 v25, s56, v25
  v_mul_f32 v26, s56, v26
  v_mul_f32 v27, s56, v27
  v_exp_f32 v24, v24
  v_exp_f32 v25, v25
  v_exp_f32 v26, v26
  v_exp_f32 v27, v27
  v_add_f32 v15, v15, v24
  v_add_f32 v15, v15, v25
  v_add_f32 v15, v15, v26
  v_add_f32 v15, v15, v27
  v_lshlrev_b32 v24, 16, v40
  v_and_b32 v25, 0xffff0000, v39
  v_lshlrev_b32 v26, 16, v39
  v_and_b32 v27, 0xffff0000, v38
  v_sub_f32 v24, v24, v14
  v_sub_f32 v25, v25, v14
  v_sub_f32 v26, v26, v14
  v_sub_f32 v27, v27, v14
  v_mul_f32 v24, s56, v24
  v_mul_f32 v25, s56, v25
  v_mul_f32 v26, s56, v26
  v_mul_f32 v27, s56, v27
  v_exp_f32 v24, v24
  v_exp_f32 v25, v25
  v_exp_f32 v26, v26
  v_exp_f32 v27, v27
  v_add_f32 v15, v15, v24
  v_add_f32 v15, v15, v25
  v_add_f32 v15, v15, v26
  v_add_f32 v15, v15, v27
  v_lshlrev_b32 v24, 16, v38
  v_and_b32 v25, 0xffff0000, v37
  v_lshlrev_b32 v26, 16, v37
  v_and_b32 v27, 0xffff0000, v36
  v_sub_f32 v24, v24, v14
  v_sub_f32 v25, v25, v14
  v_sub_f32 v26, v26, v14
  v_sub_f32 v27, v27, v14
  v_mul_f32 v24, s56, v24
  v_mul_f32 v25, s56, v25
  v_mul_f32 v26, s56, v26
  v_mul_f32 v27, s56, v27
  v_exp_f32 v24, v24
  v_exp_f32 v25, v25
  v_exp_f32 v26, v26
  v_exp_f32 v27, v27
  v_add_f32 v15, v15, v24
  v_add_f32 v15, v15, v25
  v_add_f32 v15, v15, v26
  v_add_f32 v15, v15, v27
  v_lshlrev_b32 v24, 16, v36
  v_and_b32 v25, 0xffff0000, v35
  v_lshlrev_b32 v26, 16, v35
  v_and_b32 v27, 0xffff0000, v34
  v_sub_f32 v24, v24, v14
  v_sub_f32 v25, v25, v14
  v_sub_f32 v26, v26, v14
  v_sub_f32 v27, v27, v14
  v_mul_f32 v24, s56, v24
  v_mul_f32 v25, s56, v25
  v_mul_f32 v26, s56, v26
  v_mul_f32 v27, s56, v27
  v_exp_f32 v24, v24
  v_exp_f32 v25, v25
  v_exp_f32 v26, v26
  v_exp_f32 v27, v27
  v_add_f32 v15, v15, v24
  v_add_f32 v15, v15, v25
  v_add_f32 v15, v15, v26
  v_add_f32 v15, v15, v27
  v_lshlrev_b32 v24, 16, v34
  v_and_b32 v25, 0xffff0000, v33
  v_lshlrev_b32 v26, 16, v33
  v_and_b32 v27, 0xffff0000, v32
  v_sub_f32 v24, v24, v14
  v_sub_f32 v25, v25, v14
  v_sub_f32 v26, v26, v14
  v_sub_f32 v27, v27, v14
  v_mul_f32 v24, s56, v24
  v_mul_f32 v25, s56, v25
  v_mul_f32 v26, s56, v26
  v_mul_f32 v27, s56, v27
  v_exp_f32 v24, v24
  v_exp_f32 v25, v25
  v_exp_f32 v26, v26
  v_exp_f32 v27, v27
  v_add_f32 v15, v15, v24
  v_add_f32 v15, v15, v25
  v_add_f32 v15, v15, v26
  v_add_f32 v15, v15, v27
  v_lshlrev_b32 v24, 16, v32
  v_sub_f32 v24, v24, v14
  v_mul_f32 v24, s56, v24
  v_exp_f32 v24, v24
  s_nop 0
  v_add_f32 v15, v15, v24
  v_mov_b32 v24, v15
  s_nop 1
  v_permlane16_swap_b32 v15, v24
  v_add_f32 v15, v15, v24
  v_mov_b32 v24, v15
  s_nop 1
  v_permlane32_swap_b32 v15, v24
  v_add_f32 v15, v15, v24
  v_min_u32 v15, 0xfffffffe, v15
  s_mov_b64 exec, 1
  buffer_store_dwordx2 v[14:15], off, s[48:51], s67 sc1
  s_lshl_b32 s52, s3, 3
  v_mov_b32 v24, s52
  ds_write_b64 v24, v[14:15] offset:2880
  s_mov_b64 exec, -1
  s_waitcnt lgkmcnt(0)
  v_mov_b32 v24, 1
  v_mov_b32 v25, 2828
  s_mov_b64 exec, 1
  ds_add_u32 v25, v24
  s_mov_b64 exec, -1
  v_lshlrev_b32 v24, 16, v48
  v_sub_f32 v24, v24, v14
  v_mul_f32 v24, s56, v24
  v_exp_f32 v24, v24
  s_nop 0
  v_cvt_pk_bf16_f32 v25, v24, v24
  v_and_b32 v25, 0xffff0000, v25
  v_sub_f32 v25, v24, v25
  v_cndmask_b32 v24, v24, v25, s[58:59]
  v_cvt_pk_bf16_f32 v24, v24, v24
  v_and_b32 v16, v24, v2
  v_and_b32 v17, v24, v3
  v_and_b32 v18, v24, v4
  v_and_b32 v19, v24, v5
  v_and_b32 v24, 0xffff0000, v47
  v_sub_f32 v24, v24, v14
  v_mul_f32 v24, s56, v24
  v_exp_f32 v24, v24
  s_nop 0
  v_cvt_pk_bf16_f32 v25, v24, v24
  v_and_b32 v25, 0xffff0000, v25
  v_sub_f32 v25, v24, v25
  v_cndmask_b32 v24, v24, v25, s[58:59]
  v_cvt_pk_bf16_f32 v24, v24, v24
  v_and_b32 v20, v24, v2
  v_and_b32 v21, v24, v3
  v_and_b32 v22, v24, v4
  v_and_b32 v23, v24, v5
  s_waitcnt vmcnt(12)
  v_mfma_f32_16x16x32_bf16 v[10:13], v[16:19], v[64:67], v[10:13]
  s_add_u32 s52, s54, 12288
  buffer_load_dwordx4 v[64:67], v1, s[12:15], s52 offen offset:0 nt
  v_lshlrev_b32 v24, 16, v47
  v_sub_f32 v24, v24, v14
  v_mul_f32 v24, s56, v24
  v_exp_f32 v24, v24
  s_nop 0
  v_cvt_pk_bf16_f32 v25, v24, v24
  v_and_b32 v25, 0xffff0000, v25
  v_sub_f32 v25, v24, v25
  v_cndmask_b32 v24, v24, v25, s[58:59]
  v_cvt_pk_bf16_f32 v24, v24, v24
  v_and_b32 v16, v24, v2
  v_and_b32 v17, v24, v3
  v_and_b32 v18, v24, v4
  v_and_b32 v19, v24, v5
  s_waitcnt vmcnt(12)
  v_mfma_f32_16x16x32_bf16 v[10:13], v[20:23], v[68:71], v[10:13]
  s_add_u32 s52, s54, 12288
  buffer_load_dwordx4 v[68:71], v1, s[12:15], s52 offen offset:1024 nt
  v_and_b32 v24, 0xffff0000, v46
  v_sub_f32 v24, v24, v14
  v_mul_f32 v24, s56, v24
  v_exp_f32 v24, v24
  s_nop 0
  v_cvt_pk_bf16_f32 v25, v24, v24
  v_and_b32 v25, 0xffff0000, v25
  v_sub_f32 v25, v24, v25
  v_cndmask_b32 v24, v24, v25, s[58:59]
  v_cvt_pk_bf16_f32 v24, v24, v24
  v_and_b32 v20, v24, v2
  v_and_b32 v21, v24, v3
  v_and_b32 v22, v24, v4
  v_and_b32 v23, v24, v5
  s_waitcnt vmcnt(12)
  v_mfma_f32_16x16x32_bf16 v[10:13], v[16:19], v[72:75], v[10:13]
  s_add_u32 s52, s54, 12288
  buffer_load_dwordx4 v[72:75], v1, s[12:15], s52 offen offset:2048 nt
  v_lshlrev_b32 v24, 16, v46
  v_sub_f32 v24, v24, v14
  v_mul_f32 v24, s56, v24
  v_exp_f32 v24, v24
  s_nop 0
  v_cvt_pk_bf16_f32 v25, v24, v24
  v_and_b32 v25, 0xffff0000, v25
  v_sub_f32 v25, v24, v25
  v_cndmask_b32 v24, v24, v25, s[58:59]
  v_cvt_pk_bf16_f32 v24, v24, v24
  v_and_b32 v16, v24, v2
  v_and_b32 v17, v24, v3
  v_and_b32 v18, v24, v4
  v_and_b32 v19, v24, v5
  s_waitcnt vmcnt(12)
  v_mfma_f32_16x16x32_bf16 v[10:13], v[20:23], v[76:79], v[10:13]
  s_add_u32 s52, s54, 12288
  buffer_load_dwordx4 v[76:79], v1, s[12:15], s52 offen offset:3072 nt
  v_and_b32 v24, 0xffff0000, v45
  v_sub_f32 v24, v24, v14
  v_mul_f32 v24, s56, v24
  v_exp_f32 v24, v24
  s_nop 0
  v_cvt_pk_bf16_f32 v25, v24, v24
  v_and_b32 v25, 0xffff0000, v25
  v_sub_f32 v25, v24, v25
  v_cndmask_b32 v24, v24, v25, s[58:59]
  v_cvt_pk_bf16_f32 v24, v24, v24
  v_and_b32 v20, v24, v2
  v_and_b32 v21, v24, v3
  v_and_b32 v22, v24, v4
  v_and_b32 v23, v24, v5
  s_waitcnt vmcnt(12)
  v_mfma_f32_16x16x32_bf16 v[10:13], v[16:19], v[80:83], v[10:13]
  s_add_u32 s52, s54, 16384
  buffer_load_dwordx4 v[80:83], v1, s[12:15], s52 offen offset:0 nt
  v_lshlrev_b32 v24, 16, v45
  v_sub_f32 v24, v24, v14
  v_mul_f32 v24, s56, v24
  v_exp_f32 v24, v24
  s_nop 0
  v_cvt_pk_bf16_f32 v25, v24, v24
  v_and_b32 v25, 0xffff0000, v25
  v_sub_f32 v25, v24, v25
  v_cndmask_b32 v24, v24, v25, s[58:59]
  v_cvt_pk_bf16_f32 v24, v24, v24
  v_and_b32 v16, v24, v2
  v_and_b32 v17, v24, v3
  v_and_b32 v18, v24, v4
  v_and_b32 v19, v24, v5
  s_waitcnt vmcnt(12)
  v_mfma_f32_16x16x32_bf16 v[10:13], v[20:23], v[84:87], v[10:13]
  s_add_u32 s52, s54, 16384
  buffer_load_dwordx4 v[84:87], v1, s[12:15], s52 offen offset:1024 nt
  v_and_b32 v24, 0xffff0000, v44
  v_sub_f32 v24, v24, v14
  v_mul_f32 v24, s56, v24
  v_exp_f32 v24, v24
  s_nop 0
  v_cvt_pk_bf16_f32 v25, v24, v24
  v_and_b32 v25, 0xffff0000, v25
  v_sub_f32 v25, v24, v25
  v_cndmask_b32 v24, v24, v25, s[58:59]
  v_cvt_pk_bf16_f32 v24, v24, v24
  v_and_b32 v20, v24, v2
  v_and_b32 v21, v24, v3
  v_and_b32 v22, v24, v4
  v_and_b32 v23, v24, v5
  s_waitcnt vmcnt(12)
  v_mfma_f32_16x16x32_bf16 v[10:13], v[16:19], v[88:91], v[10:13]
  s_add_u32 s52, s54, 16384
  buffer_load_dwordx4 v[88:91], v1, s[12:15], s52 offen offset:2048 nt
  v_lshlrev_b32 v24, 16, v44
  v_sub_f32 v24, v24, v14
  v_mul_f32 v24, s56, v24
  v_exp_f32 v24, v24
  s_nop 0
  v_cvt_pk_bf16_f32 v25, v24, v24
  v_and_b32 v25, 0xffff0000, v25
  v_sub_f32 v25, v24, v25
  v_cndmask_b32 v24, v24, v25, s[58:59]
  v_cvt_pk_bf16_f32 v24, v24, v24
  v_and_b32 v16, v24, v2
  v_and_b32 v17, v24, v3
  v_and_b32 v18, v24, v4
  v_and_b32 v19, v24, v5
  s_waitcnt vmcnt(12)
  v_mfma_f32_16x16x32_bf16 v[10:13], v[20:23], v[92:95], v[10:13]
  s_add_u32 s52, s54, 16384
  buffer_load_dwordx4 v[92:95], v1, s[12:15], s52 offen offset:3072 nt
  v_and_b32 v24, 0xffff0000, v43
  v_sub_f32 v24, v24, v14
  v_mul_f32 v24, s56, v24
  v_exp_f32 v24, v24
  s_nop 0
  v_cvt_pk_bf16_f32 v25, v24, v24
  v_and_b32 v25, 0xffff0000, v25
  v_sub_f32 v25, v24, v25
  v_cndmask_b32 v24, v24, v25, s[58:59]
  v_cvt_pk_bf16_f32 v24, v24, v24
  v_and_b32 v20, v24, v2
  v_and_b32 v21, v24, v3
  v_and_b32 v22, v24, v4
  v_and_b32 v23, v24, v5
  s_waitcnt vmcnt(12)
  v_mfma_f32_16x16x32_bf16 v[10:13], v[16:19], v[96:99], v[10:13]
  s_add_u32 s52, s54, 20480
  buffer_load_dwordx4 v[96:99], v1, s[12:15], s52 offen offset:0 nt
  v_lshlrev_b32 v24, 16, v43
  v_sub_f32 v24, v24, v14
  v_mul_f32 v24, s56, v24
  v_exp_f32 v24, v24
  s_nop 0
  v_cvt_pk_bf16_f32 v25, v24, v24
  v_and_b32 v25, 0xffff0000, v25
  v_sub_f32 v25, v24, v25
  v_cndmask_b32 v24, v24, v25, s[58:59]
  v_cvt_pk_bf16_f32 v24, v24, v24
  v_and_b32 v16, v24, v2
  v_and_b32 v17, v24, v3
  v_and_b32 v18, v24, v4
  v_and_b32 v19, v24, v5
  s_waitcnt vmcnt(12)
  v_mfma_f32_16x16x32_bf16 v[10:13], v[20:23], v[52:55], v[10:13]
  s_add_u32 s52, s54, 20480
  buffer_load_dwordx4 v[52:55], v1, s[12:15], s52 offen offset:1024 nt
  v_and_b32 v24, 0xffff0000, v42
  v_sub_f32 v24, v24, v14
  v_mul_f32 v24, s56, v24
  v_exp_f32 v24, v24
  s_nop 0
  v_cvt_pk_bf16_f32 v25, v24, v24
  v_and_b32 v25, 0xffff0000, v25
  v_sub_f32 v25, v24, v25
  v_cndmask_b32 v24, v24, v25, s[58:59]
  v_cvt_pk_bf16_f32 v24, v24, v24
  v_and_b32 v20, v24, v2
  v_and_b32 v21, v24, v3
  v_and_b32 v22, v24, v4
  v_and_b32 v23, v24, v5
  s_waitcnt vmcnt(12)
  v_mfma_f32_16x16x32_bf16 v[10:13], v[16:19], v[56:59], v[10:13]
  s_add_u32 s52, s54, 20480
  buffer_load_dwordx4 v[56:59], v1, s[12:15], s52 offen offset:2048 nt
  v_lshlrev_b32 v24, 16, v42
  v_sub_f32 v24, v24, v14
  v_mul_f32 v24, s56, v24
  v_exp_f32 v24, v24
  s_nop 0
  v_cvt_pk_bf16_f32 v25, v24, v24
  v_and_b32 v25, 0xffff0000, v25
  v_sub_f32 v25, v24, v25
  v_cndmask_b32 v24, v24, v25, s[58:59]
  v_cvt_pk_bf16_f32 v24, v24, v24
  v_and_b32 v16, v24, v2
  v_and_b32 v17, v24, v3
  v_and_b32 v18, v24, v4
  v_and_b32 v19, v24, v5
  s_waitcnt vmcnt(12)
  v_mfma_f32_16x16x32_bf16 v[10:13], v[20:23], v[60:63], v[10:13]
  s_add_u32 s52, s54, 20480
  buffer_load_dwordx4 v[60:63], v1, s[12:15], s52 offen offset:3072 nt
  v_and_b32 v24, 0xffff0000, v41
  v_sub_f32 v24, v24, v14
  v_mul_f32 v24, s56, v24
  v_exp_f32 v24, v24
  s_nop 0
  v_cvt_pk_bf16_f32 v25, v24, v24
  v_and_b32 v25, 0xffff0000, v25
  v_sub_f32 v25, v24, v25
  v_cndmask_b32 v24, v24, v25, s[58:59]
  v_cvt_pk_bf16_f32 v24, v24, v24
  v_and_b32 v20, v24, v2
  v_and_b32 v21, v24, v3
  v_and_b32 v22, v24, v4
  v_and_b32 v23, v24, v5
  s_waitcnt vmcnt(11)
  v_mfma_f32_16x16x32_bf16 v[10:13], v[16:19], v[64:67], v[10:13]
  s_add_u32 s52, s54, 24576
  buffer_load_dwordx4 v[64:67], v1, s[12:15], s52 offen offset:0 nt
  v_lshlrev_b32 v24, 16, v41
  v_sub_f32 v24, v24, v14
  v_mul_f32 v24, s56, v24
  v_exp_f32 v24, v24
  s_nop 0
  v_cvt_pk_bf16_f32 v25, v24, v24
  v_and_b32 v25, 0xffff0000, v25
  v_sub_f32 v25, v24, v25
  v_cndmask_b32 v24, v24, v25, s[58:59]
  v_cvt_pk_bf16_f32 v24, v24, v24
  v_and_b32 v16, v24, v2
  v_and_b32 v17, v24, v3
  v_and_b32 v18, v24, v4
  v_and_b32 v19, v24, v5
  s_waitcnt vmcnt(11)
  v_mfma_f32_16x16x32_bf16 v[10:13], v[20:23], v[68:71], v[10:13]
  s_add_u32 s52, s54, 24576
  buffer_load_dwordx4 v[68:71], v1, s[12:15], s52 offen offset:1024 nt
  v_and_b32 v24, 0xffff0000, v40
  v_sub_f32 v24, v24, v14
  v_mul_f32 v24, s56, v24
  v_exp_f32 v24, v24
  s_nop 0
  v_cvt_pk_bf16_f32 v25, v24, v24
  v_and_b32 v25, 0xffff0000, v25
  v_sub_f32 v25, v24, v25
  v_cndmask_b32 v24, v24, v25, s[58:59]
  v_cvt_pk_bf16_f32 v24, v24, v24
  v_and_b32 v20, v24, v2
  v_and_b32 v21, v24, v3
  v_and_b32 v22, v24, v4
  v_and_b32 v23, v24, v5
  s_waitcnt vmcnt(11)
  v_mfma_f32_16x16x32_bf16 v[10:13], v[16:19], v[72:75], v[10:13]
  s_add_u32 s52, s54, 24576
  buffer_load_dwordx4 v[72:75], v1, s[12:15], s52 offen offset:2048 nt
  v_lshlrev_b32 v24, 16, v40
  v_sub_f32 v24, v24, v14
  v_mul_f32 v24, s56, v24
  v_exp_f32 v24, v24
  s_nop 0
  v_cvt_pk_bf16_f32 v25, v24, v24
  v_and_b32 v25, 0xffff0000, v25
  v_sub_f32 v25, v24, v25
  v_cndmask_b32 v24, v24, v25, s[58:59]
  v_cvt_pk_bf16_f32 v24, v24, v24
  v_and_b32 v16, v24, v2
  v_and_b32 v17, v24, v3
  v_and_b32 v18, v24, v4
  v_and_b32 v19, v24, v5
  s_waitcnt vmcnt(11)
  v_mfma_f32_16x16x32_bf16 v[10:13], v[20:23], v[76:79], v[10:13]
  s_add_u32 s52, s54, 24576
  buffer_load_dwordx4 v[76:79], v1, s[12:15], s52 offen offset:3072 nt
  v_and_b32 v24, 0xffff0000, v39
  v_sub_f32 v24, v24, v14
  v_mul_f32 v24, s56, v24
  v_exp_f32 v24, v24
  s_nop 0
  v_cvt_pk_bf16_f32 v25, v24, v24
  v_and_b32 v25, 0xffff0000, v25
  v_sub_f32 v25, v24, v25
  v_cndmask_b32 v24, v24, v25, s[58:59]
  v_cvt_pk_bf16_f32 v24, v24, v24
  v_and_b32 v20, v24, v2
  v_and_b32 v21, v24, v3
  v_and_b32 v22, v24, v4
  v_and_b32 v23, v24, v5
  s_waitcnt vmcnt(11)
  v_mfma_f32_16x16x32_bf16 v[10:13], v[16:19], v[80:83], v[10:13]
  s_add_u32 s52, s54, 28672
  buffer_load_dwordx4 v[80:83], v1, s[12:15], s52 offen offset:0 nt
  v_lshlrev_b32 v24, 16, v39
  v_sub_f32 v24, v24, v14
  v_mul_f32 v24, s56, v24
  v_exp_f32 v24, v24
  s_nop 0
  v_cvt_pk_bf16_f32 v25, v24, v24
  v_and_b32 v25, 0xffff0000, v25
  v_sub_f32 v25, v24, v25
  v_cndmask_b32 v24, v24, v25, s[58:59]
  v_cvt_pk_bf16_f32 v24, v24, v24
  v_and_b32 v16, v24, v2
  v_and_b32 v17, v24, v3
  v_and_b32 v18, v24, v4
  v_and_b32 v19, v24, v5
  s_waitcnt vmcnt(11)
  v_mfma_f32_16x16x32_bf16 v[10:13], v[20:23], v[84:87], v[10:13]
  s_add_u32 s52, s54, 28672
  buffer_load_dwordx4 v[84:87], v1, s[12:15], s52 offen offset:1024 nt
  v_and_b32 v24, 0xffff0000, v38
  v_sub_f32 v24, v24, v14
  v_mul_f32 v24, s56, v24
  v_exp_f32 v24, v24
  s_nop 0
  v_cvt_pk_bf16_f32 v25, v24, v24
  v_and_b32 v25, 0xffff0000, v25
  v_sub_f32 v25, v24, v25
  v_cndmask_b32 v24, v24, v25, s[58:59]
  v_cvt_pk_bf16_f32 v24, v24, v24
  v_and_b32 v20, v24, v2
  v_and_b32 v21, v24, v3
  v_and_b32 v22, v24, v4
  v_and_b32 v23, v24, v5
  s_waitcnt vmcnt(11)
  v_mfma_f32_16x16x32_bf16 v[10:13], v[16:19], v[88:91], v[10:13]
  s_add_u32 s52, s54, 28672
  buffer_load_dwordx4 v[88:91], v1, s[12:15], s52 offen offset:2048 nt
  v_lshlrev_b32 v24, 16, v38
  v_sub_f32 v24, v24, v14
  v_mul_f32 v24, s56, v24
  v_exp_f32 v24, v24
  s_nop 0
  v_cvt_pk_bf16_f32 v25, v24, v24
  v_and_b32 v25, 0xffff0000, v25
  v_sub_f32 v25, v24, v25
  v_cndmask_b32 v24, v24, v25, s[58:59]
  v_cvt_pk_bf16_f32 v24, v24, v24
  v_and_b32 v16, v24, v2
  v_and_b32 v17, v24, v3
  v_and_b32 v18, v24, v4
  v_and_b32 v19, v24, v5
  s_waitcnt vmcnt(11)
  v_mfma_f32_16x16x32_bf16 v[10:13], v[20:23], v[92:95], v[10:13]
  s_add_u32 s52, s54, 28672
  buffer_load_dwordx4 v[92:95], v1, s[12:15], s52 offen offset:3072 nt
  v_and_b32 v24, 0xffff0000, v37
  v_sub_f32 v24, v24, v14
  v_mul_f32 v24, s56, v24
  v_exp_f32 v24, v24
  s_nop 0
  v_cvt_pk_bf16_f32 v25, v24, v24
  v_and_b32 v25, 0xffff0000, v25
  v_sub_f32 v25, v24, v25
  v_cndmask_b32 v24, v24, v25, s[58:59]
  v_cvt_pk_bf16_f32 v24, v24, v24
  v_and_b32 v20, v24, v2
  v_and_b32 v21, v24, v3
  v_and_b32 v22, v24, v4
  v_and_b32 v23, v24, v5
  s_waitcnt vmcnt(11)
  v_mfma_f32_16x16x32_bf16 v[10:13], v[16:19], v[96:99], v[10:13]
  s_add_u32 s52, s54, 32768
  buffer_load_dwordx4 v[96:99], v1, s[12:15], s52 offen offset:0 nt
  s_nop 5
  s_branch L_final
L_path1:
  s_add_u32 s52, s73, 0
  buffer_load_dwordx4 v[72:75], v23, s[16:19], s52 offen
  s_add_u32 s52, s73, 32768
  buffer_load_dwordx4 v[76:79], v23, s[16:19], s52 offen
  s_add_u32 s52, s73, 65536
  buffer_load_dwordx4 v[80:83], v23, s[16:19], s52 offen
  s_add_u32 s52, s73, 98304
  buffer_load_dwordx4 v[84:87], v23, s[16:19], s52 offen
  s_add_u32 s52, s73, 131072
  buffer_load_dwordx4 v[88:91], v23, s[16:19], s52 offen
  s_waitcnt vmcnt(5)
  v_dot2_f32_bf16 v29, v24, s57, 0
  v_dot2_f32_bf16 v29, v25, s57, v29
  v_dot2_f32_bf16 v29, v26, s57, v29
  v_dot2_f32_bf16 v29, v27, s57, v29
  v_dot2_f32_bf16 v29, v28, s57, v29
  v_lshlrev_b32 v42, 16, v24
  v_and_b32 v43, 0xffff0000, v24
  v_lshlrev_b32 v44, 16, v25
  v_and_b32 v45, 0xffff0000, v25
  v_lshlrev_b32 v46, 16, v26
  v_and_b32 v47, 0xffff0000, v26
  v_lshlrev_b32 v48, 16, v27
  v_and_b32 v49, 0xffff0000, v27
  v_lshlrev_b32 v50, 16, v28
  v_and_b32 v51, 0xffff0000, v28
  v_add_f32_dpp v29, v29, v29 row_ror:8 row_mask:0xf bank_mask:0xf
  s_nop 1
  v_add_f32_dpp v29, v29, v29 row_ror:4 row_mask:0xf bank_mask:0xf
  s_nop 1
  v_add_f32_dpp v29, v29, v29 row_ror:2 row_mask:0xf bank_mask:0xf
  s_nop 1
  v_add_f32_dpp v29, v29, v29 row_ror:1 row_mask:0xf bank_mask:0xf
  v_mov_b32 v30, v29
  s_nop 1
  v_permlane16_swap_b32 v29, v30
  v_add_f32 v29, v29, v30
  v_mov_b32 v30, v29
  s_nop 1
  v_permlane32_swap_b32 v29, v30
  v_add_f32 v29, v29, v30
  v_mul_f32 v29, 0x3acccccd, v29
  v_cvt_pk_bf16_f32 v30, v29, v29
  v_and_b32 v30, 0xffff0000, v30
  v_sub_f32 v29, v29, v30
  v_sub_f32 v42, v42, v30
  v_sub_f32 v43, v43, v30
  v_sub_f32 v44, v44, v30
  v_sub_f32 v45, v45, v30
  v_sub_f32 v46, v46, v30
  v_sub_f32 v47, v47, v30
  v_sub_f32 v48, v48, v30
  v_sub_f32 v49, v49, v30
  v_sub_f32 v50, v50, v30
  v_sub_f32 v51, v51, v30
  v_mul_f32 v31, v42, v42
  v_mul_f32 v41, v43, v43
  v_fmac_f32 v31, v44, v44
  v_fmac_f32 v41, v45, v45
  v_fmac_f32 v31, v46, v46
  v_fmac_f32 v41, v47, v47
  v_fmac_f32 v31, v48, v48
  v_fmac_f32 v41, v49, v49
  v_fmac_f32 v31, v50, v50
  v_fmac_f32 v41, v51, v51
  v_add_f32 v31, v31, v41
  v_cvt_pk_bf16_f32 v24, v42, v43
  v_cvt_pk_bf16_f32 v25, v44, v45
  v_cvt_pk_bf16_f32 v26, v46, v47
  v_cvt_pk_bf16_f32 v27, v48, v49
  v_cvt_pk_bf16_f32 v28, v50, v51
  v_add_f32_dpp v31, v31, v31 row_ror:8 row_mask:0xf bank_mask:0xf
  s_nop 1
  v_add_f32_dpp v31, v31, v31 row_ror:4 row_mask:0xf bank_mask:0xf
  s_nop 1
  v_add_f32_dpp v31, v31, v31 row_ror:2 row_mask:0xf bank_mask:0xf
  s_nop 1
  v_add_f32_dpp v31, v31, v31 row_ror:1 row_mask:0xf bank_mask:0xf
  v_mov_b32 v30, v31
  s_nop 1
  v_permlane16_swap_b32 v31, v30
  v_add_f32 v31, v31, v30
  v_mov_b32 v30, v31
  s_nop 1
  v_permlane32_swap_b32 v31, v30
  v_add_f32 v31, v31, v30
  v_mul_f32 v31, 0x3acccccd, v31
  v_fma_f32 v31, -v29, v29, v31
  v_max_f32 v31, 0, v31
  v_cvt_pk_bf16_f32 v31, v31, v31
  v_and_b32 v31, 0xffff0000, v31
  v_add_f32 v31, 0x3727c5ac, v31
  v_cvt_pk_bf16_f32 v31, v31, v31
  v_and_b32 v31, 0xffff0000, v31
  v_sqrt_f32 v31, v31
  v_lshlrev_b32 v42, 16, v24
  v_and_b32 v43, 0xffff0000, v24
  v_lshlrev_b32 v44, 16, v25
  v_and_b32 v45, 0xffff0000, v25
  v_lshlrev_b32 v46, 16, v26
  v_and_b32 v47, 0xffff0000, v26
  v_lshlrev_b32 v48, 16, v27
  v_and_b32 v49, 0xffff0000, v27
  v_lshlrev_b32 v50, 16, v28
  v_and_b32 v51, 0xffff0000, v28
  v_cvt_pk_bf16_f32 v31, v31, v31
  v_and_b32 v31, 0xffff0000, v31
  v_rcp_f32 v31, v31
  s_nop 0
  v_mul_f32 v42, v42, v31
  v_mul_f32 v43, v43, v31
  v_mul_f32 v44, v44, v31
  v_mul_f32 v45, v45, v31
  v_mul_f32 v46, v46, v31
  v_mul_f32 v47, v47, v31
  v_mul_f32 v48, v48, v31
  v_mul_f32 v49, v49, v31
  v_mul_f32 v50, v50, v31
  v_mul_f32 v51, v51, v31
  s_mul_i32 s52, s3, 2560
  v_lshl_add_u32 v31, v0, 3, s52
  v_cvt_pk_bf16_f32 v24, v42, v42
  v_cvt_pk_bf16_f32 v25, v43, v43
  ds_write_b64 v31, v[24:25] offset:18432
  v_cvt_pk_bf16_f32 v26, v44, v44
  v_cvt_pk_bf16_f32 v27, v45, v45
  ds_write_b64 v31, v[26:27] offset:18944
  v_cvt_pk_bf16_f32 v24, v46, v46
  v_cvt_pk_bf16_f32 v25, v47, v47
  ds_write_b64 v31, v[24:25] offset:19456
  v_cvt_pk_bf16_f32 v26, v48, v48
  v_cvt_pk_bf16_f32 v27, v49, v49
  ds_write_b64 v31, v[26:27] offset:19968
  v_cvt_pk_bf16_f32 v24, v50, v50
  v_cvt_pk_bf16_f32 v25, v51, v51
  ds_write_b64 v31, v[24:25] offset:20480
  s_waitcnt lgkmcnt(0)
  v_mov_b32 v24, 1
  v_mov_b32 v25, 2844
  s_mov_b64 exec, 1
  ds_add_u32 v25, v24
  s_mov_b64 exec, -1
  v_mov_b32 v25, 2844
  s_mov_b32 s61, 0
  s_nop 0
L_lw_12r:
  ds_read_b32 v24, v25
  s_waitcnt lgkmcnt(0)
  v_readfirstlane_b32 s52, v24
  s_cmp_ge_u32 s52, 4
  s_nop 3
  s_cbranch_scc1 L_lw_12o
  s_sleep 1
  s_add_u32 s61, s61, 1
  s_cmp_lt_u32 s61, 4800000
  s_cbranch_scc1 L_lw_12r
L_lw_12o:
  v_lshrrev_b32 v24, 4, v0
  v_lshl_add_u32 v24, v24, 2, s84
  ds_read_b32 v32, v24 offset:18432
  ds_read_b32 v33, v24 offset:20992
  ds_read_b32 v34, v24 offset:23552
  ds_read_b32 v35, v24 offset:26112
  ds_read_b32 v36, v24 offset:18448
  ds_read_b32 v37, v24 offset:21008
  ds_read_b32 v38, v24 offset:23568
  ds_read_b32 v39, v24 offset:26128
  ds_read_b32 v40, v24 offset:18464
  ds_read_b32 v41, v24 offset:21024
  ds_read_b32 v42, v24 offset:23584
  ds_read_b32 v43, v24 offset:26144
  s_waitcnt lgkmcnt(0)
  ds_read_b32 v44, v24 offset:18480
  ds_read_b32 v45, v24 offset:21040
  ds_read_b32 v46, v24 offset:23600
  ds_read_b32 v47, v24 offset:26160
  ds_read_b32 v48, v24 offset:18496
  ds_read_b32 v49, v24 offset:21056
  ds_read_b32 v50, v24 offset:23616
  ds_read_b32 v51, v24 offset:26176
  v_mov_b32 v52, 0
  v_mov_b32 v53, 0
  v_mov_b32 v54, 0
  v_mov_b32 v55, 0
  v_mov_b32 v56, 0
  v_mov_b32 v57, 0
  v_mov_b32 v58, 0
  v_mov_b32 v59, 0
  v_mov_b32 v60, 0
  v_mov_b32 v61, 0
  v_mov_b32 v62, 0
  v_mov_b32 v63, 0
  v_mov_b32 v64, 0
  v_mov_b32 v65, 0
  v_mov_b32 v66, 0
  v_mov_b32 v67, 0
  s_waitcnt lgkmcnt(0)
  s_waitcnt vmcnt(4)
  v_cndmask_b32 v32, v32, 0, s[58:59]
  v_and_b32 v16, v32, v2
  v_and_b32 v17, v32, v3
  v_and_b32 v18, v32, v4
  v_and_b32 v19, v32, v5
  s_nop 1
  v_mfma_f32_16x16x32_bf16 v[52:55], v[16:19], v[72:75], v[52:55]
  v_cndmask_b32 v33, v33, 0, s[58:59]
  v_and_b32 v24, v33, v2
  v_and_b32 v25, v33, v3
  v_and_b32 v26, v33, v4
  v_and_b32 v27, v33, v5
  s_nop 1
  v_mfma_f32_16x16x32_bf16 v[56:59], v[24:27], v[72:75], v[56:59]
  v_cndmask_b32 v34, v34, 0, s[58:59]
  v_and_b32 v28, v34, v2
  v_and_b32 v29, v34, v3
  v_and_b32 v30, v34, v4
  v_and_b32 v31, v34, v5
  s_nop 1
  v_mfma_f32_16x16x32_bf16 v[60:63], v[28:31], v[72:75], v[60:63]
  v_cndmask_b32 v35, v35, 0, s[58:59]
  v_and_b32 v16, v35, v2
  v_and_b32 v17, v35, v3
  v_and_b32 v18, v35, v4
  v_and_b32 v19, v35, v5
  s_nop 1
  v_mfma_f32_16x16x32_bf16 v[64:67], v[16:19], v[72:75], v[64:67]
  s_waitcnt vmcnt(3)
  v_cndmask_b32 v36, v36, 0, s[58:59]
  v_and_b32 v24, v36, v2
  v_and_b32 v25, v36, v3
  v_and_b32 v26, v36, v4
  v_and_b32 v27, v36, v5
  s_nop 1
  v_mfma_f32_16x16x32_bf16 v[52:55], v[24:27], v[76:79], v[52:55]
  v_cndmask_b32 v37, v37, 0, s[58:59]
  v_and_b32 v28, v37, v2
  v_and_b32 v29, v37, v3
  v_and_b32 v30, v37, v4
  v_and_b32 v31, v37, v5
  s_nop 1
  v_mfma_f32_16x16x32_bf16 v[56:59], v[28:31], v[76:79], v[56:59]
  v_cndmask_b32 v38, v38, 0, s[58:59]
  v_and_b32 v16, v38, v2
  v_and_b32 v17, v38, v3
  v_and_b32 v18, v38, v4
  v_and_b32 v19, v38, v5
  s_nop 1
  v_mfma_f32_16x16x32_bf16 v[60:63], v[16:19], v[76:79], v[60:63]
  v_cndmask_b32 v39, v39, 0, s[58:59]
  v_and_b32 v24, v39, v2
  v_and_b32 v25, v39, v3
  v_and_b32 v26, v39, v4
  v_and_b32 v27, v39, v5
  s_nop 1
  v_mfma_f32_16x16x32_bf16 v[64:67], v[24:27], v[76:79], v[64:67]
  s_waitcnt vmcnt(2)
  v_cndmask_b32 v40, v40, 0, s[58:59]
  v_and_b32 v28, v40, v2
  v_and_b32 v29, v40, v3
  v_and_b32 v30, v40, v4
  v_and_b32 v31, v40, v5
  s_nop 1
  v_mfma_f32_16x16x32_bf16 v[52:55], v[28:31], v[80:83], v[52:55]
  v_cndmask_b32 v41, v41, 0, s[58:59]
  v_and_b32 v16, v41, v2
  v_and_b32 v17, v41, v3
  v_and_b32 v18, v41, v4
  v_and_b32 v19, v41, v5
  s_nop 1
  v_mfma_f32_16x16x32_bf16 v[56:59], v[16:19], v[80:83], v[56:59]
  v_cndmask_b32 v42, v42, 0, s[58:59]
  v_and_b32 v24, v42, v2
  v_and_b32 v25, v42, v3
  v_and_b32 v26, v42, v4
  v_and_b32 v27, v42, v5
  s_nop 1
  v_mfma_f32_16x16x32_bf16 v[60:63], v[24:27], v[80:83], v[60:63]
  v_cndmask_b32 v43, v43, 0, s[58:59]
  v_and_b32 v28, v43, v2
  v_and_b32 v29, v43, v3
  v_and_b32 v30, v43, v4
  v_and_b32 v31, v43, v5
  s_nop 1
  v_mfma_f32_16x16x32_bf16 v[64:67], v[28:31], v[80:83], v[64:67]
  s_waitcnt vmcnt(1)
  v_cndmask_b32 v44, v44, 0, s[58:59]
  v_and_b32 v16, v44, v2
  v_and_b32 v17, v44, v3
  v_and_b32 v18, v44, v4
  v_and_b32 v19, v44, v5
  s_nop 1
  v_mfma_f32_16x16x32_bf16 v[52:55], v[16:19], v[84:87], v[52:55]
  v_cndmask_b32 v45, v45, 0, s[58:59]
  v_and_b32 v24, v45, v2
  v_and_b32 v25, v45, v3
  v_and_b32 v26, v45, v4
  v_and_b32 v27, v45, v5
  s_nop 1
  v_mfma_f32_16x16x32_bf16 v[56:59], v[24:27], v[84:87], v[56:59]
  v_cndmask_b32 v46, v46, 0, s[58:59]
  v_and_b32 v28, v46, v2
  v_and_b32 v29, v46, v3
  v_and_b32 v30, v46, v4
  v_and_b32 v31, v46, v5
  s_nop 1
  v_mfma_f32_16x16x32_bf16 v[60:63], v[28:31], v[84:87], v[60:63]
  v_cndmask_b32 v47, v47, 0, s[58:59]
  v_and_b32 v16, v47, v2
  v_and_b32 v17, v47, v3
  v_and_b32 v18, v47, v4
  v_and_b32 v19, v47, v5
  s_nop 1
  v_mfma_f32_16x16x32_bf16 v[64:67], v[16:19], v[84:87], v[64:67]
  s_waitcnt vmcnt(0)
  v_cndmask_b32 v48, v48, 0, s[58:59]
  v_and_b32 v24, v48, v2
  v_and_b32 v25, v48, v3
  v_and_b32 v26, v48, v4
  v_and_b32 v27, v48, v5
  s_nop 1
  v_mfma_f32_16x16x32_bf16 v[52:55], v[24:27], v[88:91], v[52:55]
  v_cndmask_b32 v49, v49, 0, s[58:59]
  v_and_b32 v28, v49, v2
  v_and_b32 v29, v49, v3
  v_and_b32 v30, v49, v4
  v_and_b32 v31, v49, v5
  s_nop 1
  v_mfma_f32_16x16x32_bf16 v[56:59], v[28:31], v[88:91], v[56:59]
  v_cndmask_b32 v50, v50, 0, s[58:59]
  v_and_b32 v16, v50, v2
  v_and_b32 v17, v50, v3
  v_and_b32 v18, v50, v4
  v_and_b32 v19, v50, v5
  s_nop 1
  v_mfma_f32_16x16x32_bf16 v[60:63], v[16:19], v[88:91], v[60:63]
  v_cndmask_b32 v51, v51, 0, s[58:59]
  v_and_b32 v24, v51, v2
  v_and_b32 v25, v51, v3
  v_and_b32 v26, v51, v4
  v_and_b32 v27, v51, v5
  s_nop 1
  v_mfma_f32_16x16x32_bf16 v[64:67], v[24:27], v[88:91], v[64:67]
  v_and_b32 v32, 15, v0
  v_lshlrev_b32 v32, 5, v32
  v_lshrrev_b32 v33, 4, v0
  v_lshl_add_u32 v32, v33, 4, v32
  s_lshl_b32 s52, s3, 11
  v_add_u32 v32, s52, v32
  s_mov_b32 exec_hi, 0
  ds_write_b128 v32, v[52:55] offset:4096
  ds_write_b128 v32, v[56:59] offset:4608
  ds_write_b128 v32, v[60:63] offset:5120
  ds_write_b128 v32, v[64:67] offset:5632
  s_mov_b32 exec_hi, -1
  s_waitcnt lgkmcnt(0)
  v_mov_b32 v24, 1
  v_mov_b32 v25, 2820
  s_mov_b64 exec, 1
  ds_add_u32 v25, v24
  s_mov_b64 exec, -1
  v_mov_b32 v25, 2820
  s_mov_b32 s61, 0
  s_nop 0
L_lw_13r:
  ds_read_b32 v24, v25
  s_waitcnt lgkmcnt(0)
  v_readfirstlane_b32 s52, v24
  s_cmp_ge_u32 s52, 4
  s_nop 3
  s_cbranch_scc1 L_lw_13o
  s_sleep 1
  s_add_u32 s61, s61, 1
  s_cmp_lt_u32 s61, 4800000
  s_cbranch_scc1 L_lw_13r
L_lw_13o:
  s_lshl_b32 s52, s3, 9
  v_lshl_add_u32 v32, v0, 3, s52
  ds_read_b64 v[34:35], v32 offset:4096
  ds_read_b64 v[36:37], v32 offset:6144
  ds_read_b64 v[38:39], v32 offset:8192
  ds_read_b64 v[40:41], v32 offset:10240
  v_mov_b32 v25, 2848
  s_mov_b32 s61, 0
  s_nop 0
L_lw_14r:
  ds_read_b32 v24, v25
  s_waitcnt lgkmcnt(0)
  v_readfirstlane_b32 s52, v24
  s_cmp_ge_u32 s52, 1
  s_nop 3
  s_cbranch_scc1 L_lw_14o
  s_sleep 1
  s_add_u32 s61, s61, 1
  s_cmp_lt_u32 s61, 4800000
  s_cbranch_scc1 L_lw_14r
L_lw_14o:
  v_add_f32 v34, v34, v36
  v_add_f32 v35, v35, v37
  v_add_f32 v34, v34, v38
  v_add_f32 v35, v35, v39
  v_add_f32 v34, v34, v40
  v_add_f32 v35, v35, v41
  v_min_u32 v34, 0xfffffffe, v34
  v_min_u32 v35, 0xfffffffe, v35
  v_lshlrev_b32 v33, 3, v0
  s_lshl_b32 s52, s3, 12
  s_add_u32 s52, s52, s82
  buffer_store_dwordx2 v[34:35], v33, s[48:51], s52 offen sc1
  s_cmp_lg_u32 s3, 0
  s_cbranch_scc1 L_q_15
  v_and_b32 v33, 3, v0
  v_lshlrev_b32 v33, 6, v33
  s_mov_b32 s61, 0
  s_nop 0
L_cchk_16r:
  buffer_load_dword v34, v33, s[44:47], 0 offen sc1
  s_waitcnt vmcnt(0)
  v_cmp_gt_u32 vcc, 64, v34
  s_nop 4
  s_cbranch_vccz L_cchk_16o
  s_sleep 8
  s_add_u32 s61, s61, 1
  s_cmp_lt_u32 s61, 300000
  s_cbranch_scc1 L_cchk_16r
L_cchk_16o:
  s_lshl_b32 s52, s5, 14
  s_lshl_b32 s53, s6, 12
  s_add_u32 s53, s53, s52
  s_add_u32 s53, s53, 851968
  s_mov_b32 s61, 0
L_qp_17r:
  buffer_load_dwordx4 v[32:35], v1, s[48:51], s53 offen offset:0 sc1
  buffer_load_dwordx4 v[36:39], v1, s[48:51], s53 offen offset:1024 sc1
  buffer_load_dwordx4 v[40:43], v1, s[48:51], s53 offen offset:2048 sc1
  buffer_load_dwordx4 v[44:47], v1, s[48:51], s53 offen offset:3072 sc1
  s_waitcnt vmcnt(0)
  v_max3_u32 v48, v32, v33, v34
  v_max3_u32 v48, v48, v35, v36
  v_max3_u32 v48, v48, v37, v38
  v_max3_u32 v48, v48, v39, v40
  v_max3_u32 v48, v48, v41, v42
  v_max3_u32 v48, v48, v43, v44
  v_max3_u32 v48, v48, v45, v46
  v_max_u32 v48, v48, v47
  v_cmp_eq_u32 vcc, -1, v48
  s_nop 4
  s_cbranch_vccz L_qp_17o
  s_sleep 2
  s_add_u32 s61, s61, 1
  s_cmp_lt_u32 s61, 300000
  s_cbranch_scc1 L_qp_17r
L_qp_17o:
  v_add_f32 v32, v32, v36
  v_add_f32 v33, v33, v37
  v_add_f32 v34, v34, v38
  v_add_f32 v35, v35, v39
  v_add_f32 v32, v32, v40
  v_add_f32 v33, v33, v41
  v_add_f32 v34, v34, v42
  v_add_f32 v35, v35, v43
  v_add_f32 v32, v32, v44
  v_add_f32 v33, v33, v45
  v_add_f32 v34, v34, v46
  v_add_f32 v35, v35, v47
  v_mov_b32 v36, v32
  v_mov_b32 v37, v33
  v_mov_b32 v38, v34
  v_mov_b32 v39, v35
  v_permlane32_swap_b32 v32, v36
  v_permlane32_swap_b32 v33, v37
  v_permlane32_swap_b32 v34, v38
  v_permlane32_swap_b32 v35, v39
  v_add_f32 v32, v32, v36
  v_add_f32 v33, v33, v37
  v_add_f32 v34, v34, v38
  v_add_f32 v35, v35, v39
  v_cvt_pk_bf16_f32 v32, v32, v33
  v_cvt_pk_bf16_f32 v33, v34, v35
  v_and_b32 v34, 31, v0
  v_lshlrev_b32 v34, 3, v34
  ds_write_b64 v34, v[32:33] offset:2560
  s_waitcnt lgkmcnt(0)
  v_mov_b32 v24, 1
  v_mov_b32 v25, 2824
  s_mov_b64 exec, 1
  ds_add_u32 v25, v24
  s_mov_b64 exec, -1
L_q_15:
  s_add_u32 s52, s54, 0
  buffer_load_dwordx4 v[92:95], v1, s[8:11], s52 offen offset:0 nt
  s_add_u32 s52, s54, 0
  buffer_load_dwordx4 v[96:99], v1, s[8:11], s52 offen offset:1024 nt
  s_add_u32 s52, s54, 0
  buffer_load_dwordx4 v[52:55], v1, s[8:11], s52 offen offset:2048 nt
  s_add_u32 s52, s54, 0
  buffer_load_dwordx4 v[56:59], v1, s[8:11], s52 offen offset:3072 nt
  s_add_u32 s52, s54, 4096
  buffer_load_dwordx4 v[60:63], v1, s[8:11], s52 offen offset:0 nt
  s_add_u32 s52, s54, 4096
  buffer_load_dwordx4 v[64:67], v1, s[8:11], s52 offen offset:1024 nt
  s_add_u32 s52, s54, 4096
  buffer_load_dwordx4 v[68:71], v1, s[8:11], s52 offen offset:2048 nt
  s_add_u32 s52, s54, 4096
  buffer_load_dwordx4 v[72:75], v1, s[8:11], s52 offen offset:3072 nt
  s_add_u32 s52, s54, 8192
  buffer_load_dwordx4 v[76:79], v1, s[8:11], s52 offen offset:0 nt
  s_add_u32 s52, s54, 8192
  buffer_load_dwordx4 v[80:83], v1, s[8:11], s52 offen offset:1024 nt
  s_add_u32 s52, s54, 8192
  buffer_load_dwordx4 v[84:87], v1, s[8:11], s52 offen offset:2048 nt
  s_add_u32 s52, s54, 8192
  buffer_load_dwordx4 v[88:91], v1, s[8:11], s52 offen offset:3072 nt
  v_mov_b32 v25, 2824
  s_mov_b32 s61, 0
  s_nop 0
L_lw_18r:
  ds_read_b32 v24, v25
  s_waitcnt lgkmcnt(0)
  v_readfirstlane_b32 s52, v24
  s_cmp_ge_u32 s52, 1
  s_nop 3
  s_cbranch_scc1 L_lw_18o
  s_sleep 4
  s_add_u32 s61, s61, 1
  s_cmp_lt_u32 s61, 1200000
  s_cbranch_scc1 L_lw_18r
L_lw_18o:
  v_and_b32 v24, 15, v0
  v_lshlrev_b32 v24, 4, v24
  ds_read_b128 v[6:9], v24 offset:2560
  v_mov_b32 v14, 0xff800000
  v_mov_b32 v10, 0
  v_mov_b32 v11, 0
  v_mov_b32 v12, 0
  v_mov_b32 v13, 0
  s_waitcnt lgkmcnt(0)
  s_waitcnt vmcnt(11)
  v_dot2_f32_bf16 v24, v92, v6, 0
  v_dot2_f32_bf16 v24, v93, v7, v24
  v_dot2_f32_bf16 v24, v94, v8, v24
  v_dot2_f32_bf16 v24, v95, v9, v24
  s_add_u32 s52, s54, 12288
  buffer_load_dwordx4 v[92:95], v1, s[8:11], s52 offen offset:0 nt
  s_nop 0
  v_add_f32_dpp v24, v24, v24 row_ror:8 row_mask:0xf bank_mask:0xf
  s_nop 1
  v_add_f32_dpp v24, v24, v24 row_ror:4 row_mask:0xf bank_mask:0xf
  s_nop 1
  v_add_f32_dpp v24, v24, v24 row_ror:2 row_mask:0xf bank_mask:0xf
  s_nop 1
  v_add_f32_dpp v24, v24, v24 row_ror:1 row_mask:0xf bank_mask:0xf
  v_cvt_pk_bf16_f32 v28, v24, v24
  v_and_b32 v29, 0xffff0000, v28
  v_lshlrev_b32 v28, 16, v28
  v_mul_f32 v29, s55, v29
  v_mul_f32 v28, s55, v28
  v_max3_f32 v14, v14, v28, v29
  v_cvt_pk_bf16_f32 v47, v28, v29
  s_waitcnt vmcnt(11)
  v_dot2_f32_bf16 v24, v96, v6, 0
  v_dot2_f32_bf16 v24, v97, v7, v24
  v_dot2_f32_bf16 v24, v98, v8, v24
  v_dot2_f32_bf16 v24, v99, v9, v24
  s_add_u32 s52, s54, 12288
  buffer_load_dwordx4 v[96:99], v1, s[8:11], s52 offen offset:1024 nt
  s_waitcnt vmcnt(11)
  v_dot2_f32_bf16 v25, v52, v6, 0
  v_dot2_f32_bf16 v25, v53, v7, v25
  v_dot2_f32_bf16 v25, v54, v8, v25
  v_dot2_f32_bf16 v25, v55, v9, v25
  s_add_u32 s52, s54, 12288
  buffer_load_dwordx4 v[52:55], v1, s[8:11], s52 offen offset:2048 nt
  s_waitcnt vmcnt(11)
  v_dot2_f32_bf16 v26, v56, v6, 0
  v_dot2_f32_bf16 v26, v57, v7, v26
  v_dot2_f32_bf16 v26, v58, v8, v26
  v_dot2_f32_bf16 v26, v59, v9, v26
  s_add_u32 s52, s54, 12288
  buffer_load_dwordx4 v[56:59], v1, s[8:11], s52 offen offset:3072 nt
  s_waitcnt vmcnt(11)
  v_dot2_f32_bf16 v27, v60, v6, 0
  v_dot2_f32_bf16 v27, v61, v7, v27
  v_dot2_f32_bf16 v27, v62, v8, v27
  v_dot2_f32_bf16 v27, v63, v9, v27
  s_add_u32 s52, s54, 16384
  buffer_load_dwordx4 v[60:63], v1, s[8:11], s52 offen offset:0 nt
  v_add_f32_dpp v24, v24, v24 row_ror:8 row_mask:0xf bank_mask:0xf
  v_add_f32_dpp v25, v25, v25 row_ror:8 row_mask:0xf bank_mask:0xf
  v_add_f32_dpp v26, v26, v26 row_ror:8 row_mask:0xf bank_mask:0xf
  v_add_f32_dpp v27, v27, v27 row_ror:8 row_mask:0xf bank_mask:0xf
  v_add_f32_dpp v24, v24, v24 row_ror:4 row_mask:0xf bank_mask:0xf
  v_add_f32_dpp v25, v25, v25 row_ror:4 row_mask:0xf bank_mask:0xf
  v_add_f32_dpp v26, v26, v26 row_ror:4 row_mask:0xf bank_mask:0xf
  v_add_f32_dpp v27, v27, v27 row_ror:4 row_mask:0xf bank_mask:0xf
  v_add_f32_dpp v24, v24, v24 row_ror:2 row_mask:0xf bank_mask:0xf
  v_add_f32_dpp v25, v25, v25 row_ror:2 row_mask:0xf bank_mask:0xf
  v_add_f32_dpp v26, v26, v26 row_ror:2 row_mask:0xf bank_mask:0xf
  v_add_f32_dpp v27, v27, v27 row_ror:2 row_mask:0xf bank_mask:0xf
  v_add_f32_dpp v24, v24, v24 row_ror:1 row_mask:0xf bank_mask:0xf
  v_add_f32_dpp v25, v25, v25 row_ror:1 row_mask:0xf bank_mask:0xf
  v_add_f32_dpp v26, v26, v26 row_ror:1 row_mask:0xf bank_mask:0xf
  v_add_f32_dpp v27, v27, v27 row_ror:1 row_mask:0xf bank_mask:0xf
  v_cvt_pk_bf16_f32 v28, v25, v24
  v_and_b32 v29, 0xffff0000, v28
  v_lshlrev_b32 v28, 16, v28
  v_mul_f32 v29, s55, v29
  v_mul_f32 v28, s55, v28
  v_max3_f32 v14, v14, v28, v29
  v_cvt_pk_bf16_f32 v46, v28, v29
  v_cvt_pk_bf16_f32 v30, v27, v26
  v_and_b32 v31, 0xffff0000, v30
  v_lshlrev_b32 v30, 16, v30
  v_mul_f32 v31, s55, v31
  v_mul_f32 v30, s55, v30
  v_max3_f32 v14, v14, v30, v31
  v_cvt_pk_bf16_f32 v45, v30, v31
  s_waitcnt vmcnt(11)
  v_dot2_f32_bf16 v24, v64, v6, 0
  v_dot2_f32_bf16 v24, v65, v7, v24
  v_dot2_f32_bf16 v24, v66, v8, v24
  v_dot2_f32_bf16 v24, v67, v9, v24
  s_add_u32 s52, s54, 16384
  buffer_load_dwordx4 v[64:67], v1, s[8:11], s52 offen offset:1024 nt
  s_waitcnt vmcnt(11)
  v_dot2_f32_bf16 v25, v68, v6, 0
  v_dot2_f32_bf16 v25, v69, v7, v25
  v_dot2_f32_bf16 v25, v70, v8, v25
  v_dot2_f32_bf16 v25, v71, v9, v25
  s_add_u32 s52, s54, 16384
  buffer_load_dwordx4 v[68:71], v1, s[8:11], s52 offen offset:2048 nt
  s_waitcnt vmcnt(11)
  v_dot2_f32_bf16 v26, v72, v6, 0
  v_dot2_f32_bf16 v26, v73, v7, v26
  v_dot2_f32_bf16 v26, v74, v8, v26
  v_dot2_f32_bf16 v26, v75, v9, v26
  s_add_u32 s52, s54, 16384
  buffer_load_dwordx4 v[72:75], v1, s[8:11], s52 offen offset:3072 nt
  s_waitcnt vmcnt(11)
  v_dot2_f32_bf16 v27, v76, v6, 0
  v_dot2_f32_bf16 v27, v77, v7, v27
  v_dot2_f32_bf16 v27, v78, v8, v27
  v_dot2_f32_bf16 v27, v79, v9, v27
  s_add_u32 s52, s54, 20480
  buffer_load_dwordx4 v[76:79], v1, s[8:11], s52 offen offset:0 nt
  v_add_f32_dpp v24, v24, v24 row_ror:8 row_mask:0xf bank_mask:0xf
  v_add_f32_dpp v25, v25, v25 row_ror:8 row_mask:0xf bank_mask:0xf
  v_add_f32_dpp v26, v26, v26 row_ror:8 row_mask:0xf bank_mask:0xf
  v_add_f32_dpp v27, v27, v27 row_ror:8 row_mask:0xf bank_mask:0xf
  v_add_f32_dpp v24, v24, v24 row_ror:4 row_mask:0xf bank_mask:0xf
  v_add_f32_dpp v25, v25, v25 row_ror:4 row_mask:0xf bank_mask:0xf
  v_add_f32_dpp v26, v26, v26 row_ror:4 row_mask:0xf bank_mask:0xf
  v_add_f32_dpp v27, v27, v27 row_ror:4 row_mask:0xf bank_mask:0xf
  v_add_f32_dpp v24, v24, v24 row_ror:2 row_mask:0xf bank_mask:0xf
  v_add_f32_dpp v25, v25, v25 row_ror:2 row_mask:0xf bank_mask:0xf
  v_add_f32_dpp v26, v26, v26 row_ror:2 row_mask:0xf bank_mask:0xf
  v_add_f32_dpp v27, v27, v27 row_ror:2 row_mask:0xf bank_mask:0xf
  v_add_f32_dpp v24, v24, v24 row_ror:1 row_mask:0xf bank_mask:0xf
  v_add_f32_dpp v25, v25, v25 row_ror:1 row_mask:0xf bank_mask:0xf
  v_add_f32_dpp v26, v26, v26 row_ror:1 row_mask:0xf bank_mask:0xf
  v_add_f32_dpp v27, v27, v27 row_ror:1 row_mask:0xf bank_mask:0xf
  v_cvt_pk_bf16_f32 v28, v25, v24
  v_and_b32 v29, 0xffff0000, v28
  v_lshlrev_b32 v28, 16, v28
  v_mul_f32 v29, s55, v29
  v_mul_f32 v28, s55, v28
  v_max3_f32 v14, v14, v28, v29
  v_cvt_pk_bf16_f32 v44, v28, v29
  v_cvt_pk_bf16_f32 v30, v27, v26
  v_and_b32 v31, 0xffff0000, v30
  v_lshlrev_b32 v30, 16, v30
  v_mul_f32 v31, s55, v31
  v_mul_f32 v30, s55, v30
  v_max3_f32 v14, v14, v30, v31
  v_cvt_pk_bf16_f32 v43, v30, v31
  s_waitcnt vmcnt(11)
  v_dot2_f32_bf16 v24, v80, v6, 0
  v_dot2_f32_bf16 v24, v81, v7, v24
  v_dot2_f32_bf16 v24, v82, v8, v24
  v_dot2_f32_bf16 v24, v83, v9, v24
  s_add_u32 s52, s54, 20480
  buffer_load_dwordx4 v[80:83], v1, s[8:11], s52 offen offset:1024 nt
  s_waitcnt vmcnt(11)
  v_dot2_f32_bf16 v25, v84, v6, 0
  v_dot2_f32_bf16 v25, v85, v7, v25
  v_dot2_f32_bf16 v25, v86, v8, v25
  v_dot2_f32_bf16 v25, v87, v9, v25
  s_add_u32 s52, s54, 20480
  buffer_load_dwordx4 v[84:87], v1, s[8:11], s52 offen offset:2048 nt
  s_waitcnt vmcnt(11)
  v_dot2_f32_bf16 v26, v88, v6, 0
  v_dot2_f32_bf16 v26, v89, v7, v26
  v_dot2_f32_bf16 v26, v90, v8, v26
  v_dot2_f32_bf16 v26, v91, v9, v26
  s_add_u32 s52, s54, 20480
  buffer_load_dwordx4 v[88:91], v1, s[8:11], s52 offen offset:3072 nt
  s_waitcnt vmcnt(11)
  v_dot2_f32_bf16 v27, v92, v6, 0
  v_dot2_f32_bf16 v27, v93, v7, v27
  v_dot2_f32_bf16 v27, v94, v8, v27
  v_dot2_f32_bf16 v27, v95, v9, v27
  s_add_u32 s52, s54, 24576
  buffer_load_dwordx4 v[92:95], v1, s[8:11], s52 offen offset:0 nt
  v_add_f32_dpp v24, v24, v24 row_ror:8 row_mask:0xf bank_mask:0xf
  v_add_f32_dpp v25, v25, v25 row_ror:8 row_mask:0xf bank_mask:0xf
  v_add_f32_dpp v26, v26, v26 row_ror:8 row_mask:0xf bank_mask:0xf
  v_add_f32_dpp v27, v27, v27 row_ror:8 row_mask:0xf bank_mask:0xf
  v_add_f32_dpp v24, v24, v24 row_ror:4 row_mask:0xf bank_mask:0xf
  v_add_f32_dpp v25, v25, v25 row_ror:4 row_mask:0xf bank_mask:0xf
  v_add_f32_dpp v26, v26, v26 row_ror:4 row_mask:0xf bank_mask:0xf
  v_add_f32_dpp v27, v27, v27 row_ror:4 row_mask:0xf bank_mask:0xf
  v_add_f32_dpp v24, v24, v24 row_ror:2 row_mask:0xf bank_mask:0xf
  v_add_f32_dpp v25, v25, v25 row_ror:2 row_mask:0xf bank_mask:0xf
  v_add_f32_dpp v26, v26, v26 row_ror:2 row_mask:0xf bank_mask:0xf
  v_add_f32_dpp v27, v27, v27 row_ror:2 row_mask:0xf bank_mask:0xf
  v_add_f32_dpp v24, v24, v24 row_ror:1 row_mask:0xf bank_mask:0xf
  v_add_f32_dpp v25, v25, v25 row_ror:1 row_mask:0xf bank_mask:0xf
  v_add_f32_dpp v26, v26, v26 row_ror:1 row_mask:0xf bank_mask:0xf
  v_add_f32_dpp v27, v27, v27 row_ror:1 row_mask:0xf bank_mask:0xf
  v_cvt_pk_bf16_f32 v28, v25, v24
  v_and_b32 v29, 0xffff0000, v28
  v_lshlrev_b32 v28, 16, v28
  v_mul_f32 v29, s55, v29
  v_mul_f32 v28, s55, v28
  v_max3_f32 v14, v14, v28, v29
  v_cvt_pk_bf16_f32 v42, v28, v29
  v_cvt_pk_bf16_f32 v30, v27, v26
  v_and_b32 v31, 0xffff0000, v30
  v_lshlrev_b32 v30, 16, v30
  v_mul_f32 v31, s55, v31
  v_mul_f32 v30, s55, v30
  v_max3_f32 v14, v14, v30, v31
  v_cvt_pk_bf16_f32 v41, v30, v31
  s_waitcnt vmcnt(11)
  v_dot2_f32_bf16 v24, v96, v6, 0
  v_dot2_f32_bf16 v24, v97, v7, v24
  v_dot2_f32_bf16 v24, v98, v8, v24
  v_dot2_f32_bf16 v24, v99, v9, v24
  s_add_u32 s52, s54, 24576
  buffer_load_dwordx4 v[96:99], v1, s[8:11], s52 offen offset:1024 nt
  s_waitcnt vmcnt(11)
  v_dot2_f32_bf16 v25, v52, v6, 0
  v_dot2_f32_bf16 v25, v53, v7, v25
  v_dot2_f32_bf16 v25, v54, v8, v25
  v_dot2_f32_bf16 v25, v55, v9, v25
  s_add_u32 s52, s54, 24576
  buffer_load_dwordx4 v[52:55], v1, s[8:11], s52 offen offset:2048 nt
  s_waitcnt vmcnt(11)
  v_dot2_f32_bf16 v26, v56, v6, 0
  v_dot2_f32_bf16 v26, v57, v7, v26
  v_dot2_f32_bf16 v26, v58, v8, v26
  v_dot2_f32_bf16 v26, v59, v9, v26
  s_add_u32 s52, s54, 24576
  buffer_load_dwordx4 v[56:59], v1, s[8:11], s52 offen offset:3072 nt
  s_waitcnt vmcnt(11)
  v_dot2_f32_bf16 v27, v60, v6, 0
  v_dot2_f32_bf16 v27, v61, v7, v27
  v_dot2_f32_bf16 v27, v62, v8, v27
  v_dot2_f32_bf16 v27, v63, v9, v27
  s_add_u32 s52, s54, 28672
  buffer_load_dwordx4 v[60:63], v1, s[8:11], s52 offen offset:0 nt
  v_add_f32_dpp v24, v24, v24 row_ror:8 row_mask:0xf bank_mask:0xf
  v_add_f32_dpp v25, v25, v25 row_ror:8 row_mask:0xf bank_mask:0xf
  v_add_f32_dpp v26, v26, v26 row_ror:8 row_mask:0xf bank_mask:0xf
  v_add_f32_dpp v27, v27, v27 row_ror:8 row_mask:0xf bank_mask:0xf
  v_add_f32_dpp v24, v24, v24 row_ror:4 row_mask:0xf bank_mask:0xf
  v_add_f32_dpp v25, v25, v25 row_ror:4 row_mask:0xf bank_mask:0xf
  v_add_f32_dpp v26, v26, v26 row_ror:4 row_mask:0xf bank_mask:0xf
  v_add_f32_dpp v27, v27, v27 row_ror:4 row_mask:0xf bank_mask:0xf
  v_add_f32_dpp v24, v24, v24 row_ror:2 row_mask:0xf bank_mask:0xf
  v_add_f32_dpp v25, v25, v25 row_ror:2 row_mask:0xf bank_mask:0xf
  v_add_f32_dpp v26, v26, v26 row_ror:2 row_mask:0xf bank_mask:0xf
  v_add_f32_dpp v27, v27, v27 row_ror:2 row_mask:0xf bank_mask:0xf
  v_add_f32_dpp v24, v24, v24 row_ror:1 row_mask:0xf bank_mask:0xf
  v_add_f32_dpp v25, v25, v25 row_ror:1 row_mask:0xf bank_mask:0xf
  v_add_f32_dpp v26, v26, v26 row_ror:1 row_mask:0xf bank_mask:0xf
  v_add_f32_dpp v27, v27, v27 row_ror:1 row_mask:0xf bank_mask:0xf
  v_cvt_pk_bf16_f32 v28, v25, v24
  v_and_b32 v29, 0xffff0000, v28
  v_lshlrev_b32 v28, 16, v28
  v_mul_f32 v29, s55, v29
  v_mul_f32 v28, s55, v28
  v_max3_f32 v14, v14, v28, v29
  v_cvt_pk_bf16_f32 v40, v28, v29
  v_cvt_pk_bf16_f32 v30, v27, v26
  v_and_b32 v31, 0xffff0000, v30
  v_lshlrev_b32 v30, 16, v30
  v_mul_f32 v31, s55, v31
  v_mul_f32 v30, s55, v30
  v_max3_f32 v14, v14, v30, v31
  v_cvt_pk_bf16_f32 v39, v30, v31
  s_waitcnt vmcnt(11)
  v_dot2_f32_bf16 v24, v64, v6, 0
  v_dot2_f32_bf16 v24, v65, v7, v24
  v_dot2_f32_bf16 v24, v66, v8, v24
  v_dot2_f32_bf16 v24, v67, v9, v24
  s_add_u32 s52, s54, 28672
  buffer_load_dwordx4 v[64:67], v1, s[8:11], s52 offen offset:1024 nt
  s_waitcnt vmcnt(11)
  v_dot2_f32_bf16 v25, v68, v6, 0
  v_dot2_f32_bf16 v25, v69, v7, v25
  v_dot2_f32_bf16 v25, v70, v8, v25
  v_dot2_f32_bf16 v25, v71, v9, v25
  s_add_u32 s52, s54, 28672
  buffer_load_dwordx4 v[68:71], v1, s[8:11], s52 offen offset:2048 nt
  s_waitcnt vmcnt(11)
  v_dot2_f32_bf16 v26, v72, v6, 0
  v_dot2_f32_bf16 v26, v73, v7, v26
  v_dot2_f32_bf16 v26, v74, v8, v26
  v_dot2_f32_bf16 v26, v75, v9, v26
  s_add_u32 s52, s54, 0
  buffer_load_dwordx4 v[72:75], v1, s[12:15], s52 offen offset:0 nt
  s_waitcnt vmcnt(11)
  v_dot2_f32_bf16 v27, v76, v6, 0
  v_dot2_f32_bf16 v27, v77, v7, v27
  v_dot2_f32_bf16 v27, v78, v8, v27
  v_dot2_f32_bf16 v27, v79, v9, v27
  s_add_u32 s52, s54, 0
  buffer_load_dwordx4 v[76:79], v1, s[12:15], s52 offen offset:1024 nt
  v_add_f32_dpp v24, v24, v24 row_ror:8 row_mask:0xf bank_mask:0xf
  v_add_f32_dpp v25, v25, v25 row_ror:8 row_mask:0xf bank_mask:0xf
  v_add_f32_dpp v26, v26, v26 row_ror:8 row_mask:0xf bank_mask:0xf
  v_add_f32_dpp v27, v27, v27 row_ror:8 row_mask:0xf bank_mask:0xf
  v_add_f32_dpp v24, v24, v24 row_ror:4 row_mask:0xf bank_mask:0xf
  v_add_f32_dpp v25, v25, v25 row_ror:4 row_mask:0xf bank_mask:0xf
  v_add_f32_dpp v26, v26, v26 row_ror:4 row_mask:0xf bank_mask:0xf
  v_add_f32_dpp v27, v27, v27 row_ror:4 row_mask:0xf bank_mask:0xf
  v_add_f32_dpp v24, v24, v24 row_ror:2 row_mask:0xf bank_mask:0xf
  v_add_f32_dpp v25, v25, v25 row_ror:2 row_mask:0xf bank_mask:0xf
  v_add_f32_dpp v26, v26, v26 row_ror:2 row_mask:0xf bank_mask:0xf
  v_add_f32_dpp v27, v27, v27 row_ror:2 row_mask:0xf bank_mask:0xf
  v_add_f32_dpp v24, v24, v24 row_ror:1 row_mask:0xf bank_mask:0xf
  v_add_f32_dpp v25, v25, v25 row_ror:1 row_mask:0xf bank_mask:0xf
  v_add_f32_dpp v26, v26, v26 row_ror:1 row_mask:0xf bank_mask:0xf
  v_add_f32_dpp v27, v27, v27 row_ror:1 row_mask:0xf bank_mask:0xf
  v_cvt_pk_bf16_f32 v28, v25, v24
  v_and_b32 v29, 0xffff0000, v28
  v_lshlrev_b32 v28, 16, v28
  v_mul_f32 v29, s55, v29
  v_mul_f32 v28, s55, v28
  v_max3_f32 v14, v14, v28, v29
  v_cvt_pk_bf16_f32 v38, v28, v29
  v_cvt_pk_bf16_f32 v30, v27, v26
  v_and_b32 v31, 0xffff0000, v30
  v_lshlrev_b32 v30, 16, v30
  v_mul_f32 v31, s55, v31
  v_mul_f32 v30, s55, v30
  v_max3_f32 v14, v14, v30, v31
  v_cvt_pk_bf16_f32 v37, v30, v31
  s_waitcnt vmcnt(11)
  v_dot2_f32_bf16 v24, v80, v6, 0
  v_dot2_f32_bf16 v24, v81, v7, v24
  v_dot2_f32_bf16 v24, v82, v8, v24
  v_dot2_f32_bf16 v24, v83, v9, v24
  s_add_u32 s52, s54, 0
  buffer_load_dwordx4 v[80:83], v1, s[12:15], s52 offen offset:2048 nt
  s_waitcnt vmcnt(11)
  v_dot2_f32_bf16 v25, v84, v6, 0
  v_dot2_f32_bf16 v25, v85, v7, v25
  v_dot2_f32_bf16 v25, v86, v8, v25
  v_dot2_f32_bf16 v25, v87, v9, v25
  s_add_u32 s52, s54, 0
  buffer_load_dwordx4 v[84:87], v1, s[12:15], s52 offen offset:3072 nt
  s_waitcnt vmcnt(11)
  v_dot2_f32_bf16 v26, v88, v6, 0
  v_dot2_f32_bf16 v26, v89, v7, v26
  v_dot2_f32_bf16 v26, v90, v8, v26
  v_dot2_f32_bf16 v26, v91, v9, v26
  s_add_u32 s52, s54, 4096
  buffer_load_dwordx4 v[88:91], v1, s[12:15], s52 offen offset:0 nt
  s_waitcnt vmcnt(11)
  v_dot2_f32_bf16 v27, v92, v6, 0
  v_dot2_f32_bf16 v27, v93, v7, v27
  v_dot2_f32_bf16 v27, v94, v8, v27
  v_dot2_f32_bf16 v27, v95, v9, v27
  s_add_u32 s52, s54, 4096
  buffer_load_dwordx4 v[92:95], v1, s[12:15], s52 offen offset:1024 nt
  v_add_f32_dpp v24, v24, v24 row_ror:8 row_mask:0xf bank_mask:0xf
  v_add_f32_dpp v25, v25, v25 row_ror:8 row_mask:0xf bank_mask:0xf
  v_add_f32_dpp v26, v26, v26 row_ror:8 row_mask:0xf bank_mask:0xf
  v_add_f32_dpp v27, v27, v27 row_ror:8 row_mask:0xf bank_mask:0xf
  v_add_f32_dpp v24, v24, v24 row_ror:4 row_mask:0xf bank_mask:0xf
  v_add_f32_dpp v25, v25, v25 row_ror:4 row_mask:0xf bank_mask:0xf
  v_add_f32_dpp v26, v26, v26 row_ror:4 row_mask:0xf bank_mask:0xf
  v_add_f32_dpp v27, v27, v27 row_ror:4 row_mask:0xf bank_mask:0xf
  v_add_f32_dpp v24, v24, v24 row_ror:2 row_mask:0xf bank_mask:0xf
  v_add_f32_dpp v25, v25, v25 row_ror:2 row_mask:0xf bank_mask:0xf
  v_add_f32_dpp v26, v26, v26 row_ror:2 row_mask:0xf bank_mask:0xf
  v_add_f32_dpp v27, v27, v27 row_ror:2 row_mask:0xf bank_mask:0xf
  v_add_f32_dpp v24, v24, v24 row_ror:1 row_mask:0xf bank_mask:0xf
  v_add_f32_dpp v25, v25, v25 row_ror:1 row_mask:0xf bank_mask:0xf
  v_add_f32_dpp v26, v26, v26 row_ror:1 row_mask:0xf bank_mask:0xf
  v_add_f32_dpp v27, v27, v27 row_ror:1 row_mask:0xf bank_mask:0xf
  v_cvt_pk_bf16_f32 v28, v25, v24
  v_and_b32 v29, 0xffff0000, v28
  v_lshlrev_b32 v28, 16, v28
  v_mul_f32 v29, s55, v29
  v_mul_f32 v28, s55, v28
  v_max3_f32 v14, v14, v28, v29
  v_cvt_pk_bf16_f32 v36, v28, v29
  v_cvt_pk_bf16_f32 v30, v27, v26
  v_and_b32 v31, 0xffff0000, v30
  v_lshlrev_b32 v30, 16, v30
  v_mul_f32 v31, s55, v31
  v_mul_f32 v30, s55, v30
  v_max3_f32 v14, v14, v30, v31
  v_cvt_pk_bf16_f32 v35, v30, v31
  s_waitcnt vmcnt(11)
  v_dot2_f32_bf16 v24, v96, v6, 0
  v_dot2_f32_bf16 v24, v97, v7, v24
  v_dot2_f32_bf16 v24, v98, v8, v24
  v_dot2_f32_bf16 v24, v99, v9, v24
  s_add_u32 s52, s54, 4096
  buffer_load_dwordx4 v[96:99], v1, s[12:15], s52 offen offset:2048 nt
  s_waitcnt vmcnt(11)
  v_dot2_f32_bf16 v25, v52, v6, 0
  v_dot2_f32_bf16 v25, v53, v7, v25
  v_dot2_f32_bf16 v25, v54, v8, v25
  v_dot2_f32_bf16 v25, v55, v9, v25
  s_add_u32 s52, s54, 4096
  buffer_load_dwordx4 v[52:55], v1, s[12:15], s52 offen offset:3072 nt
  s_waitcnt vmcnt(11)
  v_dot2_f32_bf16 v26, v56, v6, 0
  v_dot2_f32_bf16 v26, v57, v7, v26
  v_dot2_f32_bf16 v26, v58, v8, v26
  v_dot2_f32_bf16 v26, v59, v9, v26
  s_add_u32 s52, s54, 8192
  buffer_load_dwordx4 v[56:59], v1, s[12:15], s52 offen offset:0 nt
  s_waitcnt vmcnt(11)
  v_dot2_f32_bf16 v27, v60, v6, 0
  v_dot2_f32_bf16 v27, v61, v7, v27
  v_dot2_f32_bf16 v27, v62, v8, v27
  v_dot2_f32_bf16 v27, v63, v9, v27
  s_add_u32 s52, s54, 8192
  buffer_load_dwordx4 v[60:63], v1, s[12:15], s52 offen offset:1024 nt
  v_add_f32_dpp v24, v24, v24 row_ror:8 row_mask:0xf bank_mask:0xf
  v_add_f32_dpp v25, v25, v25 row_ror:8 row_mask:0xf bank_mask:0xf
  v_add_f32_dpp v26, v26, v26 row_ror:8 row_mask:0xf bank_mask:0xf
  v_add_f32_dpp v27, v27, v27 row_ror:8 row_mask:0xf bank_mask:0xf
  v_add_f32_dpp v24, v24, v24 row_ror:4 row_mask:0xf bank_mask:0xf
  v_add_f32_dpp v25, v25, v25 row_ror:4 row_mask:0xf bank_mask:0xf
  v_add_f32_dpp v26, v26, v26 row_ror:4 row_mask:0xf bank_mask:0xf
  v_add_f32_dpp v27, v27, v27 row_ror:4 row_mask:0xf bank_mask:0xf
  v_add_f32_dpp v24, v24, v24 row_ror:2 row_mask:0xf bank_mask:0xf
  v_add_f32_dpp v25, v25, v25 row_ror:2 row_mask:0xf bank_mask:0xf
  v_add_f32_dpp v26, v26, v26 row_ror:2 row_mask:0xf bank_mask:0xf
  v_add_f32_dpp v27, v27, v27 row_ror:2 row_mask:0xf bank_mask:0xf
  v_add_f32_dpp v24, v24, v24 row_ror:1 row_mask:0xf bank_mask:0xf
  v_add_f32_dpp v25, v25, v25 row_ror:1 row_mask:0xf bank_mask:0xf
  v_add_f32_dpp v26, v26, v26 row_ror:1 row_mask:0xf bank_mask:0xf
  v_add_f32_dpp v27, v27, v27 row_ror:1 row_mask:0xf bank_mask:0xf
  v_cvt_pk_bf16_f32 v28, v25, v24
  v_and_b32 v29, 0xffff0000, v28
  v_lshlrev_b32 v28, 16, v28
  v_mul_f32 v29, s55, v29
  v_mul_f32 v28, s55, v28
  v_max3_f32 v14, v14, v28, v29
  v_cvt_pk_bf16_f32 v34, v28, v29
  v_cvt_pk_bf16_f32 v30, v27, v26
  v_and_b32 v31, 0xffff0000, v30
  v_lshlrev_b32 v30, 16, v30
  v_mul_f32 v31, s55, v31
  v_mul_f32 v30, s55, v30
  v_max3_f32 v14, v14, v30, v31
  v_cvt_pk_bf16_f32 v33, v30, v31
  s_waitcnt vmcnt(11)
  v_dot2_f32_bf16 v24, v64, v6, 0
  v_dot2_f32_bf16 v24, v65, v7, v24
  v_dot2_f32_bf16 v24, v66, v8, v24
  v_dot2_f32_bf16 v24, v67, v9, v24
  s_add_u32 s52, s54, 8192
  buffer_load_dwordx4 v[64:67], v1, s[12:15], s52 offen offset:2048 nt
  s_waitcnt vmcnt(11)
  v_dot2_f32_bf16 v25, v68, v6, 0
  v_dot2_f32_bf16 v25, v69, v7, v25
  v_dot2_f32_bf16 v25, v70, v8, v25
  v_dot2_f32_bf16 v25, v71, v9, v25
  s_add_u32 s52, s54, 8192
  buffer_load_dwordx4 v[68:71], v1, s[12:15], s52 offen offset:3072 nt
  v_add_f32_dpp v24, v24, v24 row_ror:8 row_mask:0xf bank_mask:0xf
  v_add_f32_dpp v25, v25, v25 row_ror:8 row_mask:0xf bank_mask:0xf
  s_nop 0
  v_add_f32_dpp v24, v24, v24 row_ror:4 row_mask:0xf bank_mask:0xf
  v_add_f32_dpp v25, v25, v25 row_ror:4 row_mask:0xf bank_mask:0xf
  s_nop 0
  v_add_f32_dpp v24, v24, v24 row_ror:2 row_mask:0xf bank_mask:0xf
  v_add_f32_dpp v25, v25, v25 row_ror:2 row_mask:0xf bank_mask:0xf
  s_nop 0
  v_add_f32_dpp v24, v24, v24 row_ror:1 row_mask:0xf bank_mask:0xf
  v_add_f32_dpp v25, v25, v25 row_ror:1 row_mask:0xf bank_mask:0xf
  v_cvt_pk_bf16_f32 v28, v25, v24
  v_and_b32 v29, 0xffff0000, v28
  v_lshlrev_b32 v28, 16, v28
  v_mul_f32 v29, s55, v29
  v_mul_f32 v28, s55, v28
  v_max3_f32 v14, v14, v28, v29
  v_cvt_pk_bf16_f32 v32, v28, v29
  v_mov_b32 v24, v14
  s_nop 1
  v_permlane16_swap_b32 v14, v24
  v_max_f32 v14, v14, v24
  v_mov_b32 v24, v14
  s_nop 1
  v_permlane32_swap_b32 v14, v24
  v_max_f32 v14, v14, v24
  v_cvt_pk_bf16_f32 v14, v14, v14
  v_and_b32 v14, 0xffff0000, v14
  v_mov_b32 v15, 0
  v_lshlrev_b32 v24, 16, v47
  v_and_b32 v25, 0xffff0000, v46
  v_lshlrev_b32 v26, 16, v46
  v_and_b32 v27, 0xffff0000, v45
  v_sub_f32 v24, v24, v14
  v_sub_f32 v25, v25, v14
  v_sub_f32 v26, v26, v14
  v_sub_f32 v27, v27, v14
  v_mul_f32 v24, s56, v24
  v_mul_f32 v25, s56, v25
  v_mul_f32 v26, s56, v26
  v_mul_f32 v27, s56, v27
  v_exp_f32 v24, v24
  v_exp_f32 v25, v25
  v_exp_f32 v26, v26
  v_exp_f32 v27, v27
  v_add_f32 v15, v15, v24
  v_add_f32 v15, v15, v25
  v_add_f32 v15, v15, v26
  v_add_f32 v15, v15, v27
  v_lshlrev_b32 v24, 16, v45
  v_and_b32 v25, 0xffff0000, v44
  v_lshlrev_b32 v26, 16, v44
  v_and_b32 v27, 0xffff0000, v43
  v_sub_f32 v24, v24, v14
  v_sub_f32 v25, v25, v14
  v_sub_f32 v26, v26, v14
  v_sub_f32 v27, v27, v14
  v_mul_f32 v24, s56, v24
  v_mul_f32 v25, s56, v25
  v_mul_f32 v26, s56, v26
  v_mul_f32 v27, s56, v27
  v_exp_f32 v24, v24
  v_exp_f32 v25, v25
  v_exp_f32 v26, v26
  v_exp_f32 v27, v27
  v_add_f32 v15, v15, v24
  v_add_f32 v15, v15, v25
  v_add_f32 v15, v15, v26
  v_add_f32 v15, v15, v27
  v_lshlrev_b32 v24, 16, v43
  v_and_b32 v25, 0xffff0000, v42
  v_lshlrev_b32 v26, 16, v42
  v_and_b32 v27, 0xffff0000, v41
  v_sub_f32 v24, v24, v14
  v_sub_f32 v25, v25, v14
  v_sub_f32 v26, v26, v14
  v_sub_f32 v27, v27, v14
  v_mul_f32 v24, s56, v24
  v_mul_f32 v25, s56, v25
  v_mul_f32 v26, s56, v26
  v_mul_f32 v27, s56, v27
  v_exp_f32 v24, v24
  v_exp_f32 v25, v25
  v_exp_f32 v26, v26
  v_exp_f32 v27, v27
  v_add_f32 v15, v15, v24
  v_add_f32 v15, v15, v25
  v_add_f32 v15, v15, v26
  v_add_f32 v15, v15, v27
  v_lshlrev_b32 v24, 16, v41
  v_and_b32 v25, 0xffff0000, v40
  v_lshlrev_b32 v26, 16, v40
  v_and_b32 v27, 0xffff0000, v39
  v_sub_f32 v24, v24, v14
  v_sub_f32 v25, v25, v14
  v_sub_f32 v26, v26, v14
  v_sub_f32 v27, v27, v14
  v_mul_f32 v24, s56, v24
  v_mul_f32 v25, s56, v25
  v_mul_f32 v26, s56, v26
  v_mul_f32 v27, s56, v27
  v_exp_f32 v24, v24
  v_exp_f32 v25, v25
  v_exp_f32 v26, v26
  v_exp_f32 v27, v27
  v_add_f32 v15, v15, v24
  v_add_f32 v15, v15, v25
  v_add_f32 v15, v15, v26
  v_add_f32 v15, v15, v27
  v_lshlrev_b32 v24, 16, v39
  v_and_b32 v25, 0xffff0000, v38
  v_lshlrev_b32 v26, 16, v38
  v_and_b32 v27, 0xffff0000, v37
  v_sub_f32 v24, v24, v14
  v_sub_f32 v25, v25, v14
  v_sub_f32 v26, v26, v14
  v_sub_f32 v27, v27, v14
  v_mul_f32 v24, s56, v24
  v_mul_f32 v25, s56, v25
  v_mul_f32 v26, s56, v26
  v_mul_f32 v27, s56, v27
  v_exp_f32 v24, v24
  v_exp_f32 v25, v25
  v_exp_f32 v26, v26
  v_exp_f32 v27, v27
  v_add_f32 v15, v15, v24
  v_add_f32 v15, v15, v25
  v_add_f32 v15, v15, v26
  v_add_f32 v15, v15, v27
  v_lshlrev_b32 v24, 16, v37
  v_and_b32 v25, 0xffff0000, v36
  v_lshlrev_b32 v26, 16, v36
  v_and_b32 v27, 0xffff0000, v35
  v_sub_f32 v24, v24, v14
  v_sub_f32 v25, v25, v14
  v_sub_f32 v26, v26, v14
  v_sub_f32 v27, v27, v14
  v_mul_f32 v24, s56, v24
  v_mul_f32 v25, s56, v25
  v_mul_f32 v26, s56, v26
  v_mul_f32 v27, s56, v27
  v_exp_f32 v24, v24
  v_exp_f32 v25, v25
  v_exp_f32 v26, v26
  v_exp_f32 v27, v27
  v_add_f32 v15, v15, v24
  v_add_f32 v15, v15, v25
  v_add_f32 v15, v15, v26
  v_add_f32 v15, v15, v27
  v_lshlrev_b32 v24, 16, v35
  v_and_b32 v25, 0xffff0000, v34
  v_lshlrev_b32 v26, 16, v34
  v_and_b32 v27, 0xffff0000, v33
  v_sub_f32 v24, v24, v14
  v_sub_f32 v25, v25, v14
  v_sub_f32 v26, v26, v14
  v_sub_f32 v27, v27, v14
  v_mul_f32 v24, s56, v24
  v_mul_f32 v25, s56, v25
  v_mul_f32 v26, s56, v26
  v_mul_f32 v27, s56, v27
  v_exp_f32 v24, v24
  v_exp_f32 v25, v25
  v_exp_f32 v26, v26
  v_exp_f32 v27, v27
  v_add_f32 v15, v15, v24
  v_add_f32 v15, v15, v25
  v_add_f32 v15, v15, v26
  v_add_f32 v15, v15, v27
  v_lshlrev_b32 v24, 16, v33
  v_and_b32 v25, 0xffff0000, v32
  v_lshlrev_b32 v26, 16, v32
  v_sub_f32 v24, v24, v14
  v_sub_f32 v25, v25, v14
  v_sub_f32 v26, v26, v14
  v_mul_f32 v24, s56, v24
  v_mul_f32 v25, s56, v25
  v_mul_f32 v26, s56, v26
  v_exp_f32 v24, v24
  v_exp_f32 v25, v25
  v_exp_f32 v26, v26
  v_add_f32 v15, v15, v24
  v_add_f32 v15, v15, v25
  v_add_f32 v15, v15, v26
  v_mov_b32 v24, v15
  s_nop 1
  v_permlane16_swap_b32 v15, v24
  v_add_f32 v15, v15, v24
  v_mov_b32 v24, v15
  s_nop 1
  v_permlane32_swap_b32 v15, v24
  v_add_f32 v15, v15, v24
  v_min_u32 v15, 0xfffffffe, v15
  s_mov_b64 exec, 1
  buffer_store_dwordx2 v[14:15], off, s[48:51], s67 sc1
  s_lshl_b32 s52, s3, 3
  v_mov_b32 v24, s52
  ds_write_b64 v24, v[14:15] offset:2880
  s_mov_b64 exec, -1
  s_waitcnt lgkmcnt(0)
  v_mov_b32 v24, 1
  v_mov_b32 v25, 2828
  s_mov_b64 exec, 1
  ds_add_u32 v25, v24
  s_mov_b64 exec, -1
  v_lshlrev_b32 v24, 16, v47
  v_sub_f32 v24, v24, v14
  v_mul_f32 v24, s56, v24
  v_exp_f32 v24, v24
  s_nop 0
  v_cvt_pk_bf16_f32 v25, v24, v24
  v_and_b32 v25, 0xffff0000, v25
  v_sub_f32 v25, v24, v25
  v_cndmask_b32 v24, v24, v25, s[58:59]
  v_cvt_pk_bf16_f32 v24, v24, v24
  v_and_b32 v16, v24, v2
  v_and_b32 v17, v24, v3
  v_and_b32 v18, v24, v4
  v_and_b32 v19, v24, v5
  v_and_b32 v24, 0xffff0000, v46
  v_sub_f32 v24, v24, v14
  v_mul_f32 v24, s56, v24
  v_exp_f32 v24, v24
  s_nop 0
  v_cvt_pk_bf16_f32 v25, v24, v24
  v_and_b32 v25, 0xffff0000, v25
  v_sub_f32 v25, v24, v25
  v_cndmask_b32 v24, v24, v25, s[58:59]
  v_cvt_pk_bf16_f32 v24, v24, v24
  v_and_b32 v20, v24, v2
  v_and_b32 v21, v24, v3
  v_and_b32 v22, v24, v4
  v_and_b32 v23, v24, v5
  s_waitcnt vmcnt(12)
  v_mfma_f32_16x16x32_bf16 v[10:13], v[16:19], v[72:75], v[10:13]
  s_add_u32 s52, s54, 12288
  buffer_load_dwordx4 v[72:75], v1, s[12:15], s52 offen offset:0 nt
  v_lshlrev_b32 v24, 16, v46
  v_sub_f32 v24, v24, v14
  v_mul_f32 v24, s56, v24
  v_exp_f32 v24, v24
  s_nop 0
  v_cvt_pk_bf16_f32 v25, v24, v24
  v_and_b32 v25, 0xffff0000, v25
  v_sub_f32 v25, v24, v25
  v_cndmask_b32 v24, v24, v25, s[58:59]
  v_cvt_pk_bf16_f32 v24, v24, v24
  v_and_b32 v16, v24, v2
  v_and_b32 v17, v24, v3
  v_and_b32 v18, v24, v4
  v_and_b32 v19, v24, v5
  s_waitcnt vmcnt(12)
  v_mfma_f32_16x16x32_bf16 v[10:13], v[20:23], v[76:79], v[10:13]
  s_add_u32 s52, s54, 12288
  buffer_load_dwordx4 v[76:79], v1, s[12:15], s52 offen offset:1024 nt
  v_and_b32 v24, 0xffff0000, v45
  v_sub_f32 v24, v24, v14
  v_mul_f32 v24, s56, v24
  v_exp_f32 v24, v24
  s_nop 0
  v_cvt_pk_bf16_f32 v25, v24, v24
  v_and_b32 v25, 0xffff0000, v25
  v_sub_f32 v25, v24, v25
  v_cndmask_b32 v24, v24, v25, s[58:59]
  v_cvt_pk_bf16_f32 v24, v24, v24
  v_and_b32 v20, v24, v2
  v_and_b32 v21, v24, v3
  v_and_b32 v22, v24, v4
  v_and_b32 v23, v24, v5
  s_waitcnt vmcnt(12)
  v_mfma_f32_16x16x32_bf16 v[10:13], v[16:19], v[80:83], v[10:13]
  s_add_u32 s52, s54, 12288
  buffer_load_dwordx4 v[80:83], v1, s[12:15], s52 offen offset:2048 nt
  v_lshlrev_b32 v24, 16, v45
  v_sub_f32 v24, v24, v14
  v_mul_f32 v24, s56, v24
  v_exp_f32 v24, v24
  s_nop 0
  v_cvt_pk_bf16_f32 v25, v24, v24
  v_and_b32 v25, 0xffff0000, v25
  v_sub_f32 v25, v24, v25
  v_cndmask_b32 v24, v24, v25, s[58:59]
  v_cvt_pk_bf16_f32 v24, v24, v24
  v_and_b32 v16, v24, v2
  v_and_b32 v17, v24, v3
  v_and_b32 v18, v24, v4
  v_and_b32 v19, v24, v5
  s_waitcnt vmcnt(12)
  v_mfma_f32_16x16x32_bf16 v[10:13], v[20:23], v[84:87], v[10:13]
  s_add_u32 s52, s54, 12288
  buffer_load_dwordx4 v[84:87], v1, s[12:15], s52 offen offset:3072 nt
  v_and_b32 v24, 0xffff0000, v44
  v_sub_f32 v24, v24, v14
  v_mul_f32 v24, s56, v24
  v_exp_f32 v24, v24
  s_nop 0
  v_cvt_pk_bf16_f32 v25, v24, v24
  v_and_b32 v25, 0xffff0000, v25
  v_sub_f32 v25, v24, v25
  v_cndmask_b32 v24, v24, v25, s[58:59]
  v_cvt_pk_bf16_f32 v24, v24, v24
  v_and_b32 v20, v24, v2
  v_and_b32 v21, v24, v3
  v_and_b32 v22, v24, v4
  v_and_b32 v23, v24, v5
  s_waitcnt vmcnt(12)
  v_mfma_f32_16x16x32_bf16 v[10:13], v[16:19], v[88:91], v[10:13]
  s_add_u32 s52, s54, 16384
  buffer_load_dwordx4 v[88:91], v1, s[12:15], s52 offen offset:0 nt
  v_lshlrev_b32 v24, 16, v44
  v_sub_f32 v24, v24, v14
  v_mul_f32 v24, s56, v24
  v_exp_f32 v24, v24
  s_nop 0
  v_cvt_pk_bf16_f32 v25, v24, v24
  v_and_b32 v25, 0xffff0000, v25
  v_sub_f32 v25, v24, v25
  v_cndmask_b32 v24, v24, v25, s[58:59]
  v_cvt_pk_bf16_f32 v24, v24, v24
  v_and_b32 v16, v24, v2
  v_and_b32 v17, v24, v3
  v_and_b32 v18, v24, v4
  v_and_b32 v19, v24, v5
  s_waitcnt vmcnt(12)
  v_mfma_f32_16x16x32_bf16 v[10:13], v[20:23], v[92:95], v[10:13]
  s_add_u32 s52, s54, 16384
  buffer_load_dwordx4 v[92:95], v1, s[12:15], s52 offen offset:1024 nt
  v_and_b32 v24, 0xffff0000, v43
  v_sub_f32 v24, v24, v14
  v_mul_f32 v24, s56, v24
  v_exp_f32 v24, v24
  s_nop 0
  v_cvt_pk_bf16_f32 v25, v24, v24
  v_and_b32 v25, 0xffff0000, v25
  v_sub_f32 v25, v24, v25
  v_cndmask_b32 v24, v24, v25, s[58:59]
  v_cvt_pk_bf16_f32 v24, v24, v24
  v_and_b32 v20, v24, v2
  v_and_b32 v21, v24, v3
  v_and_b32 v22, v24, v4
  v_and_b32 v23, v24, v5
  s_waitcnt vmcnt(12)
  v_mfma_f32_16x16x32_bf16 v[10:13], v[16:19], v[96:99], v[10:13]
  s_add_u32 s52, s54, 16384
  buffer_load_dwordx4 v[96:99], v1, s[12:15], s52 offen offset:2048 nt
  v_lshlrev_b32 v24, 16, v43
  v_sub_f32 v24, v24, v14
  v_mul_f32 v24, s56, v24
  v_exp_f32 v24, v24
  s_nop 0
  v_cvt_pk_bf16_f32 v25, v24, v24
  v_and_b32 v25, 0xffff0000, v25
  v_sub_f32 v25, v24, v25
  v_cndmask_b32 v24, v24, v25, s[58:59]
  v_cvt_pk_bf16_f32 v24, v24, v24
  v_and_b32 v16, v24, v2
  v_and_b32 v17, v24, v3
  v_and_b32 v18, v24, v4
  v_and_b32 v19, v24, v5
  s_waitcnt vmcnt(12)
  v_mfma_f32_16x16x32_bf16 v[10:13], v[20:23], v[52:55], v[10:13]
  s_add_u32 s52, s54, 16384
  buffer_load_dwordx4 v[52:55], v1, s[12:15], s52 offen offset:3072 nt
  v_and_b32 v24, 0xffff0000, v42
  v_sub_f32 v24, v24, v14
  v_mul_f32 v24, s56, v24
  v_exp_f32 v24, v24
  s_nop 0
  v_cvt_pk_bf16_f32 v25, v24, v24
  v_and_b32 v25, 0xffff0000, v25
  v_sub_f32 v25, v24, v25
  v_cndmask_b32 v24, v24, v25, s[58:59]
  v_cvt_pk_bf16_f32 v24, v24, v24
  v_and_b32 v20, v24, v2
  v_and_b32 v21, v24, v3
  v_and_b32 v22, v24, v4
  v_and_b32 v23, v24, v5
  s_waitcnt vmcnt(12)
  v_mfma_f32_16x16x32_bf16 v[10:13], v[16:19], v[56:59], v[10:13]
  s_add_u32 s52, s54, 20480
  buffer_load_dwordx4 v[56:59], v1, s[12:15], s52 offen offset:0 nt
  v_lshlrev_b32 v24, 16, v42
  v_sub_f32 v24, v24, v14
  v_mul_f32 v24, s56, v24
  v_exp_f32 v24, v24
  s_nop 0
  v_cvt_pk_bf16_f32 v25, v24, v24
  v_and_b32 v25, 0xffff0000, v25
  v_sub_f32 v25, v24, v25
  v_cndmask_b32 v24, v24, v25, s[58:59]
  v_cvt_pk_bf16_f32 v24, v24, v24
  v_and_b32 v16, v24, v2
  v_and_b32 v17, v24, v3
  v_and_b32 v18, v24, v4
  v_and_b32 v19, v24, v5
  s_waitcnt vmcnt(12)
  v_mfma_f32_16x16x32_bf16 v[10:13], v[20:23], v[60:63], v[10:13]
  s_add_u32 s52, s54, 20480
  buffer_load_dwordx4 v[60:63], v1, s[12:15], s52 offen offset:1024 nt
  v_and_b32 v24, 0xffff0000, v41
  v_sub_f32 v24, v24, v14
  v_mul_f32 v24, s56, v24
  v_exp_f32 v24, v24
  s_nop 0
  v_cvt_pk_bf16_f32 v25, v24, v24
  v_and_b32 v25, 0xffff0000, v25
  v_sub_f32 v25, v24, v25
  v_cndmask_b32 v24, v24, v25, s[58:59]
  v_cvt_pk_bf16_f32 v24, v24, v24
  v_and_b32 v20, v24, v2
  v_and_b32 v21, v24, v3
  v_and_b32 v22, v24, v4
  v_and_b32 v23, v24, v5
  s_waitcnt vmcnt(12)
  v_mfma_f32_16x16x32_bf16 v[10:13], v[16:19], v[64:67], v[10:13]
  s_add_u32 s52, s54, 20480
  buffer_load_dwordx4 v[64:67], v1, s[12:15], s52 offen offset:2048 nt
  v_lshlrev_b32 v24, 16, v41
  v_sub_f32 v24, v24, v14
  v_mul_f32 v24, s56, v24
  v_exp_f32 v24, v24
  s_nop 0
  v_cvt_pk_bf16_f32 v25, v24, v24
  v_and_b32 v25, 0xffff0000, v25
  v_sub_f32 v25, v24, v25
  v_cndmask_b32 v24, v24, v25, s[58:59]
  v_cvt_pk_bf16_f32 v24, v24, v24
  v_and_b32 v16, v24, v2
  v_and_b32 v17, v24, v3
  v_and_b32 v18, v24, v4
  v_and_b32 v19, v24, v5
  s_waitcnt vmcnt(12)
  v_mfma_f32_16x16x32_bf16 v[10:13], v[20:23], v[68:71], v[10:13]
  s_add_u32 s52, s54, 20480
  buffer_load_dwordx4 v[68:71], v1, s[12:15], s52 offen offset:3072 nt
  v_and_b32 v24, 0xffff0000, v40
  v_sub_f32 v24, v24, v14
  v_mul_f32 v24, s56, v24
  v_exp_f32 v24, v24
  s_nop 0
  v_cvt_pk_bf16_f32 v25, v24, v24
  v_and_b32 v25, 0xffff0000, v25
  v_sub_f32 v25, v24, v25
  v_cndmask_b32 v24, v24, v25, s[58:59]
  v_cvt_pk_bf16_f32 v24, v24, v24
  v_and_b32 v20, v24, v2
  v_and_b32 v21, v24, v3
  v_and_b32 v22, v24, v4
  v_and_b32 v23, v24, v5
  s_waitcnt vmcnt(11)
  v_mfma_f32_16x16x32_bf16 v[10:13], v[16:19], v[72:75], v[10:13]
  s_add_u32 s52, s54, 24576
  buffer_load_dwordx4 v[72:75], v1, s[12:15], s52 offen offset:0 nt
  v_lshlrev_b32 v24, 16, v40
  v_sub_f32 v24, v24, v14
  v_mul_f32 v24, s56, v24
  v_exp_f32 v24, v24
  s_nop 0
  v_cvt_pk_bf16_f32 v25, v24, v24
  v_and_b32 v25, 0xffff0000, v25
  v_sub_f32 v25, v24, v25
  v_cndmask_b32 v24, v24, v25, s[58:59]
  v_cvt_pk_bf16_f32 v24, v24, v24
  v_and_b32 v16, v24, v2
  v_and_b32 v17, v24, v3
  v_and_b32 v18, v24, v4
  v_and_b32 v19, v24, v5
  s_waitcnt vmcnt(11)
  v_mfma_f32_16x16x32_bf16 v[10:13], v[20:23], v[76:79], v[10:13]
  s_add_u32 s52, s54, 24576
  buffer_load_dwordx4 v[76:79], v1, s[12:15], s52 offen offset:1024 nt
  v_and_b32 v24, 0xffff0000, v39
  v_sub_f32 v24, v24, v14
  v_mul_f32 v24, s56, v24
  v_exp_f32 v24, v24
  s_nop 0
  v_cvt_pk_bf16_f32 v25, v24, v24
  v_and_b32 v25, 0xffff0000, v25
  v_sub_f32 v25, v24, v25
  v_cndmask_b32 v24, v24, v25, s[58:59]
  v_cvt_pk_bf16_f32 v24, v24, v24
  v_and_b32 v20, v24, v2
  v_and_b32 v21, v24, v3
  v_and_b32 v22, v24, v4
  v_and_b32 v23, v24, v5
  s_waitcnt vmcnt(11)
  v_mfma_f32_16x16x32_bf16 v[10:13], v[16:19], v[80:83], v[10:13]
  s_add_u32 s52, s54, 24576
  buffer_load_dwordx4 v[80:83], v1, s[12:15], s52 offen offset:2048 nt
  v_lshlrev_b32 v24, 16, v39
  v_sub_f32 v24, v24, v14
  v_mul_f32 v24, s56, v24
  v_exp_f32 v24, v24
  s_nop 0
  v_cvt_pk_bf16_f32 v25, v24, v24
  v_and_b32 v25, 0xffff0000, v25
  v_sub_f32 v25, v24, v25
  v_cndmask_b32 v24, v24, v25, s[58:59]
  v_cvt_pk_bf16_f32 v24, v24, v24
  v_and_b32 v16, v24, v2
  v_and_b32 v17, v24, v3
  v_and_b32 v18, v24, v4
  v_and_b32 v19, v24, v5
  s_waitcnt vmcnt(11)
  v_mfma_f32_16x16x32_bf16 v[10:13], v[20:23], v[84:87], v[10:13]
  s_add_u32 s52, s54, 24576
  buffer_load_dwordx4 v[84:87], v1, s[12:15], s52 offen offset:3072 nt
  v_and_b32 v24, 0xffff0000, v38
  v_sub_f32 v24, v24, v14
  v_mul_f32 v24, s56, v24
  v_exp_f32 v24, v24
  s_nop 0
  v_cvt_pk_bf16_f32 v25, v24, v24
  v_and_b32 v25, 0xffff0000, v25
  v_sub_f32 v25, v24, v25
  v_cndmask_b32 v24, v24, v25, s[58:59]
  v_cvt_pk_bf16_f32 v24, v24, v24
  v_and_b32 v20, v24, v2
  v_and_b32 v21, v24, v3
  v_and_b32 v22, v24, v4
  v_and_b32 v23, v24, v5
  s_waitcnt vmcnt(11)
  v_mfma_f32_16x16x32_bf16 v[10:13], v[16:19], v[88:91], v[10:13]
  s_add_u32 s52, s54, 28672
  buffer_load_dwordx4 v[88:91], v1, s[12:15], s52 offen offset:0 nt
  v_lshlrev_b32 v24, 16, v38
  v_sub_f32 v24, v24, v14
  v_mul_f32 v24, s56, v24
  v_exp_f32 v24, v24
  s_nop 0
  v_cvt_pk_bf16_f32 v25, v24, v24
  v_and_b32 v25, 0xffff0000, v25
  v_sub_f32 v25, v24, v25
  v_cndmask_b32 v24, v24, v25, s[58:59]
  v_cvt_pk_bf16_f32 v24, v24, v24
  v_and_b32 v16, v24, v2
  v_and_b32 v17, v24, v3
  v_and_b32 v18, v24, v4
  v_and_b32 v19, v24, v5
  s_waitcnt vmcnt(11)
  v_mfma_f32_16x16x32_bf16 v[10:13], v[20:23], v[92:95], v[10:13]
  s_add_u32 s52, s54, 28672
  buffer_load_dwordx4 v[92:95], v1, s[12:15], s52 offen offset:1024 nt
  v_and_b32 v24, 0xffff0000, v37
  v_sub_f32 v24, v24, v14
  v_mul_f32 v24, s56, v24
  v_exp_f32 v24, v24
  s_nop 0
  v_cvt_pk_bf16_f32 v25, v24, v24
  v_and_b32 v25, 0xffff0000, v25
  v_sub_f32 v25, v24, v25
  v_cndmask_b32 v24, v24, v25, s[58:59]
  v_cvt_pk_bf16_f32 v24, v24, v24
  v_and_b32 v20, v24, v2
  v_and_b32 v21, v24, v3
  v_and_b32 v22, v24, v4
  v_and_b32 v23, v24, v5
  s_waitcnt vmcnt(11)
  v_mfma_f32_16x16x32_bf16 v[10:13], v[16:19], v[96:99], v[10:13]
  s_add_u32 s52, s54, 28672
  buffer_load_dwordx4 v[96:99], v1, s[12:15], s52 offen offset:2048 nt
  s_nop 5
  s_branch L_final
L_path2:
  s_add_u32 s52, s54, 0
  buffer_load_dwordx4 v[76:79], v1, s[8:11], s52 offen offset:0 nt
  s_add_u32 s52, s54, 0
  buffer_load_dwordx4 v[80:83], v1, s[8:11], s52 offen offset:1024 nt
  s_add_u32 s52, s54, 0
  buffer_load_dwordx4 v[84:87], v1, s[8:11], s52 offen offset:2048 nt
  s_add_u32 s52, s54, 0
  buffer_load_dwordx4 v[88:91], v1, s[8:11], s52 offen offset:3072 nt
  s_add_u32 s52, s54, 4096
  buffer_load_dwordx4 v[92:95], v1, s[8:11], s52 offen offset:0 nt
  s_add_u32 s52, s54, 4096
  buffer_load_dwordx4 v[96:99], v1, s[8:11], s52 offen offset:1024 nt
  s_add_u32 s52, s54, 4096
  buffer_load_dwordx4 v[52:55], v1, s[8:11], s52 offen offset:2048 nt
  s_add_u32 s52, s54, 4096
  buffer_load_dwordx4 v[56:59], v1, s[8:11], s52 offen offset:3072 nt
  s_add_u32 s52, s54, 8192
  buffer_load_dwordx4 v[60:63], v1, s[8:11], s52 offen offset:0 nt
  s_add_u32 s52, s54, 8192
  buffer_load_dwordx4 v[64:67], v1, s[8:11], s52 offen offset:1024 nt
  s_add_u32 s52, s54, 8192
  buffer_load_dwordx4 v[68:71], v1, s[8:11], s52 offen offset:2048 nt
  s_add_u32 s52, s54, 8192
  buffer_load_dwordx4 v[72:75], v1, s[8:11], s52 offen offset:3072 nt
  v_mov_b32 v25, 2824
  s_mov_b32 s61, 0
  s_nop 0
L_lw_19r:
  ds_read_b32 v24, v25
  s_waitcnt lgkmcnt(0)
  v_readfirstlane_b32 s52, v24
  s_cmp_ge_u32 s52, 1
  s_nop 3
  s_cbranch_scc1 L_lw_19o
  s_sleep 4
  s_add_u32 s61, s61, 1
  s_cmp_lt_u32 s61, 1200000
  s_cbranch_scc1 L_lw_19r
L_lw_19o:
  v_and_b32 v24, 15, v0
  v_lshlrev_b32 v24, 4, v24
  ds_read_b128 v[6:9], v24 offset:2560
  v_mov_b32 v14, 0xff800000
  v_mov_b32 v10, 0
  v_mov_b32 v11, 0
  v_mov_b32 v12, 0
  v_mov_b32 v13, 0
  s_waitcnt lgkmcnt(0)
  s_waitcnt vmcnt(11)
  v_dot2_f32_bf16 v24, v76, v6, 0
  v_dot2_f32_bf16 v24, v77, v7, v24
  v_dot2_f32_bf16 v24, v78, v8, v24
  v_dot2_f32_bf16 v24, v79, v9, v24
  s_add_u32 s52, s54, 12288
  buffer_load_dwordx4 v[76:79], v1, s[8:11], s52 offen offset:0 nt
  s_nop 0
  v_add_f32_dpp v24, v24, v24 row_ror:8 row_mask:0xf bank_mask:0xf
  s_nop 1
  v_add_f32_dpp v24, v24, v24 row_ror:4 row_mask:0xf bank_mask:0xf
  s_nop 1
  v_add_f32_dpp v24, v24, v24 row_ror:2 row_mask:0xf bank_mask:0xf
  s_nop 1
  v_add_f32_dpp v24, v24, v24 row_ror:1 row_mask:0xf bank_mask:0xf
  v_cvt_pk_bf16_f32 v28, v24, v24
  v_and_b32 v29, 0xffff0000, v28
  v_lshlrev_b32 v28, 16, v28
  v_mul_f32 v29, s55, v29
  v_mul_f32 v28, s55, v28
  v_max3_f32 v14, v14, v28, v29
  v_cvt_pk_bf16_f32 v48, v28, v29
  s_waitcnt vmcnt(11)
  v_dot2_f32_bf16 v24, v80, v6, 0
  v_dot2_f32_bf16 v24, v81, v7, v24
  v_dot2_f32_bf16 v24, v82, v8, v24
  v_dot2_f32_bf16 v24, v83, v9, v24
  s_add_u32 s52, s54, 12288
  buffer_load_dwordx4 v[80:83], v1, s[8:11], s52 offen offset:1024 nt
  s_waitcnt vmcnt(11)
  v_dot2_f32_bf16 v25, v84, v6, 0
  v_dot2_f32_bf16 v25, v85, v7, v25
  v_dot2_f32_bf16 v25, v86, v8, v25
  v_dot2_f32_bf16 v25, v87, v9, v25
  s_add_u32 s52, s54, 12288
  buffer_load_dwordx4 v[84:87], v1, s[8:11], s52 offen offset:2048 nt
  s_waitcnt vmcnt(11)
  v_dot2_f32_bf16 v26, v88, v6, 0
  v_dot2_f32_bf16 v26, v89, v7, v26
  v_dot2_f32_bf16 v26, v90, v8, v26
  v_dot2_f32_bf16 v26, v91, v9, v26
  s_add_u32 s52, s54, 12288
  buffer_load_dwordx4 v[88:91], v1, s[8:11], s52 offen offset:3072 nt
  s_waitcnt vmcnt(11)
  v_dot2_f32_bf16 v27, v92, v6, 0
  v_dot2_f32_bf16 v27, v93, v7, v27
  v_dot2_f32_bf16 v27, v94, v8, v27
  v_dot2_f32_bf16 v27, v95, v9, v27
  s_add_u32 s52, s54, 16384
  buffer_load_dwordx4 v[92:95], v1, s[8:11], s52 offen offset:0 nt
  v_add_f32_dpp v24, v24, v24 row_ror:8 row_mask:0xf bank_mask:0xf
  v_add_f32_dpp v25, v25, v25 row_ror:8 row_mask:0xf bank_mask:0xf
  v_add_f32_dpp v26, v26, v26 row_ror:8 row_mask:0xf bank_mask:0xf
  v_add_f32_dpp v27, v27, v27 row_ror:8 row_mask:0xf bank_mask:0xf
  v_add_f32_dpp v24, v24, v24 row_ror:4 row_mask:0xf bank_mask:0xf
  v_add_f32_dpp v25, v25, v25 row_ror:4 row_mask:0xf bank_mask:0xf
  v_add_f32_dpp v26, v26, v26 row_ror:4 row_mask:0xf bank_mask:0xf
  v_add_f32_dpp v27, v27, v27 row_ror:4 row_mask:0xf bank_mask:0xf
  v_add_f32_dpp v24, v24, v24 row_ror:2 row_mask:0xf bank_mask:0xf
  v_add_f32_dpp v25, v25, v25 row_ror:2 row_mask:0xf bank_mask:0xf
  v_add_f32_dpp v26, v26, v26 row_ror:2 row_mask:0xf bank_mask:0xf
  v_add_f32_dpp v27, v27, v27 row_ror:2 row_mask:0xf bank_mask:0xf
  v_add_f32_dpp v24, v24, v24 row_ror:1 row_mask:0xf bank_mask:0xf
  v_add_f32_dpp v25, v25, v25 row_ror:1 row_mask:0xf bank_mask:0xf
  v_add_f32_dpp v26, v26, v26 row_ror:1 row_mask:0xf bank_mask:0xf
  v_add_f32_dpp v27, v27, v27 row_ror:1 row_mask:0xf bank_mask:0xf
  v_cvt_pk_bf16_f32 v28, v25, v24
  v_and_b32 v29, 0xffff0000, v28
  v_lshlrev_b32 v28, 16, v28
  v_mul_f32 v29, s55, v29
  v_mul_f32 v28, s55, v28
  v_max3_f32 v14, v14, v28, v29
  v_cvt_pk_bf16_f32 v47, v28, v29
  v_cvt_pk_bf16_f32 v30, v27, v26
  v_and_b32 v31, 0xffff0000, v30
  v_lshlrev_b32 v30, 16, v30
  v_mul_f32 v31, s55, v31
  v_mul_f32 v30, s55, v30
  v_max3_f32 v14, v14, v30, v31
  v_cvt_pk_bf16_f32 v46, v30, v31
  s_waitcnt vmcnt(11)
  v_dot2_f32_bf16 v24, v96, v6, 0
  v_dot2_f32_bf16 v24, v97, v7, v24
  v_dot2_f32_bf16 v24, v98, v8, v24
  v_dot2_f32_bf16 v24, v99, v9, v24
  s_add_u32 s52, s54, 16384
  buffer_load_dwordx4 v[96:99], v1, s[8:11], s52 offen offset:1024 nt
  s_waitcnt vmcnt(11)
  v_dot2_f32_bf16 v25, v52, v6, 0
  v_dot2_f32_bf16 v25, v53, v7, v25
  v_dot2_f32_bf16 v25, v54, v8, v25
  v_dot2_f32_bf16 v25, v55, v9, v25
  s_add_u32 s52, s54, 16384
  buffer_load_dwordx4 v[52:55], v1, s[8:11], s52 offen offset:2048 nt
  s_waitcnt vmcnt(11)
  v_dot2_f32_bf16 v26, v56, v6, 0
  v_dot2_f32_bf16 v26, v57, v7, v26
  v_dot2_f32_bf16 v26, v58, v8, v26
  v_dot2_f32_bf16 v26, v59, v9, v26
  s_add_u32 s52, s54, 16384
  buffer_load_dwordx4 v[56:59], v1, s[8:11], s52 offen offset:3072 nt
  s_waitcnt vmcnt(11)
  v_dot2_f32_bf16 v27, v60, v6, 0
  v_dot2_f32_bf16 v27, v61, v7, v27
  v_dot2_f32_bf16 v27, v62, v8, v27
  v_dot2_f32_bf16 v27, v63, v9, v27
  s_add_u32 s52, s54, 20480
  buffer_load_dwordx4 v[60:63], v1, s[8:11], s52 offen offset:0 nt
  v_add_f32_dpp v24, v24, v24 row_ror:8 row_mask:0xf bank_mask:0xf
  v_add_f32_dpp v25, v25, v25 row_ror:8 row_mask:0xf bank_mask:0xf
  v_add_f32_dpp v26, v26, v26 row_ror:8 row_mask:0xf bank_mask:0xf
  v_add_f32_dpp v27, v27, v27 row_ror:8 row_mask:0xf bank_mask:0xf
  v_add_f32_dpp v24, v24, v24 row_ror:4 row_mask:0xf bank_mask:0xf
  v_add_f32_dpp v25, v25, v25 row_ror:4 row_mask:0xf bank_mask:0xf
  v_add_f32_dpp v26, v26, v26 row_ror:4 row_mask:0xf bank_mask:0xf
  v_add_f32_dpp v27, v27, v27 row_ror:4 row_mask:0xf bank_mask:0xf
  v_add_f32_dpp v24, v24, v24 row_ror:2 row_mask:0xf bank_mask:0xf
  v_add_f32_dpp v25, v25, v25 row_ror:2 row_mask:0xf bank_mask:0xf
  v_add_f32_dpp v26, v26, v26 row_ror:2 row_mask:0xf bank_mask:0xf
  v_add_f32_dpp v27, v27, v27 row_ror:2 row_mask:0xf bank_mask:0xf
  v_add_f32_dpp v24, v24, v24 row_ror:1 row_mask:0xf bank_mask:0xf
  v_add_f32_dpp v25, v25, v25 row_ror:1 row_mask:0xf bank_mask:0xf
  v_add_f32_dpp v26, v26, v26 row_ror:1 row_mask:0xf bank_mask:0xf
  v_add_f32_dpp v27, v27, v27 row_ror:1 row_mask:0xf bank_mask:0xf
  v_cvt_pk_bf16_f32 v28, v25, v24
  v_and_b32 v29, 0xffff0000, v28
  v_lshlrev_b32 v28, 16, v28
  v_mul_f32 v29, s55, v29
  v_mul_f32 v28, s55, v28
  v_max3_f32 v14, v14, v28, v29
  v_cvt_pk_bf16_f32 v45, v28, v29
  v_cvt_pk_bf16_f32 v30, v27, v26
  v_and_b32 v31, 0xffff0000, v30
  v_lshlrev_b32 v30, 16, v30
  v_mul_f32 v31, s55, v31
  v_mul_f32 v30, s55, v30
  v_max3_f32 v14, v14, v30, v31
  v_cvt_pk_bf16_f32 v44, v30, v31
  s_waitcnt vmcnt(11)
  v_dot2_f32_bf16 v24, v64, v6, 0
  v_dot2_f32_bf16 v24, v65, v7, v24
  v_dot2_f32_bf16 v24, v66, v8, v24
  v_dot2_f32_bf16 v24, v67, v9, v24
  s_add_u32 s52, s54, 20480
  buffer_load_dwordx4 v[64:67], v1, s[8:11], s52 offen offset:1024 nt
  s_waitcnt vmcnt(11)
  v_dot2_f32_bf16 v25, v68, v6, 0
  v_dot2_f32_bf16 v25, v69, v7, v25
  v_dot2_f32_bf16 v25, v70, v8, v25
  v_dot2_f32_bf16 v25, v71, v9, v25
  s_add_u32 s52, s54, 20480
  buffer_load_dwordx4 v[68:71], v1, s[8:11], s52 offen offset:2048 nt
  s_waitcnt vmcnt(11)
  v_dot2_f32_bf16 v26, v72, v6, 0
  v_dot2_f32_bf16 v26, v73, v7, v26
  v_dot2_f32_bf16 v26, v74, v8, v26
  v_dot2_f32_bf16 v26, v75, v9, v26
  s_add_u32 s52, s54, 20480
  buffer_load_dwordx4 v[72:75], v1, s[8:11], s52 offen offset:3072 nt
  s_waitcnt vmcnt(11)
  v_dot2_f32_bf16 v27, v76, v6, 0
  v_dot2_f32_bf16 v27, v77, v7, v27
  v_dot2_f32_bf16 v27, v78, v8, v27
  v_dot2_f32_bf16 v27, v79, v9, v27
  s_add_u32 s52, s54, 24576
  buffer_load_dwordx4 v[76:79], v1, s[8:11], s52 offen offset:0 nt
  v_add_f32_dpp v24, v24, v24 row_ror:8 row_mask:0xf bank_mask:0xf
  v_add_f32_dpp v25, v25, v25 row_ror:8 row_mask:0xf bank_mask:0xf
  v_add_f32_dpp v26, v26, v26 row_ror:8 row_mask:0xf bank_mask:0xf
  v_add_f32_dpp v27, v27, v27 row_ror:8 row_mask:0xf bank_mask:0xf
  v_add_f32_dpp v24, v24, v24 row_ror:4 row_mask:0xf bank_mask:0xf
  v_add_f32_dpp v25, v25, v25 row_ror:4 row_mask:0xf bank_mask:0xf
  v_add_f32_dpp v26, v26, v26 row_ror:4 row_mask:0xf bank_mask:0xf
  v_add_f32_dpp v27, v27, v27 row_ror:4 row_mask:0xf bank_mask:0xf
  v_add_f32_dpp v24, v24, v24 row_ror:2 row_mask:0xf bank_mask:0xf
  v_add_f32_dpp v25, v25, v25 row_ror:2 row_mask:0xf bank_mask:0xf
  v_add_f32_dpp v26, v26, v26 row_ror:2 row_mask:0xf bank_mask:0xf
  v_add_f32_dpp v27, v27, v27 row_ror:2 row_mask:0xf bank_mask:0xf
  v_add_f32_dpp v24, v24, v24 row_ror:1 row_mask:0xf bank_mask:0xf
  v_add_f32_dpp v25, v25, v25 row_ror:1 row_mask:0xf bank_mask:0xf
  v_add_f32_dpp v26, v26, v26 row_ror:1 row_mask:0xf bank_mask:0xf
  v_add_f32_dpp v27, v27, v27 row_ror:1 row_mask:0xf bank_mask:0xf
  v_cvt_pk_bf16_f32 v28, v25, v24
  v_and_b32 v29, 0xffff0000, v28
  v_lshlrev_b32 v28, 16, v28
  v_mul_f32 v29, s55, v29
  v_mul_f32 v28, s55, v28
  v_max3_f32 v14, v14, v28, v29
  v_cvt_pk_bf16_f32 v43, v28, v29
  v_cvt_pk_bf16_f32 v30, v27, v26
  v_and_b32 v31, 0xffff0000, v30
  v_lshlrev_b32 v30, 16, v30
  v_mul_f32 v31, s55, v31
  v_mul_f32 v30, s55, v30
  v_max3_f32 v14, v14, v30, v31
  v_cvt_pk_bf16_f32 v42, v30, v31
  s_waitcnt vmcnt(11)
  v_dot2_f32_bf16 v24, v80, v6, 0
  v_dot2_f32_bf16 v24, v81, v7, v24
  v_dot2_f32_bf16 v24, v82, v8, v24
  v_dot2_f32_bf16 v24, v83, v9, v24
  s_add_u32 s52, s54, 24576
  buffer_load_dwordx4 v[80:83], v1, s[8:11], s52 offen offset:1024 nt
  s_waitcnt vmcnt(11)
  v_dot2_f32_bf16 v25, v84, v6, 0
  v_dot2_f32_bf16 v25, v85, v7, v25
  v_dot2_f32_bf16 v25, v86, v8, v25
  v_dot2_f32_bf16 v25, v87, v9, v25
  s_add_u32 s52, s54, 24576
  buffer_load_dwordx4 v[84:87], v1, s[8:11], s52 offen offset:2048 nt
  s_waitcnt vmcnt(11)
  v_dot2_f32_bf16 v26, v88, v6, 0
  v_dot2_f32_bf16 v26, v89, v7, v26
  v_dot2_f32_bf16 v26, v90, v8, v26
  v_dot2_f32_bf16 v26, v91, v9, v26
  s_add_u32 s52, s54, 24576
  buffer_load_dwordx4 v[88:91], v1, s[8:11], s52 offen offset:3072 nt
  s_waitcnt vmcnt(11)
  v_dot2_f32_bf16 v27, v92, v6, 0
  v_dot2_f32_bf16 v27, v93, v7, v27
  v_dot2_f32_bf16 v27, v94, v8, v27
  v_dot2_f32_bf16 v27, v95, v9, v27
  s_add_u32 s52, s54, 28672
  buffer_load_dwordx4 v[92:95], v1, s[8:11], s52 offen offset:0 nt
  v_add_f32_dpp v24, v24, v24 row_ror:8 row_mask:0xf bank_mask:0xf
  v_add_f32_dpp v25, v25, v25 row_ror:8 row_mask:0xf bank_mask:0xf
  v_add_f32_dpp v26, v26, v26 row_ror:8 row_mask:0xf bank_mask:0xf
  v_add_f32_dpp v27, v27, v27 row_ror:8 row_mask:0xf bank_mask:0xf
  v_add_f32_dpp v24, v24, v24 row_ror:4 row_mask:0xf bank_mask:0xf
  v_add_f32_dpp v25, v25, v25 row_ror:4 row_mask:0xf bank_mask:0xf
  v_add_f32_dpp v26, v26, v26 row_ror:4 row_mask:0xf bank_mask:0xf
  v_add_f32_dpp v27, v27, v27 row_ror:4 row_mask:0xf bank_mask:0xf
  v_add_f32_dpp v24, v24, v24 row_ror:2 row_mask:0xf bank_mask:0xf
  v_add_f32_dpp v25, v25, v25 row_ror:2 row_mask:0xf bank_mask:0xf
  v_add_f32_dpp v26, v26, v26 row_ror:2 row_mask:0xf bank_mask:0xf
  v_add_f32_dpp v27, v27, v27 row_ror:2 row_mask:0xf bank_mask:0xf
  v_add_f32_dpp v24, v24, v24 row_ror:1 row_mask:0xf bank_mask:0xf
  v_add_f32_dpp v25, v25, v25 row_ror:1 row_mask:0xf bank_mask:0xf
  v_add_f32_dpp v26, v26, v26 row_ror:1 row_mask:0xf bank_mask:0xf
  v_add_f32_dpp v27, v27, v27 row_ror:1 row_mask:0xf bank_mask:0xf
  v_cvt_pk_bf16_f32 v28, v25, v24
  v_and_b32 v29, 0xffff0000, v28
  v_lshlrev_b32 v28, 16, v28
  v_mul_f32 v29, s55, v29
  v_mul_f32 v28, s55, v28
  v_max3_f32 v14, v14, v28, v29
  v_cvt_pk_bf16_f32 v41, v28, v29
  v_cvt_pk_bf16_f32 v30, v27, v26
  v_and_b32 v31, 0xffff0000, v30
  v_lshlrev_b32 v30, 16, v30
  v_mul_f32 v31, s55, v31
  v_mul_f32 v30, s55, v30
  v_max3_f32 v14, v14, v30, v31
  v_cvt_pk_bf16_f32 v40, v30, v31
  s_waitcnt vmcnt(11)
  v_dot2_f32_bf16 v24, v96, v6, 0
  v_dot2_f32_bf16 v24, v97, v7, v24
  v_dot2_f32_bf16 v24, v98, v8, v24
  v_dot2_f32_bf16 v24, v99, v9, v24
  s_add_u32 s52, s54, 28672
  buffer_load_dwordx4 v[96:99], v1, s[8:11], s52 offen offset:1024 nt
  s_waitcnt vmcnt(11)
  v_dot2_f32_bf16 v25, v52, v6, 0
  v_dot2_f32_bf16 v25, v53, v7, v25
  v_dot2_f32_bf16 v25, v54, v8, v25
  v_dot2_f32_bf16 v25, v55, v9, v25
  s_add_u32 s52, s54, 28672
  buffer_load_dwordx4 v[52:55], v1, s[8:11], s52 offen offset:2048 nt
  s_waitcnt vmcnt(11)
  v_dot2_f32_bf16 v26, v56, v6, 0
  v_dot2_f32_bf16 v26, v57, v7, v26
  v_dot2_f32_bf16 v26, v58, v8, v26
  v_dot2_f32_bf16 v26, v59, v9, v26
  s_add_u32 s52, s54, 28672
  buffer_load_dwordx4 v[56:59], v1, s[8:11], s52 offen offset:3072 nt
  s_waitcnt vmcnt(11)
  v_dot2_f32_bf16 v27, v60, v6, 0
  v_dot2_f32_bf16 v27, v61, v7, v27
  v_dot2_f32_bf16 v27, v62, v8, v27
  v_dot2_f32_bf16 v27, v63, v9, v27
  s_add_u32 s52, s54, 32768
  buffer_load_dwordx4 v[60:63], v1, s[8:11], s52 offen offset:0 nt
  v_add_f32_dpp v24, v24, v24 row_ror:8 row_mask:0xf bank_mask:0xf
  v_add_f32_dpp v25, v25, v25 row_ror:8 row_mask:0xf bank_mask:0xf
  v_add_f32_dpp v26, v26, v26 row_ror:8 row_mask:0xf bank_mask:0xf
  v_add_f32_dpp v27, v27, v27 row_ror:8 row_mask:0xf bank_mask:0xf
  v_add_f32_dpp v24, v24, v24 row_ror:4 row_mask:0xf bank_mask:0xf
  v_add_f32_dpp v25, v25, v25 row_ror:4 row_mask:0xf bank_mask:0xf
  v_add_f32_dpp v26, v26, v26 row_ror:4 row_mask:0xf bank_mask:0xf
  v_add_f32_dpp v27, v27, v27 row_ror:4 row_mask:0xf bank_mask:0xf
  v_add_f32_dpp v24, v24, v24 row_ror:2 row_mask:0xf bank_mask:0xf
  v_add_f32_dpp v25, v25, v25 row_ror:2 row_mask:0xf bank_mask:0xf
  v_add_f32_dpp v26, v26, v26 row_ror:2 row_mask:0xf bank_mask:0xf
  v_add_f32_dpp v27, v27, v27 row_ror:2 row_mask:0xf bank_mask:0xf
  v_add_f32_dpp v24, v24, v24 row_ror:1 row_mask:0xf bank_mask:0xf
  v_add_f32_dpp v25, v25, v25 row_ror:1 row_mask:0xf bank_mask:0xf
  v_add_f32_dpp v26, v26, v26 row_ror:1 row_mask:0xf bank_mask:0xf
  v_add_f32_dpp v27, v27, v27 row_ror:1 row_mask:0xf bank_mask:0xf
  v_cvt_pk_bf16_f32 v28, v25, v24
  v_and_b32 v29, 0xffff0000, v28
  v_lshlrev_b32 v28, 16, v28
  v_mul_f32 v29, s55, v29
  v_mul_f32 v28, s55, v28
  v_max3_f32 v14, v14, v28, v29
  v_cvt_pk_bf16_f32 v39, v28, v29
  v_cvt_pk_bf16_f32 v30, v27, v26
  v_and_b32 v31, 0xffff0000, v30
  v_lshlrev_b32 v30, 16, v30
  v_mul_f32 v31, s55, v31
  v_mul_f32 v30, s55, v30
  v_max3_f32 v14, v14, v30, v31
  v_cvt_pk_bf16_f32 v38, v30, v31
  s_waitcnt vmcnt(11)
  v_dot2_f32_bf16 v24, v64, v6, 0
  v_dot2_f32_bf16 v24, v65, v7, v24
  v_dot2_f32_bf16 v24, v66, v8, v24
  v_dot2_f32_bf16 v24, v67, v9, v24
  s_add_u32 s52, s54, 0
  buffer_load_dwordx4 v[64:67], v1, s[12:15], s52 offen offset:0 nt
  s_waitcnt vmcnt(11)
  v_dot2_f32_bf16 v25, v68, v6, 0
  v_dot2_f32_bf16 v25, v69, v7, v25
  v_dot2_f32_bf16 v25, v70, v8, v25
  v_dot2_f32_bf16 v25, v71, v9, v25
  s_add_u32 s52, s54, 0
  buffer_load_dwordx4 v[68:71], v1, s[12:15], s52 offen offset:1024 nt
  s_waitcnt vmcnt(11)
  v_dot2_f32_bf16 v26, v72, v6, 0
  v_dot2_f32_bf16 v26, v73, v7, v26
  v_dot2_f32_bf16 v26, v74, v8, v26
  v_dot2_f32_bf16 v26, v75, v9, v26
  s_add_u32 s52, s54, 0
  buffer_load_dwordx4 v[72:75], v1, s[12:15], s52 offen offset:2048 nt
  s_waitcnt vmcnt(11)
  v_dot2_f32_bf16 v27, v76, v6, 0
  v_dot2_f32_bf16 v27, v77, v7, v27
  v_dot2_f32_bf16 v27, v78, v8, v27
  v_dot2_f32_bf16 v27, v79, v9, v27
  s_add_u32 s52, s54, 0
  buffer_load_dwordx4 v[76:79], v1, s[12:15], s52 offen offset:3072 nt
  v_add_f32_dpp v24, v24, v24 row_ror:8 row_mask:0xf bank_mask:0xf
  v_add_f32_dpp v25, v25, v25 row_ror:8 row_mask:0xf bank_mask:0xf
  v_add_f32_dpp v26, v26, v26 row_ror:8 row_mask:0xf bank_mask:0xf
  v_add_f32_dpp v27, v27, v27 row_ror:8 row_mask:0xf bank_mask:0xf
  v_add_f32_dpp v24, v24, v24 row_ror:4 row_mask:0xf bank_mask:0xf
  v_add_f32_dpp v25, v25, v25 row_ror:4 row_mask:0xf bank_mask:0xf
  v_add_f32_dpp v26, v26, v26 row_ror:4 row_mask:0xf bank_mask:0xf
  v_add_f32_dpp v27, v27, v27 row_ror:4 row_mask:0xf bank_mask:0xf
  v_add_f32_dpp v24, v24, v24 row_ror:2 row_mask:0xf bank_mask:0xf
  v_add_f32_dpp v25, v25, v25 row_ror:2 row_mask:0xf bank_mask:0xf
  v_add_f32_dpp v26, v26, v26 row_ror:2 row_mask:0xf bank_mask:0xf
  v_add_f32_dpp v27, v27, v27 row_ror:2 row_mask:0xf bank_mask:0xf
  v_add_f32_dpp v24, v24, v24 row_ror:1 row_mask:0xf bank_mask:0xf
  v_add_f32_dpp v25, v25, v25 row_ror:1 row_mask:0xf bank_mask:0xf
  v_add_f32_dpp v26, v26, v26 row_ror:1 row_mask:0xf bank_mask:0xf
  v_add_f32_dpp v27, v27, v27 row_ror:1 row_mask:0xf bank_mask:0xf
  v_cvt_pk_bf16_f32 v28, v25, v24
  v_and_b32 v29, 0xffff0000, v28
  v_lshlrev_b32 v28, 16, v28
  v_mul_f32 v29, s55, v29
  v_mul_f32 v28, s55, v28
  v_max3_f32 v14, v14, v28, v29
  v_cvt_pk_bf16_f32 v37, v28, v29
  v_cvt_pk_bf16_f32 v30, v27, v26
  v_and_b32 v31, 0xffff0000, v30
  v_lshlrev_b32 v30, 16, v30
  v_mul_f32 v31, s55, v31
  v_mul_f32 v30, s55, v30
  v_max3_f32 v14, v14, v30, v31
  v_cvt_pk_bf16_f32 v36, v30, v31
  s_waitcnt vmcnt(11)
  v_dot2_f32_bf16 v24, v80, v6, 0
  v_dot2_f32_bf16 v24, v81, v7, v24
  v_dot2_f32_bf16 v24, v82, v8, v24
  v_dot2_f32_bf16 v24, v83, v9, v24
  s_add_u32 s52, s54, 4096
  buffer_load_dwordx4 v[80:83], v1, s[12:15], s52 offen offset:0 nt
  s_waitcnt vmcnt(11)
  v_dot2_f32_bf16 v25, v84, v6, 0
  v_dot2_f32_bf16 v25, v85, v7, v25
  v_dot2_f32_bf16 v25, v86, v8, v25
  v_dot2_f32_bf16 v25, v87, v9, v25
  s_add_u32 s52, s54, 4096
  buffer_load_dwordx4 v[84:87], v1, s[12:15], s52 offen offset:1024 nt
  s_waitcnt vmcnt(11)
  v_dot2_f32_bf16 v26, v88, v6, 0
  v_dot2_f32_bf16 v26, v89, v7, v26
  v_dot2_f32_bf16 v26, v90, v8, v26
  v_dot2_f32_bf16 v26, v91, v9, v26
  s_add_u32 s52, s54, 4096
  buffer_load_dwordx4 v[88:91], v1, s[12:15], s52 offen offset:2048 nt
  s_waitcnt vmcnt(11)
  v_dot2_f32_bf16 v27, v92, v6, 0
  v_dot2_f32_bf16 v27, v93, v7, v27
  v_dot2_f32_bf16 v27, v94, v8, v27
  v_dot2_f32_bf16 v27, v95, v9, v27
  s_add_u32 s52, s54, 4096
  buffer_load_dwordx4 v[92:95], v1, s[12:15], s52 offen offset:3072 nt
  v_add_f32_dpp v24, v24, v24 row_ror:8 row_mask:0xf bank_mask:0xf
  v_add_f32_dpp v25, v25, v25 row_ror:8 row_mask:0xf bank_mask:0xf
  v_add_f32_dpp v26, v26, v26 row_ror:8 row_mask:0xf bank_mask:0xf
  v_add_f32_dpp v27, v27, v27 row_ror:8 row_mask:0xf bank_mask:0xf
  v_add_f32_dpp v24, v24, v24 row_ror:4 row_mask:0xf bank_mask:0xf
  v_add_f32_dpp v25, v25, v25 row_ror:4 row_mask:0xf bank_mask:0xf
  v_add_f32_dpp v26, v26, v26 row_ror:4 row_mask:0xf bank_mask:0xf
  v_add_f32_dpp v27, v27, v27 row_ror:4 row_mask:0xf bank_mask:0xf
  v_add_f32_dpp v24, v24, v24 row_ror:2 row_mask:0xf bank_mask:0xf
  v_add_f32_dpp v25, v25, v25 row_ror:2 row_mask:0xf bank_mask:0xf
  v_add_f32_dpp v26, v26, v26 row_ror:2 row_mask:0xf bank_mask:0xf
  v_add_f32_dpp v27, v27, v27 row_ror:2 row_mask:0xf bank_mask:0xf
  v_add_f32_dpp v24, v24, v24 row_ror:1 row_mask:0xf bank_mask:0xf
  v_add_f32_dpp v25, v25, v25 row_ror:1 row_mask:0xf bank_mask:0xf
  v_add_f32_dpp v26, v26, v26 row_ror:1 row_mask:0xf bank_mask:0xf
  v_add_f32_dpp v27, v27, v27 row_ror:1 row_mask:0xf bank_mask:0xf
  v_cvt_pk_bf16_f32 v28, v25, v24
  v_and_b32 v29, 0xffff0000, v28
  v_lshlrev_b32 v28, 16, v28
  v_mul_f32 v29, s55, v29
  v_mul_f32 v28, s55, v28
  v_max3_f32 v14, v14, v28, v29
  v_cvt_pk_bf16_f32 v35, v28, v29
  v_cvt_pk_bf16_f32 v30, v27, v26
  v_and_b32 v31, 0xffff0000, v30
  v_lshlrev_b32 v30, 16, v30
  v_mul_f32 v31, s55, v31
  v_mul_f32 v30, s55, v30
  v_max3_f32 v14, v14, v30, v31
  v_cvt_pk_bf16_f32 v34, v30, v31
  s_waitcnt vmcnt(11)
  v_dot2_f32_bf16 v24, v96, v6, 0
  v_dot2_f32_bf16 v24, v97, v7, v24
  v_dot2_f32_bf16 v24, v98, v8, v24
  v_dot2_f32_bf16 v24, v99, v9, v24
  s_add_u32 s52, s54, 8192
  buffer_load_dwordx4 v[96:99], v1, s[12:15], s52 offen offset:0 nt
  s_waitcnt vmcnt(11)
  v_dot2_f32_bf16 v25, v52, v6, 0
  v_dot2_f32_bf16 v25, v53, v7, v25
  v_dot2_f32_bf16 v25, v54, v8, v25
  v_dot2_f32_bf16 v25, v55, v9, v25
  s_add_u32 s52, s54, 8192
  buffer_load_dwordx4 v[52:55], v1, s[12:15], s52 offen offset:1024 nt
  s_waitcnt vmcnt(11)
  v_dot2_f32_bf16 v26, v56, v6, 0
  v_dot2_f32_bf16 v26, v57, v7, v26
  v_dot2_f32_bf16 v26, v58, v8, v26
  v_dot2_f32_bf16 v26, v59, v9, v26
  s_add_u32 s52, s54, 8192
  buffer_load_dwordx4 v[56:59], v1, s[12:15], s52 offen offset:2048 nt
  s_waitcnt vmcnt(11)
  v_dot2_f32_bf16 v27, v60, v6, 0
  v_dot2_f32_bf16 v27, v61, v7, v27
  v_dot2_f32_bf16 v27, v62, v8, v27
  v_dot2_f32_bf16 v27, v63, v9, v27
  s_add_u32 s52, s54, 8192
  buffer_load_dwordx4 v[60:63], v1, s[12:15], s52 offen offset:3072 nt
  v_add_f32_dpp v24, v24, v24 row_ror:8 row_mask:0xf bank_mask:0xf
  v_add_f32_dpp v25, v25, v25 row_ror:8 row_mask:0xf bank_mask:0xf
  v_add_f32_dpp v26, v26, v26 row_ror:8 row_mask:0xf bank_mask:0xf
  v_add_f32_dpp v27, v27, v27 row_ror:8 row_mask:0xf bank_mask:0xf
  v_add_f32_dpp v24, v24, v24 row_ror:4 row_mask:0xf bank_mask:0xf
  v_add_f32_dpp v25, v25, v25 row_ror:4 row_mask:0xf bank_mask:0xf
  v_add_f32_dpp v26, v26, v26 row_ror:4 row_mask:0xf bank_mask:0xf
  v_add_f32_dpp v27, v27, v27 row_ror:4 row_mask:0xf bank_mask:0xf
  v_add_f32_dpp v24, v24, v24 row_ror:2 row_mask:0xf bank_mask:0xf
  v_add_f32_dpp v25, v25, v25 row_ror:2 row_mask:0xf bank_mask:0xf
  v_add_f32_dpp v26, v26, v26 row_ror:2 row_mask:0xf bank_mask:0xf
  v_add_f32_dpp v27, v27, v27 row_ror:2 row_mask:0xf bank_mask:0xf
  v_add_f32_dpp v24, v24, v24 row_ror:1 row_mask:0xf bank_mask:0xf
  v_add_f32_dpp v25, v25, v25 row_ror:1 row_mask:0xf bank_mask:0xf
  v_add_f32_dpp v26, v26, v26 row_ror:1 row_mask:0xf bank_mask:0xf
  v_add_f32_dpp v27, v27, v27 row_ror:1 row_mask:0xf bank_mask:0xf
  v_cvt_pk_bf16_f32 v28, v25, v24
  v_and_b32 v29, 0xffff0000, v28
  v_lshlrev_b32 v28, 16, v28
  v_mul_f32 v29, s55, v29
  v_mul_f32 v28, s55, v28
  v_max3_f32 v14, v14, v28, v29
  v_cvt_pk_bf16_f32 v33, v28, v29
  v_cvt_pk_bf16_f32 v30, v27, v26
  v_and_b32 v31, 0xffff0000, v30
  v_lshlrev_b32 v30, 16, v30
  v_mul_f32 v31, s55, v31
  v_mul_f32 v30, s55, v30
  v_max3_f32 v14, v14, v30, v31
  v_cvt_pk_bf16_f32 v32, v30, v31
  v_mov_b32 v24, v14
  s_nop 1
  v_permlane16_swap_b32 v14, v24
  v_max_f32 v14, v14, v24
  v_mov_b32 v24, v14
  s_nop 1
  v_permlane32_swap_b32 v14, v24
  v_max_f32 v14, v14, v24
  v_cvt_pk_bf16_f32 v14, v14, v14
  v_and_b32 v14, 0xffff0000, v14
  v_mov_b32 v15, 0
  v_lshlrev_b32 v24, 16, v48
  v_and_b32 v25, 0xffff0000, v47
  v_lshlrev_b32 v26, 16, v47
  v_and_b32 v27, 0xffff0000, v46
  v_sub_f32 v24, v24, v14
  v_sub_f32 v25, v25, v14
  v_sub_f32 v26, v26, v14
  v_sub_f32 v27, v27, v14
  v_mul_f32 v24, s56, v24
  v_mul_f32 v25, s56, v25
  v_mul_f32 v26, s56, v26
  v_mul_f32 v27, s56, v27
  v_exp_f32 v24, v24
  v_exp_f32 v25, v25
  v_exp_f32 v26, v26
  v_exp_f32 v27, v27
  v_add_f32 v15, v15, v24
  v_add_f32 v15, v15, v25
  v_add_f32 v15, v15, v26
  v_add_f32 v15, v15, v27
  v_lshlrev_b32 v24, 16, v46
  v_and_b32 v25, 0xffff0000, v45
  v_lshlrev_b32 v26, 16, v45
  v_and_b32 v27, 0xffff0000, v44
  v_sub_f32 v24, v24, v14
  v_sub_f32 v25, v25, v14
  v_sub_f32 v26, v26, v14
  v_sub_f32 v27, v27, v14
  v_mul_f32 v24, s56, v24
  v_mul_f32 v25, s56, v25
  v_mul_f32 v26, s56, v26
  v_mul_f32 v27, s56, v27
  v_exp_f32 v24, v24
  v_exp_f32 v25, v25
  v_exp_f32 v26, v26
  v_exp_f32 v27, v27
  v_add_f32 v15, v15, v24
  v_add_f32 v15, v15, v25
  v_add_f32 v15, v15, v26
  v_add_f32 v15, v15, v27
  v_lshlrev_b32 v24, 16, v44
  v_and_b32 v25, 0xffff0000, v43
  v_lshlrev_b32 v26, 16, v43
  v_and_b32 v27, 0xffff0000, v42
  v_sub_f32 v24, v24, v14
  v_sub_f32 v25, v25, v14
  v_sub_f32 v26, v26, v14
  v_sub_f32 v27, v27, v14
  v_mul_f32 v24, s56, v24
  v_mul_f32 v25, s56, v25
  v_mul_f32 v26, s56, v26
  v_mul_f32 v27, s56, v27
  v_exp_f32 v24, v24
  v_exp_f32 v25, v25
  v_exp_f32 v26, v26
  v_exp_f32 v27, v27
  v_add_f32 v15, v15, v24
  v_add_f32 v15, v15, v25
  v_add_f32 v15, v15, v26
  v_add_f32 v15, v15, v27
  v_lshlrev_b32 v24, 16, v42
  v_and_b32 v25, 0xffff0000, v41
  v_lshlrev_b32 v26, 16, v41
  v_and_b32 v27, 0xffff0000, v40
  v_sub_f32 v24, v24, v14
  v_sub_f32 v25, v25, v14
  v_sub_f32 v26, v26, v14
  v_sub_f32 v27, v27, v14
  v_mul_f32 v24, s56, v24
  v_mul_f32 v25, s56, v25
  v_mul_f32 v26, s56, v26
  v_mul_f32 v27, s56, v27
  v_exp_f32 v24, v24
  v_exp_f32 v25, v25
  v_exp_f32 v26, v26
  v_exp_f32 v27, v27
  v_add_f32 v15, v15, v24
  v_add_f32 v15, v15, v25
  v_add_f32 v15, v15, v26
  v_add_f32 v15, v15, v27
  v_lshlrev_b32 v24, 16, v40
  v_and_b32 v25, 0xffff0000, v39
  v_lshlrev_b32 v26, 16, v39
  v_and_b32 v27, 0xffff0000, v38
  v_sub_f32 v24, v24, v14
  v_sub_f32 v25, v25, v14
  v_sub_f32 v26, v26, v14
  v_sub_f32 v27, v27, v14
  v_mul_f32 v24, s56, v24
  v_mul_f32 v25, s56, v25
  v_mul_f32 v26, s56, v26
  v_mul_f32 v27, s56, v27
  v_exp_f32 v24, v24
  v_exp_f32 v25, v25
  v_exp_f32 v26, v26
  v_exp_f32 v27, v27
  v_add_f32 v15, v15, v24
  v_add_f32 v15, v15, v25
  v_add_f32 v15, v15, v26
  v_add_f32 v15, v15, v27
  v_lshlrev_b32 v24, 16, v38
  v_and_b32 v25, 0xffff0000, v37
  v_lshlrev_b32 v26, 16, v37
  v_and_b32 v27, 0xffff0000, v36
  v_sub_f32 v24, v24, v14
  v_sub_f32 v25, v25, v14
  v_sub_f32 v26, v26, v14
  v_sub_f32 v27, v27, v14
  v_mul_f32 v24, s56, v24
  v_mul_f32 v25, s56, v25
  v_mul_f32 v26, s56, v26
  v_mul_f32 v27, s56, v27
  v_exp_f32 v24, v24
  v_exp_f32 v25, v25
  v_exp_f32 v26, v26
  v_exp_f32 v27, v27
  v_add_f32 v15, v15, v24
  v_add_f32 v15, v15, v25
  v_add_f32 v15, v15, v26
  v_add_f32 v15, v15, v27
  v_lshlrev_b32 v24, 16, v36
  v_and_b32 v25, 0xffff0000, v35
  v_lshlrev_b32 v26, 16, v35
  v_and_b32 v27, 0xffff0000, v34
  v_sub_f32 v24, v24, v14
  v_sub_f32 v25, v25, v14
  v_sub_f32 v26, v26, v14
  v_sub_f32 v27, v27, v14
  v_mul_f32 v24, s56, v24
  v_mul_f32 v25, s56, v25
  v_mul_f32 v26, s56, v26
  v_mul_f32 v27, s56, v27
  v_exp_f32 v24, v24
  v_exp_f32 v25, v25
  v_exp_f32 v26, v26
  v_exp_f32 v27, v27
  v_add_f32 v15, v15, v24
  v_add_f32 v15, v15, v25
  v_add_f32 v15, v15, v26
  v_add_f32 v15, v15, v27
  v_lshlrev_b32 v24, 16, v34
  v_and_b32 v25, 0xffff0000, v33
  v_lshlrev_b32 v26, 16, v33
  v_and_b32 v27, 0xffff0000, v32
  v_sub_f32 v24, v24, v14
  v_sub_f32 v25, v25, v14
  v_sub_f32 v26, v26, v14
  v_sub_f32 v27, v27, v14
  v_mul_f32 v24, s56, v24
  v_mul_f32 v25, s56, v25
  v_mul_f32 v26, s56, v26
  v_mul_f32 v27, s56, v27
  v_exp_f32 v24, v24
  v_exp_f32 v25, v25
  v_exp_f32 v26, v26
  v_exp_f32 v27, v27
  v_add_f32 v15, v15, v24
  v_add_f32 v15, v15, v25
  v_add_f32 v15, v15, v26
  v_add_f32 v15, v15, v27
  v_lshlrev_b32 v24, 16, v32
  v_sub_f32 v24, v24, v14
  v_mul_f32 v24, s56, v24
  v_exp_f32 v24, v24
  s_nop 0
  v_add_f32 v15, v15, v24
  v_mov_b32 v24, v15
  s_nop 1
  v_permlane16_swap_b32 v15, v24
  v_add_f32 v15, v15, v24
  v_mov_b32 v24, v15
  s_nop 1
  v_permlane32_swap_b32 v15, v24
  v_add_f32 v15, v15, v24
  v_min_u32 v15, 0xfffffffe, v15
  s_mov_b64 exec, 1
  buffer_store_dwordx2 v[14:15], off, s[48:51], s67 sc1
  s_lshl_b32 s52, s3, 3
  v_mov_b32 v24, s52
  ds_write_b64 v24, v[14:15] offset:2880
  s_mov_b64 exec, -1
  s_waitcnt lgkmcnt(0)
  v_mov_b32 v24, 1
  v_mov_b32 v25, 2828
  s_mov_b64 exec, 1
  ds_add_u32 v25, v24
  s_mov_b64 exec, -1
  v_lshlrev_b32 v24, 16, v48
  v_sub_f32 v24, v24, v14
  v_mul_f32 v24, s56, v24
  v_exp_f32 v24, v24
  s_nop 0
  v_cvt_pk_bf16_f32 v25, v24, v24
  v_and_b32 v25, 0xffff0000, v25
  v_sub_f32 v25, v24, v25
  v_cndmask_b32 v24, v24, v25, s[58:59]
  v_cvt_pk_bf16_f32 v24, v24, v24
  v_and_b32 v16, v24, v2
  v_and_b32 v17, v24, v3
  v_and_b32 v18, v24, v4
  v_and_b32 v19, v24, v5
  v_and_b32 v24, 0xffff0000, v47
  v_sub_f32 v24, v24, v14
  v_mul_f32 v24, s56, v24
  v_exp_f32 v24, v24
  s_nop 0
  v_cvt_pk_bf16_f32 v25, v24, v24
  v_and_b32 v25, 0xffff0000, v25
  v_sub_f32 v25, v24, v25
  v_cndmask_b32 v24, v24, v25, s[58:59]
  v_cvt_pk_bf16_f32 v24, v24, v24
  v_and_b32 v20, v24, v2
  v_and_b32 v21, v24, v3
  v_and_b32 v22, v24, v4
  v_and_b32 v23, v24, v5
  s_waitcnt vmcnt(12)
  v_mfma_f32_16x16x32_bf16 v[10:13], v[16:19], v[64:67], v[10:13]
  s_add_u32 s52, s54, 12288
  buffer_load_dwordx4 v[64:67], v1, s[12:15], s52 offen offset:0 nt
  v_lshlrev_b32 v24, 16, v47
  v_sub_f32 v24, v24, v14
  v_mul_f32 v24, s56, v24
  v_exp_f32 v24, v24
  s_nop 0
  v_cvt_pk_bf16_f32 v25, v24, v24
  v_and_b32 v25, 0xffff0000, v25
  v_sub_f32 v25, v24, v25
  v_cndmask_b32 v24, v24, v25, s[58:59]
  v_cvt_pk_bf16_f32 v24, v24, v24
  v_and_b32 v16, v24, v2
  v_and_b32 v17, v24, v3
  v_and_b32 v18, v24, v4
  v_and_b32 v19, v24, v5
  s_waitcnt vmcnt(12)
  v_mfma_f32_16x16x32_bf16 v[10:13], v[20:23], v[68:71], v[10:13]
  s_add_u32 s52, s54, 12288
  buffer_load_dwordx4 v[68:71], v1, s[12:15], s52 offen offset:1024 nt
  v_and_b32 v24, 0xffff0000, v46
  v_sub_f32 v24, v24, v14
  v_mul_f32 v24, s56, v24
  v_exp_f32 v24, v24
  s_nop 0
  v_cvt_pk_bf16_f32 v25, v24, v24
  v_and_b32 v25, 0xffff0000, v25
  v_sub_f32 v25, v24, v25
  v_cndmask_b32 v24, v24, v25, s[58:59]
  v_cvt_pk_bf16_f32 v24, v24, v24
  v_and_b32 v20, v24, v2
  v_and_b32 v21, v24, v3
  v_and_b32 v22, v24, v4
  v_and_b32 v23, v24, v5
  s_waitcnt vmcnt(12)
  v_mfma_f32_16x16x32_bf16 v[10:13], v[16:19], v[72:75], v[10:13]
  s_add_u32 s52, s54, 12288
  buffer_load_dwordx4 v[72:75], v1, s[12:15], s52 offen offset:2048 nt
  v_lshlrev_b32 v24, 16, v46
  v_sub_f32 v24, v24, v14
  v_mul_f32 v24, s56, v24
  v_exp_f32 v24, v24
  s_nop 0
  v_cvt_pk_bf16_f32 v25, v24, v24
  v_and_b32 v25, 0xffff0000, v25
  v_sub_f32 v25, v24, v25
  v_cndmask_b32 v24, v24, v25, s[58:59]
  v_cvt_pk_bf16_f32 v24, v24, v24
  v_and_b32 v16, v24, v2
  v_and_b32 v17, v24, v3
  v_and_b32 v18, v24, v4
  v_and_b32 v19, v24, v5
  s_waitcnt vmcnt(12)
  v_mfma_f32_16x16x32_bf16 v[10:13], v[20:23], v[76:79], v[10:13]
  s_add_u32 s52, s54, 12288
  buffer_load_dwordx4 v[76:79], v1, s[12:15], s52 offen offset:3072 nt
  v_and_b32 v24, 0xffff0000, v45
  v_sub_f32 v24, v24, v14
  v_mul_f32 v24, s56, v24
  v_exp_f32 v24, v24
  s_nop 0
  v_cvt_pk_bf16_f32 v25, v24, v24
  v_and_b32 v25, 0xffff0000, v25
  v_sub_f32 v25, v24, v25
  v_cndmask_b32 v24, v24, v25, s[58:59]
  v_cvt_pk_bf16_f32 v24, v24, v24
  v_and_b32 v20, v24, v2
  v_and_b32 v21, v24, v3
  v_and_b32 v22, v24, v4
  v_and_b32 v23, v24, v5
  s_waitcnt vmcnt(12)
  v_mfma_f32_16x16x32_bf16 v[10:13], v[16:19], v[80:83], v[10:13]
  s_add_u32 s52, s54, 16384
  buffer_load_dwordx4 v[80:83], v1, s[12:15], s52 offen offset:0 nt
  v_lshlrev_b32 v24, 16, v45
  v_sub_f32 v24, v24, v14
  v_mul_f32 v24, s56, v24
  v_exp_f32 v24, v24
  s_nop 0
  v_cvt_pk_bf16_f32 v25, v24, v24
  v_and_b32 v25, 0xffff0000, v25
  v_sub_f32 v25, v24, v25
  v_cndmask_b32 v24, v24, v25, s[58:59]
  v_cvt_pk_bf16_f32 v24, v24, v24
  v_and_b32 v16, v24, v2
  v_and_b32 v17, v24, v3
  v_and_b32 v18, v24, v4
  v_and_b32 v19, v24, v5
  s_waitcnt vmcnt(12)
  v_mfma_f32_16x16x32_bf16 v[10:13], v[20:23], v[84:87], v[10:13]
  s_add_u32 s52, s54, 16384
  buffer_load_dwordx4 v[84:87], v1, s[12:15], s52 offen offset:1024 nt
  v_and_b32 v24, 0xffff0000, v44
  v_sub_f32 v24, v24, v14
  v_mul_f32 v24, s56, v24
  v_exp_f32 v24, v24
  s_nop 0
  v_cvt_pk_bf16_f32 v25, v24, v24
  v_and_b32 v25, 0xffff0000, v25
  v_sub_f32 v25, v24, v25
  v_cndmask_b32 v24, v24, v25, s[58:59]
  v_cvt_pk_bf16_f32 v24, v24, v24
  v_and_b32 v20, v24, v2
  v_and_b32 v21, v24, v3
  v_and_b32 v22, v24, v4
  v_and_b32 v23, v24, v5
  s_waitcnt vmcnt(12)
  v_mfma_f32_16x16x32_bf16 v[10:13], v[16:19], v[88:91], v[10:13]
  s_add_u32 s52, s54, 16384
  buffer_load_dwordx4 v[88:91], v1, s[12:15], s52 offen offset:2048 nt
  v_lshlrev_b32 v24, 16, v44
  v_sub_f32 v24, v24, v14
  v_mul_f32 v24, s56, v24
  v_exp_f32 v24, v24
  s_nop 0
  v_cvt_pk_bf16_f32 v25, v24, v24
  v_and_b32 v25, 0xffff0000, v25
  v_sub_f32 v25, v24, v25
  v_cndmask_b32 v24, v24, v25, s[58:59]
  v_cvt_pk_bf16_f32 v24, v24, v24
  v_and_b32 v16, v24, v2
  v_and_b32 v17, v24, v3
  v_and_b32 v18, v24, v4
  v_and_b32 v19, v24, v5
  s_waitcnt vmcnt(12)
  v_mfma_f32_16x16x32_bf16 v[10:13], v[20:23], v[92:95], v[10:13]
  s_add_u32 s52, s54, 16384
  buffer_load_dwordx4 v[92:95], v1, s[12:15], s52 offen offset:3072 nt
  v_and_b32 v24, 0xffff0000, v43
  v_sub_f32 v24, v24, v14
  v_mul_f32 v24, s56, v24
  v_exp_f32 v24, v24
  s_nop 0
  v_cvt_pk_bf16_f32 v25, v24, v24
  v_and_b32 v25, 0xffff0000, v25
  v_sub_f32 v25, v24, v25
  v_cndmask_b32 v24, v24, v25, s[58:59]
  v_cvt_pk_bf16_f32 v24, v24, v24
  v_and_b32 v20, v24, v2
  v_and_b32 v21, v24, v3
  v_and_b32 v22, v24, v4
  v_and_b32 v23, v24, v5
  s_waitcnt vmcnt(12)
  v_mfma_f32_16x16x32_bf16 v[10:13], v[16:19], v[96:99], v[10:13]
  s_add_u32 s52, s54, 20480
  buffer_load_dwordx4 v[96:99], v1, s[12:15], s52 offen offset:0 nt
  v_lshlrev_b32 v24, 16, v43
  v_sub_f32 v24, v24, v14
  v_mul_f32 v24, s56, v24
  v_exp_f32 v24, v24
  s_nop 0
  v_cvt_pk_bf16_f32 v25, v24, v24
  v_and_b32 v25, 0xffff0000, v25
  v_sub_f32 v25, v24, v25
  v_cndmask_b32 v24, v24, v25, s[58:59]
  v_cvt_pk_bf16_f32 v24, v24, v24
  v_and_b32 v16, v24, v2
  v_and_b32 v17, v24, v3
  v_and_b32 v18, v24, v4
  v_and_b32 v19, v24, v5
  s_waitcnt vmcnt(12)
  v_mfma_f32_16x16x32_bf16 v[10:13], v[20:23], v[52:55], v[10:13]
  s_add_u32 s52, s54, 20480
  buffer_load_dwordx4 v[52:55], v1, s[12:15], s52 offen offset:1024 nt
  v_and_b32 v24, 0xffff0000, v42
  v_sub_f32 v24, v24, v14
  v_mul_f32 v24, s56, v24
  v_exp_f32 v24, v24
  s_nop 0
  v_cvt_pk_bf16_f32 v25, v24, v24
  v_and_b32 v25, 0xffff0000, v25
  v_sub_f32 v25, v24, v25
  v_cndmask_b32 v24, v24, v25, s[58:59]
  v_cvt_pk_bf16_f32 v24, v24, v24
  v_and_b32 v20, v24, v2
  v_and_b32 v21, v24, v3
  v_and_b32 v22, v24, v4
  v_and_b32 v23, v24, v5
  s_waitcnt vmcnt(12)
  v_mfma_f32_16x16x32_bf16 v[10:13], v[16:19], v[56:59], v[10:13]
  s_add_u32 s52, s54, 20480
  buffer_load_dwordx4 v[56:59], v1, s[12:15], s52 offen offset:2048 nt
  v_lshlrev_b32 v24, 16, v42
  v_sub_f32 v24, v24, v14
  v_mul_f32 v24, s56, v24
  v_exp_f32 v24, v24
  s_nop 0
  v_cvt_pk_bf16_f32 v25, v24, v24
  v_and_b32 v25, 0xffff0000, v25
  v_sub_f32 v25, v24, v25
  v_cndmask_b32 v24, v24, v25, s[58:59]
  v_cvt_pk_bf16_f32 v24, v24, v24
  v_and_b32 v16, v24, v2
  v_and_b32 v17, v24, v3
  v_and_b32 v18, v24, v4
  v_and_b32 v19, v24, v5
  s_waitcnt vmcnt(12)
  v_mfma_f32_16x16x32_bf16 v[10:13], v[20:23], v[60:63], v[10:13]
  s_add_u32 s52, s54, 20480
  buffer_load_dwordx4 v[60:63], v1, s[12:15], s52 offen offset:3072 nt
  v_and_b32 v24, 0xffff0000, v41
  v_sub_f32 v24, v24, v14
  v_mul_f32 v24, s56, v24
  v_exp_f32 v24, v24
  s_nop 0
  v_cvt_pk_bf16_f32 v25, v24, v24
  v_and_b32 v25, 0xffff0000, v25
  v_sub_f32 v25, v24, v25
  v_cndmask_b32 v24, v24, v25, s[58:59]
  v_cvt_pk_bf16_f32 v24, v24, v24
  v_and_b32 v20, v24, v2
  v_and_b32 v21, v24, v3
  v_and_b32 v22, v24, v4
  v_and_b32 v23, v24, v5
  s_waitcnt vmcnt(11)
  v_mfma_f32_16x16x32_bf16 v[10:13], v[16:19], v[64:67], v[10:13]
  s_add_u32 s52, s54, 24576
  buffer_load_dwordx4 v[64:67], v1, s[12:15], s52 offen offset:0 nt
  v_lshlrev_b32 v24, 16, v41
  v_sub_f32 v24, v24, v14
  v_mul_f32 v24, s56, v24
  v_exp_f32 v24, v24
  s_nop 0
  v_cvt_pk_bf16_f32 v25, v24, v24
  v_and_b32 v25, 0xffff0000, v25
  v_sub_f32 v25, v24, v25
  v_cndmask_b32 v24, v24, v25, s[58:59]
  v_cvt_pk_bf16_f32 v24, v24, v24
  v_and_b32 v16, v24, v2
  v_and_b32 v17, v24, v3
  v_and_b32 v18, v24, v4
  v_and_b32 v19, v24, v5
  s_waitcnt vmcnt(11)
  v_mfma_f32_16x16x32_bf16 v[10:13], v[20:23], v[68:71], v[10:13]
  s_add_u32 s52, s54, 24576
  buffer_load_dwordx4 v[68:71], v1, s[12:15], s52 offen offset:1024 nt
  v_and_b32 v24, 0xffff0000, v40
  v_sub_f32 v24, v24, v14
  v_mul_f32 v24, s56, v24
  v_exp_f32 v24, v24
  s_nop 0
  v_cvt_pk_bf16_f32 v25, v24, v24
  v_and_b32 v25, 0xffff0000, v25
  v_sub_f32 v25, v24, v25
  v_cndmask_b32 v24, v24, v25, s[58:59]
  v_cvt_pk_bf16_f32 v24, v24, v24
  v_and_b32 v20, v24, v2
  v_and_b32 v21, v24, v3
  v_and_b32 v22, v24, v4
  v_and_b32 v23, v24, v5
  s_waitcnt vmcnt(11)
  v_mfma_f32_16x16x32_bf16 v[10:13], v[16:19], v[72:75], v[10:13]
  s_add_u32 s52, s54, 24576
  buffer_load_dwordx4 v[72:75], v1, s[12:15], s52 offen offset:2048 nt
  v_lshlrev_b32 v24, 16, v40
  v_sub_f32 v24, v24, v14
  v_mul_f32 v24, s56, v24
  v_exp_f32 v24, v24
  s_nop 0
  v_cvt_pk_bf16_f32 v25, v24, v24
  v_and_b32 v25, 0xffff0000, v25
  v_sub_f32 v25, v24, v25
  v_cndmask_b32 v24, v24, v25, s[58:59]
  v_cvt_pk_bf16_f32 v24, v24, v24
  v_and_b32 v16, v24, v2
  v_and_b32 v17, v24, v3
  v_and_b32 v18, v24, v4
  v_and_b32 v19, v24, v5
  s_waitcnt vmcnt(11)
  v_mfma_f32_16x16x32_bf16 v[10:13], v[20:23], v[76:79], v[10:13]
  s_add_u32 s52, s54, 24576
  buffer_load_dwordx4 v[76:79], v1, s[12:15], s52 offen offset:3072 nt
  v_and_b32 v24, 0xffff0000, v39
  v_sub_f32 v24, v24, v14
  v_mul_f32 v24, s56, v24
  v_exp_f32 v24, v24
  s_nop 0
  v_cvt_pk_bf16_f32 v25, v24, v24
  v_and_b32 v25, 0xffff0000, v25
  v_sub_f32 v25, v24, v25
  v_cndmask_b32 v24, v24, v25, s[58:59]
  v_cvt_pk_bf16_f32 v24, v24, v24
  v_and_b32 v20, v24, v2
  v_and_b32 v21, v24, v3
  v_and_b32 v22, v24, v4
  v_and_b32 v23, v24, v5
  s_waitcnt vmcnt(11)
  v_mfma_f32_16x16x32_bf16 v[10:13], v[16:19], v[80:83], v[10:13]
  s_add_u32 s52, s54, 28672
  buffer_load_dwordx4 v[80:83], v1, s[12:15], s52 offen offset:0 nt
  v_lshlrev_b32 v24, 16, v39
  v_sub_f32 v24, v24, v14
  v_mul_f32 v24, s56, v24
  v_exp_f32 v24, v24
  s_nop 0
  v_cvt_pk_bf16_f32 v25, v24, v24
  v_and_b32 v25, 0xffff0000, v25
  v_sub_f32 v25, v24, v25
  v_cndmask_b32 v24, v24, v25, s[58:59]
  v_cvt_pk_bf16_f32 v24, v24, v24
  v_and_b32 v16, v24, v2
  v_and_b32 v17, v24, v3
  v_and_b32 v18, v24, v4
  v_and_b32 v19, v24, v5
  s_waitcnt vmcnt(11)
  v_mfma_f32_16x16x32_bf16 v[10:13], v[20:23], v[84:87], v[10:13]
  s_add_u32 s52, s54, 28672
  buffer_load_dwordx4 v[84:87], v1, s[12:15], s52 offen offset:1024 nt
  v_and_b32 v24, 0xffff0000, v38
  v_sub_f32 v24, v24, v14
  v_mul_f32 v24, s56, v24
  v_exp_f32 v24, v24
  s_nop 0
  v_cvt_pk_bf16_f32 v25, v24, v24
  v_and_b32 v25, 0xffff0000, v25
  v_sub_f32 v25, v24, v25
  v_cndmask_b32 v24, v24, v25, s[58:59]
  v_cvt_pk_bf16_f32 v24, v24, v24
  v_and_b32 v20, v24, v2
  v_and_b32 v21, v24, v3
  v_and_b32 v22, v24, v4
  v_and_b32 v23, v24, v5
  s_waitcnt vmcnt(11)
  v_mfma_f32_16x16x32_bf16 v[10:13], v[16:19], v[88:91], v[10:13]
  s_add_u32 s52, s54, 28672
  buffer_load_dwordx4 v[88:91], v1, s[12:15], s52 offen offset:2048 nt
  v_lshlrev_b32 v24, 16, v38
  v_sub_f32 v24, v24, v14
  v_mul_f32 v24, s56, v24
  v_exp_f32 v24, v24
  s_nop 0
  v_cvt_pk_bf16_f32 v25, v24, v24
  v_and_b32 v25, 0xffff0000, v25
  v_sub_f32 v25, v24, v25
  v_cndmask_b32 v24, v24, v25, s[58:59]
  v_cvt_pk_bf16_f32 v24, v24, v24
  v_and_b32 v16, v24, v2
  v_and_b32 v17, v24, v3
  v_and_b32 v18, v24, v4
  v_and_b32 v19, v24, v5
  s_waitcnt vmcnt(11)
  v_mfma_f32_16x16x32_bf16 v[10:13], v[20:23], v[92:95], v[10:13]
  s_add_u32 s52, s54, 28672
  buffer_load_dwordx4 v[92:95], v1, s[12:15], s52 offen offset:3072 nt
  v_and_b32 v24, 0xffff0000, v37
  v_sub_f32 v24, v24, v14
  v_mul_f32 v24, s56, v24
  v_exp_f32 v24, v24
  s_nop 0
  v_cvt_pk_bf16_f32 v25, v24, v24
  v_and_b32 v25, 0xffff0000, v25
  v_sub_f32 v25, v24, v25
  v_cndmask_b32 v24, v24, v25, s[58:59]
  v_cvt_pk_bf16_f32 v24, v24, v24
  v_and_b32 v20, v24, v2
  v_and_b32 v21, v24, v3
  v_and_b32 v22, v24, v4
  v_and_b32 v23, v24, v5
  s_waitcnt vmcnt(11)
  v_mfma_f32_16x16x32_bf16 v[10:13], v[16:19], v[96:99], v[10:13]
  s_add_u32 s52, s54, 32768
  buffer_load_dwordx4 v[96:99], v1, s[12:15], s52 offen offset:0 nt
  s_nop 5
  s_branch L_final
L_path3:
  s_add_u32 s52, s54, 0
  buffer_load_dwordx4 v[92:95], v1, s[8:11], s52 offen offset:0 nt
  s_add_u32 s52, s54, 0
  buffer_load_dwordx4 v[96:99], v1, s[8:11], s52 offen offset:1024 nt
  s_add_u32 s52, s54, 0
  buffer_load_dwordx4 v[52:55], v1, s[8:11], s52 offen offset:2048 nt
  s_add_u32 s52, s54, 0
  buffer_load_dwordx4 v[56:59], v1, s[8:11], s52 offen offset:3072 nt
  s_add_u32 s52, s54, 4096
  buffer_load_dwordx4 v[60:63], v1, s[8:11], s52 offen offset:0 nt
  s_add_u32 s52, s54, 4096
  buffer_load_dwordx4 v[64:67], v1, s[8:11], s52 offen offset:1024 nt
  s_add_u32 s52, s54, 4096
  buffer_load_dwordx4 v[68:71], v1, s[8:11], s52 offen offset:2048 nt
  s_add_u32 s52, s54, 4096
  buffer_load_dwordx4 v[72:75], v1, s[8:11], s52 offen offset:3072 nt
  s_add_u32 s52, s54, 8192
  buffer_load_dwordx4 v[76:79], v1, s[8:11], s52 offen offset:0 nt
  s_add_u32 s52, s54, 8192
  buffer_load_dwordx4 v[80:83], v1, s[8:11], s52 offen offset:1024 nt
  s_add_u32 s52, s54, 8192
  buffer_load_dwordx4 v[84:87], v1, s[8:11], s52 offen offset:2048 nt
  s_add_u32 s52, s54, 8192
  buffer_load_dwordx4 v[88:91], v1, s[8:11], s52 offen offset:3072 nt
  v_mov_b32 v25, 2824
  s_mov_b32 s61, 0
  s_nop 0
L_lw_20r:
  ds_read_b32 v24, v25
  s_waitcnt lgkmcnt(0)
  v_readfirstlane_b32 s52, v24
  s_cmp_ge_u32 s52, 1
  s_nop 3
  s_cbranch_scc1 L_lw_20o
  s_sleep 4
  s_add_u32 s61, s61, 1
  s_cmp_lt_u32 s61, 1200000
  s_cbranch_scc1 L_lw_20r
L_lw_20o:
  v_and_b32 v24, 15, v0
  v_lshlrev_b32 v24, 4, v24
  ds_read_b128 v[6:9], v24 offset:2560
  v_mov_b32 v14, 0xff800000
  v_mov_b32 v10, 0
  v_mov_b32 v11, 0
  v_mov_b32 v12, 0
  v_mov_b32 v13, 0
  s_waitcnt lgkmcnt(0)
  s_waitcnt vmcnt(11)
  v_dot2_f32_bf16 v24, v92, v6, 0
  v_dot2_f32_bf16 v24, v93, v7, v24
  v_dot2_f32_bf16 v24, v94, v8, v24
  v_dot2_f32_bf16 v24, v95, v9, v24
  s_add_u32 s52, s54, 12288
  buffer_load_dwordx4 v[92:95], v1, s[8:11], s52 offen offset:0 nt
  s_nop 0
  v_add_f32_dpp v24, v24, v24 row_ror:8 row_mask:0xf bank_mask:0xf
  s_nop 1
  v_add_f32_dpp v24, v24, v24 row_ror:4 row_mask:0xf bank_mask:0xf
  s_nop 1
  v_add_f32_dpp v24, v24, v24 row_ror:2 row_mask:0xf bank_mask:0xf
  s_nop 1
  v_add_f32_dpp v24, v24, v24 row_ror:1 row_mask:0xf bank_mask:0xf
  v_cvt_pk_bf16_f32 v28, v24, v24
  v_and_b32 v29, 0xffff0000, v28
  v_lshlrev_b32 v28, 16, v28
  v_mul_f32 v29, s55, v29
  v_mul_f32 v28, s55, v28
  v_max3_f32 v14, v14, v28, v29
  v_cvt_pk_bf16_f32 v47, v28, v29
  s_waitcnt vmcnt(11)
  v_dot2_f32_bf16 v24, v96, v6, 0
  v_dot2_f32_bf16 v24, v97, v7, v24
  v_dot2_f32_bf16 v24, v98, v8, v24
  v_dot2_f32_bf16 v24, v99, v9, v24
  s_add_u32 s52, s54, 12288
  buffer_load_dwordx4 v[96:99], v1, s[8:11], s52 offen offset:1024 nt
  s_waitcnt vmcnt(11)
  v_dot2_f32_bf16 v25, v52, v6, 0
  v_dot2_f32_bf16 v25, v53, v7, v25
  v_dot2_f32_bf16 v25, v54, v8, v25
  v_dot2_f32_bf16 v25, v55, v9, v25
  s_add_u32 s52, s54, 12288
  buffer_load_dwordx4 v[52:55], v1, s[8:11], s52 offen offset:2048 nt
  s_waitcnt vmcnt(11)
  v_dot2_f32_bf16 v26, v56, v6, 0
  v_dot2_f32_bf16 v26, v57, v7, v26
  v_dot2_f32_bf16 v26, v58, v8, v26
  v_dot2_f32_bf16 v26, v59, v9, v26
  s_add_u32 s52, s54, 12288
  buffer_load_dwordx4 v[56:59], v1, s[8:11], s52 offen offset:3072 nt
  s_waitcnt vmcnt(11)
  v_dot2_f32_bf16 v27, v60, v6, 0
  v_dot2_f32_bf16 v27, v61, v7, v27
  v_dot2_f32_bf16 v27, v62, v8, v27
  v_dot2_f32_bf16 v27, v63, v9, v27
  s_add_u32 s52, s54, 16384
  buffer_load_dwordx4 v[60:63], v1, s[8:11], s52 offen offset:0 nt
  v_add_f32_dpp v24, v24, v24 row_ror:8 row_mask:0xf bank_mask:0xf
  v_add_f32_dpp v25, v25, v25 row_ror:8 row_mask:0xf bank_mask:0xf
  v_add_f32_dpp v26, v26, v26 row_ror:8 row_mask:0xf bank_mask:0xf
  v_add_f32_dpp v27, v27, v27 row_ror:8 row_mask:0xf bank_mask:0xf
  v_add_f32_dpp v24, v24, v24 row_ror:4 row_mask:0xf bank_mask:0xf
  v_add_f32_dpp v25, v25, v25 row_ror:4 row_mask:0xf bank_mask:0xf
  v_add_f32_dpp v26, v26, v26 row_ror:4 row_mask:0xf bank_mask:0xf
  v_add_f32_dpp v27, v27, v27 row_ror:4 row_mask:0xf bank_mask:0xf
  v_add_f32_dpp v24, v24, v24 row_ror:2 row_mask:0xf bank_mask:0xf
  v_add_f32_dpp v25, v25, v25 row_ror:2 row_mask:0xf bank_mask:0xf
  v_add_f32_dpp v26, v26, v26 row_ror:2 row_mask:0xf bank_mask:0xf
  v_add_f32_dpp v27, v27, v27 row_ror:2 row_mask:0xf bank_mask:0xf
  v_add_f32_dpp v24, v24, v24 row_ror:1 row_mask:0xf bank_mask:0xf
  v_add_f32_dpp v25, v25, v25 row_ror:1 row_mask:0xf bank_mask:0xf
  v_add_f32_dpp v26, v26, v26 row_ror:1 row_mask:0xf bank_mask:0xf
  v_add_f32_dpp v27, v27, v27 row_ror:1 row_mask:0xf bank_mask:0xf
  v_cvt_pk_bf16_f32 v28, v25, v24
  v_and_b32 v29, 0xffff0000, v28
  v_lshlrev_b32 v28, 16, v28
  v_mul_f32 v29, s55, v29
  v_mul_f32 v28, s55, v28
  v_max3_f32 v14, v14, v28, v29
  v_cvt_pk_bf16_f32 v46, v28, v29
  v_cvt_pk_bf16_f32 v30, v27, v26
  v_and_b32 v31, 0xffff0000, v30
  v_lshlrev_b32 v30, 16, v30
  v_mul_f32 v31, s55, v31
  v_mul_f32 v30, s55, v30
  v_max3_f32 v14, v14, v30, v31
  v_cvt_pk_bf16_f32 v45, v30, v31
  s_waitcnt vmcnt(11)
  v_dot2_f32_bf16 v24, v64, v6, 0
  v_dot2_f32_bf16 v24, v65, v7, v24
  v_dot2_f32_bf16 v24, v66, v8, v24
  v_dot2_f32_bf16 v24, v67, v9, v24
  s_add_u32 s52, s54, 16384
  buffer_load_dwordx4 v[64:67], v1, s[8:11], s52 offen offset:1024 nt
  s_waitcnt vmcnt(11)
  v_dot2_f32_bf16 v25, v68, v6, 0
  v_dot2_f32_bf16 v25, v69, v7, v25
  v_dot2_f32_bf16 v25, v70, v8, v25
  v_dot2_f32_bf16 v25, v71, v9, v25
  s_add_u32 s52, s54, 16384
  buffer_load_dwordx4 v[68:71], v1, s[8:11], s52 offen offset:2048 nt
  s_waitcnt vmcnt(11)
  v_dot2_f32_bf16 v26, v72, v6, 0
  v_dot2_f32_bf16 v26, v73, v7, v26
  v_dot2_f32_bf16 v26, v74, v8, v26
  v_dot2_f32_bf16 v26, v75, v9, v26
  s_add_u32 s52, s54, 16384
  buffer_load_dwordx4 v[72:75], v1, s[8:11], s52 offen offset:3072 nt
  s_waitcnt vmcnt(11)
  v_dot2_f32_bf16 v27, v76, v6, 0
  v_dot2_f32_bf16 v27, v77, v7, v27
  v_dot2_f32_bf16 v27, v78, v8, v27
  v_dot2_f32_bf16 v27, v79, v9, v27
  s_add_u32 s52, s54, 20480
  buffer_load_dwordx4 v[76:79], v1, s[8:11], s52 offen offset:0 nt
  v_add_f32_dpp v24, v24, v24 row_ror:8 row_mask:0xf bank_mask:0xf
  v_add_f32_dpp v25, v25, v25 row_ror:8 row_mask:0xf bank_mask:0xf
  v_add_f32_dpp v26, v26, v26 row_ror:8 row_mask:0xf bank_mask:0xf
  v_add_f32_dpp v27, v27, v27 row_ror:8 row_mask:0xf bank_mask:0xf
  v_add_f32_dpp v24, v24, v24 row_ror:4 row_mask:0xf bank_mask:0xf
  v_add_f32_dpp v25, v25, v25 row_ror:4 row_mask:0xf bank_mask:0xf
  v_add_f32_dpp v26, v26, v26 row_ror:4 row_mask:0xf bank_mask:0xf
  v_add_f32_dpp v27, v27, v27 row_ror:4 row_mask:0xf bank_mask:0xf
  v_add_f32_dpp v24, v24, v24 row_ror:2 row_mask:0xf bank_mask:0xf
  v_add_f32_dpp v25, v25, v25 row_ror:2 row_mask:0xf bank_mask:0xf
  v_add_f32_dpp v26, v26, v26 row_ror:2 row_mask:0xf bank_mask:0xf
  v_add_f32_dpp v27, v27, v27 row_ror:2 row_mask:0xf bank_mask:0xf
  v_add_f32_dpp v24, v24, v24 row_ror:1 row_mask:0xf bank_mask:0xf
  v_add_f32_dpp v25, v25, v25 row_ror:1 row_mask:0xf bank_mask:0xf
  v_add_f32_dpp v26, v26, v26 row_ror:1 row_mask:0xf bank_mask:0xf
  v_add_f32_dpp v27, v27, v27 row_ror:1 row_mask:0xf bank_mask:0xf
  v_cvt_pk_bf16_f32 v28, v25, v24
  v_and_b32 v29, 0xffff0000, v28
  v_lshlrev_b32 v28, 16, v28
  v_mul_f32 v29, s55, v29
  v_mul_f32 v28, s55, v28
  v_max3_f32 v14, v14, v28, v29
  v_cvt_pk_bf16_f32 v44, v28, v29
  v_cvt_pk_bf16_f32 v30, v27, v26
  v_and_b32 v31, 0xffff0000, v30
  v_lshlrev_b32 v30, 16, v30
  v_mul_f32 v31, s55, v31
  v_mul_f32 v30, s55, v30
  v_max3_f32 v14, v14, v30, v31
  v_cvt_pk_bf16_f32 v43, v30, v31
  s_waitcnt vmcnt(11)
  v_dot2_f32_bf16 v24, v80, v6, 0
  v_dot2_f32_bf16 v24, v81, v7, v24
  v_dot2_f32_bf16 v24, v82, v8, v24
  v_dot2_f32_bf16 v24, v83, v9, v24
  s_add_u32 s52, s54, 20480
  buffer_load_dwordx4 v[80:83], v1, s[8:11], s52 offen offset:1024 nt
  s_waitcnt vmcnt(11)
  v_dot2_f32_bf16 v25, v84, v6, 0
  v_dot2_f32_bf16 v25, v85, v7, v25
  v_dot2_f32_bf16 v25, v86, v8, v25
  v_dot2_f32_bf16 v25, v87, v9, v25
  s_add_u32 s52, s54, 20480
  buffer_load_dwordx4 v[84:87], v1, s[8:11], s52 offen offset:2048 nt
  s_waitcnt vmcnt(11)
  v_dot2_f32_bf16 v26, v88, v6, 0
  v_dot2_f32_bf16 v26, v89, v7, v26
  v_dot2_f32_bf16 v26, v90, v8, v26
  v_dot2_f32_bf16 v26, v91, v9, v26
  s_add_u32 s52, s54, 20480
  buffer_load_dwordx4 v[88:91], v1, s[8:11], s52 offen offset:3072 nt
  s_waitcnt vmcnt(11)
  v_dot2_f32_bf16 v27, v92, v6, 0
  v_dot2_f32_bf16 v27, v93, v7, v27
  v_dot2_f32_bf16 v27, v94, v8, v27
  v_dot2_f32_bf16 v27, v95, v9, v27
  s_add_u32 s52, s54, 24576
  buffer_load_dwordx4 v[92:95], v1, s[8:11], s52 offen offset:0 nt
  v_add_f32_dpp v24, v24, v24 row_ror:8 row_mask:0xf bank_mask:0xf
  v_add_f32_dpp v25, v25, v25 row_ror:8 row_mask:0xf bank_mask:0xf
  v_add_f32_dpp v26, v26, v26 row_ror:8 row_mask:0xf bank_mask:0xf
  v_add_f32_dpp v27, v27, v27 row_ror:8 row_mask:0xf bank_mask:0xf
  v_add_f32_dpp v24, v24, v24 row_ror:4 row_mask:0xf bank_mask:0xf
  v_add_f32_dpp v25, v25, v25 row_ror:4 row_mask:0xf bank_mask:0xf
  v_add_f32_dpp v26, v26, v26 row_ror:4 row_mask:0xf bank_mask:0xf
  v_add_f32_dpp v27, v27, v27 row_ror:4 row_mask:0xf bank_mask:0xf
  v_add_f32_dpp v24, v24, v24 row_ror:2 row_mask:0xf bank_mask:0xf
  v_add_f32_dpp v25, v25, v25 row_ror:2 row_mask:0xf bank_mask:0xf
  v_add_f32_dpp v26, v26, v26 row_ror:2 row_mask:0xf bank_mask:0xf
  v_add_f32_dpp v27, v27, v27 row_ror:2 row_mask:0xf bank_mask:0xf
  v_add_f32_dpp v24, v24, v24 row_ror:1 row_mask:0xf bank_mask:0xf
  v_add_f32_dpp v25, v25, v25 row_ror:1 row_mask:0xf bank_mask:0xf
  v_add_f32_dpp v26, v26, v26 row_ror:1 row_mask:0xf bank_mask:0xf
  v_add_f32_dpp v27, v27, v27 row_ror:1 row_mask:0xf bank_mask:0xf
  v_cvt_pk_bf16_f32 v28, v25, v24
  v_and_b32 v29, 0xffff0000, v28
  v_lshlrev_b32 v28, 16, v28
  v_mul_f32 v29, s55, v29
  v_mul_f32 v28, s55, v28
  v_max3_f32 v14, v14, v28, v29
  v_cvt_pk_bf16_f32 v42, v28, v29
  v_cvt_pk_bf16_f32 v30, v27, v26
  v_and_b32 v31, 0xffff0000, v30
  v_lshlrev_b32 v30, 16, v30
  v_mul_f32 v31, s55, v31
  v_mul_f32 v30, s55, v30
  v_max3_f32 v14, v14, v30, v31
  v_cvt_pk_bf16_f32 v41, v30, v31
  s_waitcnt vmcnt(11)
  v_dot2_f32_bf16 v24, v96, v6, 0
  v_dot2_f32_bf16 v24, v97, v7, v24
  v_dot2_f32_bf16 v24, v98, v8, v24
  v_dot2_f32_bf16 v24, v99, v9, v24
  s_add_u32 s52, s54, 24576
  buffer_load_dwordx4 v[96:99], v1, s[8:11], s52 offen offset:1024 nt
  s_waitcnt vmcnt(11)
  v_dot2_f32_bf16 v25, v52, v6, 0
  v_dot2_f32_bf16 v25, v53, v7, v25
  v_dot2_f32_bf16 v25, v54, v8, v25
  v_dot2_f32_bf16 v25, v55, v9, v25
  s_add_u32 s52, s54, 24576
  buffer_load_dwordx4 v[52:55], v1, s[8:11], s52 offen offset:2048 nt
  s_waitcnt vmcnt(11)
  v_dot2_f32_bf16 v26, v56, v6, 0
  v_dot2_f32_bf16 v26, v57, v7, v26
  v_dot2_f32_bf16 v26, v58, v8, v26
  v_dot2_f32_bf16 v26, v59, v9, v26
  s_add_u32 s52, s54, 24576
  buffer_load_dwordx4 v[56:59], v1, s[8:11], s52 offen offset:3072 nt
  s_waitcnt vmcnt(11)
  v_dot2_f32_bf16 v27, v60, v6, 0
  v_dot2_f32_bf16 v27, v61, v7, v27
  v_dot2_f32_bf16 v27, v62, v8, v27
  v_dot2_f32_bf16 v27, v63, v9, v27
  s_add_u32 s52, s54, 28672
  buffer_load_dwordx4 v[60:63], v1, s[8:11], s52 offen offset:0 nt
  v_add_f32_dpp v24, v24, v24 row_ror:8 row_mask:0xf bank_mask:0xf
  v_add_f32_dpp v25, v25, v25 row_ror:8 row_mask:0xf bank_mask:0xf
  v_add_f32_dpp v26, v26, v26 row_ror:8 row_mask:0xf bank_mask:0xf
  v_add_f32_dpp v27, v27, v27 row_ror:8 row_mask:0xf bank_mask:0xf
  v_add_f32_dpp v24, v24, v24 row_ror:4 row_mask:0xf bank_mask:0xf
  v_add_f32_dpp v25, v25, v25 row_ror:4 row_mask:0xf bank_mask:0xf
  v_add_f32_dpp v26, v26, v26 row_ror:4 row_mask:0xf bank_mask:0xf
  v_add_f32_dpp v27, v27, v27 row_ror:4 row_mask:0xf bank_mask:0xf
  v_add_f32_dpp v24, v24, v24 row_ror:2 row_mask:0xf bank_mask:0xf
  v_add_f32_dpp v25, v25, v25 row_ror:2 row_mask:0xf bank_mask:0xf
  v_add_f32_dpp v26, v26, v26 row_ror:2 row_mask:0xf bank_mask:0xf
  v_add_f32_dpp v27, v27, v27 row_ror:2 row_mask:0xf bank_mask:0xf
  v_add_f32_dpp v24, v24, v24 row_ror:1 row_mask:0xf bank_mask:0xf
  v_add_f32_dpp v25, v25, v25 row_ror:1 row_mask:0xf bank_mask:0xf
  v_add_f32_dpp v26, v26, v26 row_ror:1 row_mask:0xf bank_mask:0xf
  v_add_f32_dpp v27, v27, v27 row_ror:1 row_mask:0xf bank_mask:0xf
  v_cvt_pk_bf16_f32 v28, v25, v24
  v_and_b32 v29, 0xffff0000, v28
  v_lshlrev_b32 v28, 16, v28
  v_mul_f32 v29, s55, v29
  v_mul_f32 v28, s55, v28
  v_max3_f32 v14, v14, v28, v29
  v_cvt_pk_bf16_f32 v40, v28, v29
  v_cvt_pk_bf16_f32 v30, v27, v26
  v_and_b32 v31, 0xffff0000, v30
  v_lshlrev_b32 v30, 16, v30
  v_mul_f32 v31, s55, v31
  v_mul_f32 v30, s55, v30
  v_max3_f32 v14, v14, v30, v31
  v_cvt_pk_bf16_f32 v39, v30, v31
  s_waitcnt vmcnt(11)
  v_dot2_f32_bf16 v24, v64, v6, 0
  v_dot2_f32_bf16 v24, v65, v7, v24
  v_dot2_f32_bf16 v24, v66, v8, v24
  v_dot2_f32_bf16 v24, v67, v9, v24
  s_add_u32 s52, s54, 28672
  buffer_load_dwordx4 v[64:67], v1, s[8:11], s52 offen offset:1024 nt
  s_waitcnt vmcnt(11)
  v_dot2_f32_bf16 v25, v68, v6, 0
  v_dot2_f32_bf16 v25, v69, v7, v25
  v_dot2_f32_bf16 v25, v70, v8, v25
  v_dot2_f32_bf16 v25, v71, v9, v25
  s_add_u32 s52, s54, 28672
  buffer_load_dwordx4 v[68:71], v1, s[8:11], s52 offen offset:2048 nt
  s_waitcnt vmcnt(11)
  v_dot2_f32_bf16 v26, v72, v6, 0
  v_dot2_f32_bf16 v26, v73, v7, v26
  v_dot2_f32_bf16 v26, v74, v8, v26
  v_dot2_f32_bf16 v26, v75, v9, v26
  s_add_u32 s52, s54, 0
  buffer_load_dwordx4 v[72:75], v1, s[12:15], s52 offen offset:0 nt
  s_waitcnt vmcnt(11)
  v_dot2_f32_bf16 v27, v76, v6, 0
  v_dot2_f32_bf16 v27, v77, v7, v27
  v_dot2_f32_bf16 v27, v78, v8, v27
  v_dot2_f32_bf16 v27, v79, v9, v27
  s_add_u32 s52, s54, 0
  buffer_load_dwordx4 v[76:79], v1, s[12:15], s52 offen offset:1024 nt
  v_add_f32_dpp v24, v24, v24 row_ror:8 row_mask:0xf bank_mask:0xf
  v_add_f32_dpp v25, v25, v25 row_ror:8 row_mask:0xf bank_mask:0xf
  v_add_f32_dpp v26, v26, v26 row_ror:8 row_mask:0xf bank_mask:0xf
  v_add_f32_dpp v27, v27, v27 row_ror:8 row_mask:0xf bank_mask:0xf
  v_add_f32_dpp v24, v24, v24 row_ror:4 row_mask:0xf bank_mask:0xf
  v_add_f32_dpp v25, v25, v25 row_ror:4 row_mask:0xf bank_mask:0xf
  v_add_f32_dpp v26, v26, v26 row_ror:4 row_mask:0xf bank_mask:0xf
  v_add_f32_dpp v27, v27, v27 row_ror:4 row_mask:0xf bank_mask:0xf
  v_add_f32_dpp v24, v24, v24 row_ror:2 row_mask:0xf bank_mask:0xf
  v_add_f32_dpp v25, v25, v25 row_ror:2 row_mask:0xf bank_mask:0xf
  v_add_f32_dpp v26, v26, v26 row_ror:2 row_mask:0xf bank_mask:0xf
  v_add_f32_dpp v27, v27, v27 row_ror:2 row_mask:0xf bank_mask:0xf
  v_add_f32_dpp v24, v24, v24 row_ror:1 row_mask:0xf bank_mask:0xf
  v_add_f32_dpp v25, v25, v25 row_ror:1 row_mask:0xf bank_mask:0xf
  v_add_f32_dpp v26, v26, v26 row_ror:1 row_mask:0xf bank_mask:0xf
  v_add_f32_dpp v27, v27, v27 row_ror:1 row_mask:0xf bank_mask:0xf
  v_cvt_pk_bf16_f32 v28, v25, v24
  v_and_b32 v29, 0xffff0000, v28
  v_lshlrev_b32 v28, 16, v28
  v_mul_f32 v29, s55, v29
  v_mul_f32 v28, s55, v28
  v_max3_f32 v14, v14, v28, v29
  v_cvt_pk_bf16_f32 v38, v28, v29
  v_cvt_pk_bf16_f32 v30, v27, v26
  v_and_b32 v31, 0xffff0000, v30
  v_lshlrev_b32 v30, 16, v30
  v_mul_f32 v31, s55, v31
  v_mul_f32 v30, s55, v30
  v_max3_f32 v14, v14, v30, v31
  v_cvt_pk_bf16_f32 v37, v30, v31
  s_waitcnt vmcnt(11)
  v_dot2_f32_bf16 v24, v80, v6, 0
  v_dot2_f32_bf16 v24, v81, v7, v24
  v_dot2_f32_bf16 v24, v82, v8, v24
  v_dot2_f32_bf16 v24, v83, v9, v24
  s_add_u32 s52, s54, 0
  buffer_load_dwordx4 v[80:83], v1, s[12:15], s52 offen offset:2048 nt
  s_waitcnt vmcnt(11)
  v_dot2_f32_bf16 v25, v84, v6, 0
  v_dot2_f32_bf16 v25, v85, v7, v25
  v_dot2_f32_bf16 v25, v86, v8, v25
  v_dot2_f32_bf16 v25, v87, v9, v25
  s_add_u32 s52, s54, 0
  buffer_load_dwordx4 v[84:87], v1, s[12:15], s52 offen offset:3072 nt
  s_waitcnt vmcnt(11)
  v_dot2_f32_bf16 v26, v88, v6, 0
  v_dot2_f32_bf16 v26, v89, v7, v26
  v_dot2_f32_bf16 v26, v90, v8, v26
  v_dot2_f32_bf16 v26, v91, v9, v26
  s_add_u32 s52, s54, 4096
  buffer_load_dwordx4 v[88:91], v1, s[12:15], s52 offen offset:0 nt
  s_waitcnt vmcnt(11)
  v_dot2_f32_bf16 v27, v92, v6, 0
  v_dot2_f32_bf16 v27, v93, v7, v27
  v_dot2_f32_bf16 v27, v94, v8, v27
  v_dot2_f32_bf16 v27, v95, v9, v27
  s_add_u32 s52, s54, 4096
  buffer_load_dwordx4 v[92:95], v1, s[12:15], s52 offen offset:1024 nt
  v_add_f32_dpp v24, v24, v24 row_ror:8 row_mask:0xf bank_mask:0xf
  v_add_f32_dpp v25, v25, v25 row_ror:8 row_mask:0xf bank_mask:0xf
  v_add_f32_dpp v26, v26, v26 row_ror:8 row_mask:0xf bank_mask:0xf
  v_add_f32_dpp v27, v27, v27 row_ror:8 row_mask:0xf bank_mask:0xf
  v_add_f32_dpp v24, v24, v24 row_ror:4 row_mask:0xf bank_mask:0xf
  v_add_f32_dpp v25, v25, v25 row_ror:4 row_mask:0xf bank_mask:0xf
  v_add_f32_dpp v26, v26, v26 row_ror:4 row_mask:0xf bank_mask:0xf
  v_add_f32_dpp v27, v27, v27 row_ror:4 row_mask:0xf bank_mask:0xf
  v_add_f32_dpp v24, v24, v24 row_ror:2 row_mask:0xf bank_mask:0xf
  v_add_f32_dpp v25, v25, v25 row_ror:2 row_mask:0xf bank_mask:0xf
  v_add_f32_dpp v26, v26, v26 row_ror:2 row_mask:0xf bank_mask:0xf
  v_add_f32_dpp v27, v27, v27 row_ror:2 row_mask:0xf bank_mask:0xf
  v_add_f32_dpp v24, v24, v24 row_ror:1 row_mask:0xf bank_mask:0xf
  v_add_f32_dpp v25, v25, v25 row_ror:1 row_mask:0xf bank_mask:0xf
  v_add_f32_dpp v26, v26, v26 row_ror:1 row_mask:0xf bank_mask:0xf
  v_add_f32_dpp v27, v27, v27 row_ror:1 row_mask:0xf bank_mask:0xf
  v_cvt_pk_bf16_f32 v28, v25, v24
  v_and_b32 v29, 0xffff0000, v28
  v_lshlrev_b32 v28, 16, v28
  v_mul_f32 v29, s55, v29
  v_mul_f32 v28, s55, v28
  v_max3_f32 v14, v14, v28, v29
  v_cvt_pk_bf16_f32 v36, v28, v29
  v_cvt_pk_bf16_f32 v30, v27, v26
  v_and_b32 v31, 0xffff0000, v30
  v_lshlrev_b32 v30, 16, v30
  v_mul_f32 v31, s55, v31
  v_mul_f32 v30, s55, v30
  v_max3_f32 v14, v14, v30, v31
  v_cvt_pk_bf16_f32 v35, v30, v31
  s_waitcnt vmcnt(11)
  v_dot2_f32_bf16 v24, v96, v6, 0
  v_dot2_f32_bf16 v24, v97, v7, v24
  v_dot2_f32_bf16 v24, v98, v8, v24
  v_dot2_f32_bf16 v24, v99, v9, v24
  s_add_u32 s52, s54, 4096
  buffer_load_dwordx4 v[96:99], v1, s[12:15], s52 offen offset:2048 nt
  s_waitcnt vmcnt(11)
  v_dot2_f32_bf16 v25, v52, v6, 0
  v_dot2_f32_bf16 v25, v53, v7, v25
  v_dot2_f32_bf16 v25, v54, v8, v25
  v_dot2_f32_bf16 v25, v55, v9, v25
  s_add_u32 s52, s54, 4096
  buffer_load_dwordx4 v[52:55], v1, s[12:15], s52 offen offset:3072 nt
  s_waitcnt vmcnt(11)
  v_dot2_f32_bf16 v26, v56, v6, 0
  v_dot2_f32_bf16 v26, v57, v7, v26
  v_dot2_f32_bf16 v26, v58, v8, v26
  v_dot2_f32_bf16 v26, v59, v9, v26
  s_add_u32 s52, s54, 8192
  buffer_load_dwordx4 v[56:59], v1, s[12:15], s52 offen offset:0 nt
  s_waitcnt vmcnt(11)
  v_dot2_f32_bf16 v27, v60, v6, 0
  v_dot2_f32_bf16 v27, v61, v7, v27
  v_dot2_f32_bf16 v27, v62, v8, v27
  v_dot2_f32_bf16 v27, v63, v9, v27
  s_add_u32 s52, s54, 8192
  buffer_load_dwordx4 v[60:63], v1, s[12:15], s52 offen offset:1024 nt
  v_add_f32_dpp v24, v24, v24 row_ror:8 row_mask:0xf bank_mask:0xf
  v_add_f32_dpp v25, v25, v25 row_ror:8 row_mask:0xf bank_mask:0xf
  v_add_f32_dpp v26, v26, v26 row_ror:8 row_mask:0xf bank_mask:0xf
  v_add_f32_dpp v27, v27, v27 row_ror:8 row_mask:0xf bank_mask:0xf
  v_add_f32_dpp v24, v24, v24 row_ror:4 row_mask:0xf bank_mask:0xf
  v_add_f32_dpp v25, v25, v25 row_ror:4 row_mask:0xf bank_mask:0xf
  v_add_f32_dpp v26, v26, v26 row_ror:4 row_mask:0xf bank_mask:0xf
  v_add_f32_dpp v27, v27, v27 row_ror:4 row_mask:0xf bank_mask:0xf
  v_add_f32_dpp v24, v24, v24 row_ror:2 row_mask:0xf bank_mask:0xf
  v_add_f32_dpp v25, v25, v25 row_ror:2 row_mask:0xf bank_mask:0xf
  v_add_f32_dpp v26, v26, v26 row_ror:2 row_mask:0xf bank_mask:0xf
  v_add_f32_dpp v27, v27, v27 row_ror:2 row_mask:0xf bank_mask:0xf
  v_add_f32_dpp v24, v24, v24 row_ror:1 row_mask:0xf bank_mask:0xf
  v_add_f32_dpp v25, v25, v25 row_ror:1 row_mask:0xf bank_mask:0xf
  v_add_f32_dpp v26, v26, v26 row_ror:1 row_mask:0xf bank_mask:0xf
  v_add_f32_dpp v27, v27, v27 row_ror:1 row_mask:0xf bank_mask:0xf
  v_cvt_pk_bf16_f32 v28, v25, v24
  v_and_b32 v29, 0xffff0000, v28
  v_lshlrev_b32 v28, 16, v28
  v_mul_f32 v29, s55, v29
  v_mul_f32 v28, s55, v28
  v_max3_f32 v14, v14, v28, v29
  v_cvt_pk_bf16_f32 v34, v28, v29
  v_cvt_pk_bf16_f32 v30, v27, v26
  v_and_b32 v31, 0xffff0000, v30
  v_lshlrev_b32 v30, 16, v30
  v_mul_f32 v31, s55, v31
  v_mul_f32 v30, s55, v30
  v_max3_f32 v14, v14, v30, v31
  v_cvt_pk_bf16_f32 v33, v30, v31
  s_waitcnt vmcnt(11)
  v_dot2_f32_bf16 v24, v64, v6, 0
  v_dot2_f32_bf16 v24, v65, v7, v24
  v_dot2_f32_bf16 v24, v66, v8, v24
  v_dot2_f32_bf16 v24, v67, v9, v24
  s_add_u32 s52, s54, 8192
  buffer_load_dwordx4 v[64:67], v1, s[12:15], s52 offen offset:2048 nt
  s_waitcnt vmcnt(11)
  v_dot2_f32_bf16 v25, v68, v6, 0
  v_dot2_f32_bf16 v25, v69, v7, v25
  v_dot2_f32_bf16 v25, v70, v8, v25
  v_dot2_f32_bf16 v25, v71, v9, v25
  s_add_u32 s52, s54, 8192
  buffer_load_dwordx4 v[68:71], v1, s[12:15], s52 offen offset:3072 nt
  v_add_f32_dpp v24, v24, v24 row_ror:8 row_mask:0xf bank_mask:0xf
  v_add_f32_dpp v25, v25, v25 row_ror:8 row_mask:0xf bank_mask:0xf
  s_nop 0
  v_add_f32_dpp v24, v24, v24 row_ror:4 row_mask:0xf bank_mask:0xf
  v_add_f32_dpp v25, v25, v25 row_ror:4 row_mask:0xf bank_mask:0xf
  s_nop 0
  v_add_f32_dpp v24, v24, v24 row_ror:2 row_mask:0xf bank_mask:0xf
  v_add_f32_dpp v25, v25, v25 row_ror:2 row_mask:0xf bank_mask:0xf
  s_nop 0
  v_add_f32_dpp v24, v24, v24 row_ror:1 row_mask:0xf bank_mask:0xf
  v_add_f32_dpp v25, v25, v25 row_ror:1 row_mask:0xf bank_mask:0xf
  v_cvt_pk_bf16_f32 v28, v25, v24
  v_and_b32 v29, 0xffff0000, v28
  v_lshlrev_b32 v28, 16, v28
  v_mul_f32 v29, s55, v29
  v_mul_f32 v28, s55, v28
  v_max3_f32 v14, v14, v28, v29
  v_cvt_pk_bf16_f32 v32, v28, v29
  v_mov_b32 v24, v14
  s_nop 1
  v_permlane16_swap_b32 v14, v24
  v_max_f32 v14, v14, v24
  v_mov_b32 v24, v14
  s_nop 1
  v_permlane32_swap_b32 v14, v24
  v_max_f32 v14, v14, v24
  v_cvt_pk_bf16_f32 v14, v14, v14
  v_and_b32 v14, 0xffff0000, v14
  v_mov_b32 v15, 0
  v_lshlrev_b32 v24, 16, v47
  v_and_b32 v25, 0xffff0000, v46
  v_lshlrev_b32 v26, 16, v46
  v_and_b32 v27, 0xffff0000, v45
  v_sub_f32 v24, v24, v14
  v_sub_f32 v25, v25, v14
  v_sub_f32 v26, v26, v14
  v_sub_f32 v27, v27, v14
  v_mul_f32 v24, s56, v24
  v_mul_f32 v25, s56, v25
  v_mul_f32 v26, s56, v26
  v_mul_f32 v27, s56, v27
  v_exp_f32 v24, v24
  v_exp_f32 v25, v25
  v_exp_f32 v26, v26
  v_exp_f32 v27, v27
  v_add_f32 v15, v15, v24
  v_add_f32 v15, v15, v25
  v_add_f32 v15, v15, v26
  v_add_f32 v15, v15, v27
  v_lshlrev_b32 v24, 16, v45
  v_and_b32 v25, 0xffff0000, v44
  v_lshlrev_b32 v26, 16, v44
  v_and_b32 v27, 0xffff0000, v43
  v_sub_f32 v24, v24, v14
  v_sub_f32 v25, v25, v14
  v_sub_f32 v26, v26, v14
  v_sub_f32 v27, v27, v14
  v_mul_f32 v24, s56, v24
  v_mul_f32 v25, s56, v25
  v_mul_f32 v26, s56, v26
  v_mul_f32 v27, s56, v27
  v_exp_f32 v24, v24
  v_exp_f32 v25, v25
  v_exp_f32 v26, v26
  v_exp_f32 v27, v27
  v_add_f32 v15, v15, v24
  v_add_f32 v15, v15, v25
  v_add_f32 v15, v15, v26
  v_add_f32 v15, v15, v27
  v_lshlrev_b32 v24, 16, v43
  v_and_b32 v25, 0xffff0000, v42
  v_lshlrev_b32 v26, 16, v42
  v_and_b32 v27, 0xffff0000, v41
  v_sub_f32 v24, v24, v14
  v_sub_f32 v25, v25, v14
  v_sub_f32 v26, v26, v14
  v_sub_f32 v27, v27, v14
  v_mul_f32 v24, s56, v24
  v_mul_f32 v25, s56, v25
  v_mul_f32 v26, s56, v26
  v_mul_f32 v27, s56, v27
  v_exp_f32 v24, v24
  v_exp_f32 v25, v25
  v_exp_f32 v26, v26
  v_exp_f32 v27, v27
  v_add_f32 v15, v15, v24
  v_add_f32 v15, v15, v25
  v_add_f32 v15, v15, v26
  v_add_f32 v15, v15, v27
  v_lshlrev_b32 v24, 16, v41
  v_and_b32 v25, 0xffff0000, v40
  v_lshlrev_b32 v26, 16, v40
  v_and_b32 v27, 0xffff0000, v39
  v_sub_f32 v24, v24, v14
  v_sub_f32 v25, v25, v14
  v_sub_f32 v26, v26, v14
  v_sub_f32 v27, v27, v14
  v_mul_f32 v24, s56, v24
  v_mul_f32 v25, s56, v25
  v_mul_f32 v26, s56, v26
  v_mul_f32 v27, s56, v27
  v_exp_f32 v24, v24
  v_exp_f32 v25, v25
  v_exp_f32 v26, v26
  v_exp_f32 v27, v27
  v_add_f32 v15, v15, v24
  v_add_f32 v15, v15, v25
  v_add_f32 v15, v15, v26
  v_add_f32 v15, v15, v27
  v_lshlrev_b32 v24, 16, v39
  v_and_b32 v25, 0xffff0000, v38
  v_lshlrev_b32 v26, 16, v38
  v_and_b32 v27, 0xffff0000, v37
  v_sub_f32 v24, v24, v14
  v_sub_f32 v25, v25, v14
  v_sub_f32 v26, v26, v14
  v_sub_f32 v27, v27, v14
  v_mul_f32 v24, s56, v24
  v_mul_f32 v25, s56, v25
  v_mul_f32 v26, s56, v26
  v_mul_f32 v27, s56, v27
  v_exp_f32 v24, v24
  v_exp_f32 v25, v25
  v_exp_f32 v26, v26
  v_exp_f32 v27, v27
  v_add_f32 v15, v15, v24
  v_add_f32 v15, v15, v25
  v_add_f32 v15, v15, v26
  v_add_f32 v15, v15, v27
  v_lshlrev_b32 v24, 16, v37
  v_and_b32 v25, 0xffff0000, v36
  v_lshlrev_b32 v26, 16, v36
  v_and_b32 v27, 0xffff0000, v35
  v_sub_f32 v24, v24, v14
  v_sub_f32 v25, v25, v14
  v_sub_f32 v26, v26, v14
  v_sub_f32 v27, v27, v14
  v_mul_f32 v24, s56, v24
  v_mul_f32 v25, s56, v25
  v_mul_f32 v26, s56, v26
  v_mul_f32 v27, s56, v27
  v_exp_f32 v24, v24
  v_exp_f32 v25, v25
  v_exp_f32 v26, v26
  v_exp_f32 v27, v27
  v_add_f32 v15, v15, v24
  v_add_f32 v15, v15, v25
  v_add_f32 v15, v15, v26
  v_add_f32 v15, v15, v27
  v_lshlrev_b32 v24, 16, v35
  v_and_b32 v25, 0xffff0000, v34
  v_lshlrev_b32 v26, 16, v34
  v_and_b32 v27, 0xffff0000, v33
  v_sub_f32 v24, v24, v14
  v_sub_f32 v25, v25, v14
  v_sub_f32 v26, v26, v14
  v_sub_f32 v27, v27, v14
  v_mul_f32 v24, s56, v24
  v_mul_f32 v25, s56, v25
  v_mul_f32 v26, s56, v26
  v_mul_f32 v27, s56, v27
  v_exp_f32 v24, v24
  v_exp_f32 v25, v25
  v_exp_f32 v26, v26
  v_exp_f32 v27, v27
  v_add_f32 v15, v15, v24
  v_add_f32 v15, v15, v25
  v_add_f32 v15, v15, v26
  v_add_f32 v15, v15, v27
  v_lshlrev_b32 v24, 16, v33
  v_and_b32 v25, 0xffff0000, v32
  v_lshlrev_b32 v26, 16, v32
  v_sub_f32 v24, v24, v14
  v_sub_f32 v25, v25, v14
  v_sub_f32 v26, v26, v14
  v_mul_f32 v24, s56, v24
  v_mul_f32 v25, s56, v25
  v_mul_f32 v26, s56, v26
  v_exp_f32 v24, v24
  v_exp_f32 v25, v25
  v_exp_f32 v26, v26
  v_add_f32 v15, v15, v24
  v_add_f32 v15, v15, v25
  v_add_f32 v15, v15, v26
  v_mov_b32 v24, v15
  s_nop 1
  v_permlane16_swap_b32 v15, v24
  v_add_f32 v15, v15, v24
  v_mov_b32 v24, v15
  s_nop 1
  v_permlane32_swap_b32 v15, v24
  v_add_f32 v15, v15, v24
  v_min_u32 v15, 0xfffffffe, v15
  s_mov_b64 exec, 1
  buffer_store_dwordx2 v[14:15], off, s[48:51], s67 sc1
  s_lshl_b32 s52, s3, 3
  v_mov_b32 v24, s52
  ds_write_b64 v24, v[14:15] offset:2880
  s_mov_b64 exec, -1
  s_waitcnt lgkmcnt(0)
  v_mov_b32 v24, 1
  v_mov_b32 v25, 2828
  s_mov_b64 exec, 1
  ds_add_u32 v25, v24
  s_mov_b64 exec, -1
  v_lshlrev_b32 v24, 16, v47
  v_sub_f32 v24, v24, v14
  v_mul_f32 v24, s56, v24
  v_exp_f32 v24, v24
  s_nop 0
  v_cvt_pk_bf16_f32 v25, v24, v24
  v_and_b32 v25, 0xffff0000, v25
  v_sub_f32 v25, v24, v25
  v_cndmask_b32 v24, v24, v25, s[58:59]
  v_cvt_pk_bf16_f32 v24, v24, v24
  v_and_b32 v16, v24, v2
  v_and_b32 v17, v24, v3
  v_and_b32 v18, v24, v4
  v_and_b32 v19, v24, v5
  v_and_b32 v24, 0xffff0000, v46
  v_sub_f32 v24, v24, v14
  v_mul_f32 v24, s56, v24
  v_exp_f32 v24, v24
  s_nop 0
  v_cvt_pk_bf16_f32 v25, v24, v24
  v_and_b32 v25, 0xffff0000, v25
  v_sub_f32 v25, v24, v25
  v_cndmask_b32 v24, v24, v25, s[58:59]
  v_cvt_pk_bf16_f32 v24, v24, v24
  v_and_b32 v20, v24, v2
  v_and_b32 v21, v24, v3
  v_and_b32 v22, v24, v4
  v_and_b32 v23, v24, v5
  s_waitcnt vmcnt(12)
  v_mfma_f32_16x16x32_bf16 v[10:13], v[16:19], v[72:75], v[10:13]
  s_add_u32 s52, s54, 12288
  buffer_load_dwordx4 v[72:75], v1, s[12:15], s52 offen offset:0 nt
  v_lshlrev_b32 v24, 16, v46
  v_sub_f32 v24, v24, v14
  v_mul_f32 v24, s56, v24
  v_exp_f32 v24, v24
  s_nop 0
  v_cvt_pk_bf16_f32 v25, v24, v24
  v_and_b32 v25, 0xffff0000, v25
  v_sub_f32 v25, v24, v25
  v_cndmask_b32 v24, v24, v25, s[58:59]
  v_cvt_pk_bf16_f32 v24, v24, v24
  v_and_b32 v16, v24, v2
  v_and_b32 v17, v24, v3
  v_and_b32 v18, v24, v4
  v_and_b32 v19, v24, v5
  s_waitcnt vmcnt(12)
  v_mfma_f32_16x16x32_bf16 v[10:13], v[20:23], v[76:79], v[10:13]
  s_add_u32 s52, s54, 12288
  buffer_load_dwordx4 v[76:79], v1, s[12:15], s52 offen offset:1024 nt
  v_and_b32 v24, 0xffff0000, v45
  v_sub_f32 v24, v24, v14
  v_mul_f32 v24, s56, v24
  v_exp_f32 v24, v24
  s_nop 0
  v_cvt_pk_bf16_f32 v25, v24, v24
  v_and_b32 v25, 0xffff0000, v25
  v_sub_f32 v25, v24, v25
  v_cndmask_b32 v24, v24, v25, s[58:59]
  v_cvt_pk_bf16_f32 v24, v24, v24
  v_and_b32 v20, v24, v2
  v_and_b32 v21, v24, v3
  v_and_b32 v22, v24, v4
  v_and_b32 v23, v24, v5
  s_waitcnt vmcnt(12)
  v_mfma_f32_16x16x32_bf16 v[10:13], v[16:19], v[80:83], v[10:13]
  s_add_u32 s52, s54, 12288
  buffer_load_dwordx4 v[80:83], v1, s[12:15], s52 offen offset:2048 nt
  v_lshlrev_b32 v24, 16, v45
  v_sub_f32 v24, v24, v14
  v_mul_f32 v24, s56, v24
  v_exp_f32 v24, v24
  s_nop 0
  v_cvt_pk_bf16_f32 v25, v24, v24
  v_and_b32 v25, 0xffff0000, v25
  v_sub_f32 v25, v24, v25
  v_cndmask_b32 v24, v24, v25, s[58:59]
  v_cvt_pk_bf16_f32 v24, v24, v24
  v_and_b32 v16, v24, v2
  v_and_b32 v17, v24, v3
  v_and_b32 v18, v24, v4
  v_and_b32 v19, v24, v5
  s_waitcnt vmcnt(12)
  v_mfma_f32_16x16x32_bf16 v[10:13], v[20:23], v[84:87], v[10:13]
  s_add_u32 s52, s54, 12288
  buffer_load_dwordx4 v[84:87], v1, s[12:15], s52 offen offset:3072 nt
  v_and_b32 v24, 0xffff0000, v44
  v_sub_f32 v24, v24, v14
  v_mul_f32 v24, s56, v24
  v_exp_f32 v24, v24
  s_nop 0
  v_cvt_pk_bf16_f32 v25, v24, v24
  v_and_b32 v25, 0xffff0000, v25
  v_sub_f32 v25, v24, v25
  v_cndmask_b32 v24, v24, v25, s[58:59]
  v_cvt_pk_bf16_f32 v24, v24, v24
  v_and_b32 v20, v24, v2
  v_and_b32 v21, v24, v3
  v_and_b32 v22, v24, v4
  v_and_b32 v23, v24, v5
  s_waitcnt vmcnt(12)
  v_mfma_f32_16x16x32_bf16 v[10:13], v[16:19], v[88:91], v[10:13]
  s_add_u32 s52, s54, 16384
  buffer_load_dwordx4 v[88:91], v1, s[12:15], s52 offen offset:0 nt
  v_lshlrev_b32 v24, 16, v44
  v_sub_f32 v24, v24, v14
  v_mul_f32 v24, s56, v24
  v_exp_f32 v24, v24
  s_nop 0
  v_cvt_pk_bf16_f32 v25, v24, v24
  v_and_b32 v25, 0xffff0000, v25
  v_sub_f32 v25, v24, v25
  v_cndmask_b32 v24, v24, v25, s[58:59]
  v_cvt_pk_bf16_f32 v24, v24, v24
  v_and_b32 v16, v24, v2
  v_and_b32 v17, v24, v3
  v_and_b32 v18, v24, v4
  v_and_b32 v19, v24, v5
  s_waitcnt vmcnt(12)
  v_mfma_f32_16x16x32_bf16 v[10:13], v[20:23], v[92:95], v[10:13]
  s_add_u32 s52, s54, 16384
  buffer_load_dwordx4 v[92:95], v1, s[12:15], s52 offen offset:1024 nt
  v_and_b32 v24, 0xffff0000, v43
  v_sub_f32 v24, v24, v14
  v_mul_f32 v24, s56, v24
  v_exp_f32 v24, v24
  s_nop 0
  v_cvt_pk_bf16_f32 v25, v24, v24
  v_and_b32 v25, 0xffff0000, v25
  v_sub_f32 v25, v24, v25
  v_cndmask_b32 v24, v24, v25, s[58:59]
  v_cvt_pk_bf16_f32 v24, v24, v24
  v_and_b32 v20, v24, v2
  v_and_b32 v21, v24, v3
  v_and_b32 v22, v24, v4
  v_and_b32 v23, v24, v5
  s_waitcnt vmcnt(12)
  v_mfma_f32_16x16x32_bf16 v[10:13], v[16:19], v[96:99], v[10:13]
  s_add_u32 s52, s54, 16384
  buffer_load_dwordx4 v[96:99], v1, s[12:15], s52 offen offset:2048 nt
  v_lshlrev_b32 v24, 16, v43
  v_sub_f32 v24, v24, v14
  v_mul_f32 v24, s56, v24
  v_exp_f32 v24, v24
  s_nop 0
  v_cvt_pk_bf16_f32 v25, v24, v24
  v_and_b32 v25, 0xffff0000, v25
  v_sub_f32 v25, v24, v25
  v_cndmask_b32 v24, v24, v25, s[58:59]
  v_cvt_pk_bf16_f32 v24, v24, v24
  v_and_b32 v16, v24, v2
  v_and_b32 v17, v24, v3
  v_and_b32 v18, v24, v4
  v_and_b32 v19, v24, v5
  s_waitcnt vmcnt(12)
  v_mfma_f32_16x16x32_bf16 v[10:13], v[20:23], v[52:55], v[10:13]
  s_add_u32 s52, s54, 16384
  buffer_load_dwordx4 v[52:55], v1, s[12:15], s52 offen offset:3072 nt
  v_and_b32 v24, 0xffff0000, v42
  v_sub_f32 v24, v24, v14
  v_mul_f32 v24, s56, v24
  v_exp_f32 v24, v24
  s_nop 0
  v_cvt_pk_bf16_f32 v25, v24, v24
  v_and_b32 v25, 0xffff0000, v25
  v_sub_f32 v25, v24, v25
  v_cndmask_b32 v24, v24, v25, s[58:59]
  v_cvt_pk_bf16_f32 v24, v24, v24
  v_and_b32 v20, v24, v2
  v_and_b32 v21, v24, v3
  v_and_b32 v22, v24, v4
  v_and_b32 v23, v24, v5
  s_waitcnt vmcnt(12)
  v_mfma_f32_16x16x32_bf16 v[10:13], v[16:19], v[56:59], v[10:13]
  s_add_u32 s52, s54, 20480
  buffer_load_dwordx4 v[56:59], v1, s[12:15], s52 offen offset:0 nt
  v_lshlrev_b32 v24, 16, v42
  v_sub_f32 v24, v24, v14
  v_mul_f32 v24, s56, v24
  v_exp_f32 v24, v24
  s_nop 0
  v_cvt_pk_bf16_f32 v25, v24, v24
  v_and_b32 v25, 0xffff0000, v25
  v_sub_f32 v25, v24, v25
  v_cndmask_b32 v24, v24, v25, s[58:59]
  v_cvt_pk_bf16_f32 v24, v24, v24
  v_and_b32 v16, v24, v2
  v_and_b32 v17, v24, v3
  v_and_b32 v18, v24, v4
  v_and_b32 v19, v24, v5
  s_waitcnt vmcnt(12)
  v_mfma_f32_16x16x32_bf16 v[10:13], v[20:23], v[60:63], v[10:13]
  s_add_u32 s52, s54, 20480
  buffer_load_dwordx4 v[60:63], v1, s[12:15], s52 offen offset:1024 nt
  v_and_b32 v24, 0xffff0000, v41
  v_sub_f32 v24, v24, v14
  v_mul_f32 v24, s56, v24
  v_exp_f32 v24, v24
  s_nop 0
  v_cvt_pk_bf16_f32 v25, v24, v24
  v_and_b32 v25, 0xffff0000, v25
  v_sub_f32 v25, v24, v25
  v_cndmask_b32 v24, v24, v25, s[58:59]
  v_cvt_pk_bf16_f32 v24, v24, v24
  v_and_b32 v20, v24, v2
  v_and_b32 v21, v24, v3
  v_and_b32 v22, v24, v4
  v_and_b32 v23, v24, v5
  s_waitcnt vmcnt(12)
  v_mfma_f32_16x16x32_bf16 v[10:13], v[16:19], v[64:67], v[10:13]
  s_add_u32 s52, s54, 20480
  buffer_load_dwordx4 v[64:67], v1, s[12:15], s52 offen offset:2048 nt
  v_lshlrev_b32 v24, 16, v41
  v_sub_f32 v24, v24, v14
  v_mul_f32 v24, s56, v24
  v_exp_f32 v24, v24
  s_nop 0
  v_cvt_pk_bf16_f32 v25, v24, v24
  v_and_b32 v25, 0xffff0000, v25
  v_sub_f32 v25, v24, v25
  v_cndmask_b32 v24, v24, v25, s[58:59]
  v_cvt_pk_bf16_f32 v24, v24, v24
  v_and_b32 v16, v24, v2
  v_and_b32 v17, v24, v3
  v_and_b32 v18, v24, v4
  v_and_b32 v19, v24, v5
  s_waitcnt vmcnt(12)
  v_mfma_f32_16x16x32_bf16 v[10:13], v[20:23], v[68:71], v[10:13]
  s_add_u32 s52, s54, 20480
  buffer_load_dwordx4 v[68:71], v1, s[12:15], s52 offen offset:3072 nt
  v_and_b32 v24, 0xffff0000, v40
  v_sub_f32 v24, v24, v14
  v_mul_f32 v24, s56, v24
  v_exp_f32 v24, v24
  s_nop 0
  v_cvt_pk_bf16_f32 v25, v24, v24
  v_and_b32 v25, 0xffff0000, v25
  v_sub_f32 v25, v24, v25
  v_cndmask_b32 v24, v24, v25, s[58:59]
  v_cvt_pk_bf16_f32 v24, v24, v24
  v_and_b32 v20, v24, v2
  v_and_b32 v21, v24, v3
  v_and_b32 v22, v24, v4
  v_and_b32 v23, v24, v5
  s_waitcnt vmcnt(11)
  v_mfma_f32_16x16x32_bf16 v[10:13], v[16:19], v[72:75], v[10:13]
  s_add_u32 s52, s54, 24576
  buffer_load_dwordx4 v[72:75], v1, s[12:15], s52 offen offset:0 nt
  v_lshlrev_b32 v24, 16, v40
  v_sub_f32 v24, v24, v14
  v_mul_f32 v24, s56, v24
  v_exp_f32 v24, v24
  s_nop 0
  v_cvt_pk_bf16_f32 v25, v24, v24
  v_and_b32 v25, 0xffff0000, v25
  v_sub_f32 v25, v24, v25
  v_cndmask_b32 v24, v24, v25, s[58:59]
  v_cvt_pk_bf16_f32 v24, v24, v24
  v_and_b32 v16, v24, v2
  v_and_b32 v17, v24, v3
  v_and_b32 v18, v24, v4
  v_and_b32 v19, v24, v5
  s_waitcnt vmcnt(11)
  v_mfma_f32_16x16x32_bf16 v[10:13], v[20:23], v[76:79], v[10:13]
  s_add_u32 s52, s54, 24576
  buffer_load_dwordx4 v[76:79], v1, s[12:15], s52 offen offset:1024 nt
  v_and_b32 v24, 0xffff0000, v39
  v_sub_f32 v24, v24, v14
  v_mul_f32 v24, s56, v24
  v_exp_f32 v24, v24
  s_nop 0
  v_cvt_pk_bf16_f32 v25, v24, v24
  v_and_b32 v25, 0xffff0000, v25
  v_sub_f32 v25, v24, v25
  v_cndmask_b32 v24, v24, v25, s[58:59]
  v_cvt_pk_bf16_f32 v24, v24, v24
  v_and_b32 v20, v24, v2
  v_and_b32 v21, v24, v3
  v_and_b32 v22, v24, v4
  v_and_b32 v23, v24, v5
  s_waitcnt vmcnt(11)
  v_mfma_f32_16x16x32_bf16 v[10:13], v[16:19], v[80:83], v[10:13]
  s_add_u32 s52, s54, 24576
  buffer_load_dwordx4 v[80:83], v1, s[12:15], s52 offen offset:2048 nt
  v_lshlrev_b32 v24, 16, v39
  v_sub_f32 v24, v24, v14
  v_mul_f32 v24, s56, v24
  v_exp_f32 v24, v24
  s_nop 0
  v_cvt_pk_bf16_f32 v25, v24, v24
  v_and_b32 v25, 0xffff0000, v25
  v_sub_f32 v25, v24, v25
  v_cndmask_b32 v24, v24, v25, s[58:59]
  v_cvt_pk_bf16_f32 v24, v24, v24
  v_and_b32 v16, v24, v2
  v_and_b32 v17, v24, v3
  v_and_b32 v18, v24, v4
  v_and_b32 v19, v24, v5
  s_waitcnt vmcnt(11)
  v_mfma_f32_16x16x32_bf16 v[10:13], v[20:23], v[84:87], v[10:13]
  s_add_u32 s52, s54, 24576
  buffer_load_dwordx4 v[84:87], v1, s[12:15], s52 offen offset:3072 nt
  v_and_b32 v24, 0xffff0000, v38
  v_sub_f32 v24, v24, v14
  v_mul_f32 v24, s56, v24
  v_exp_f32 v24, v24
  s_nop 0
  v_cvt_pk_bf16_f32 v25, v24, v24
  v_and_b32 v25, 0xffff0000, v25
  v_sub_f32 v25, v24, v25
  v_cndmask_b32 v24, v24, v25, s[58:59]
  v_cvt_pk_bf16_f32 v24, v24, v24
  v_and_b32 v20, v24, v2
  v_and_b32 v21, v24, v3
  v_and_b32 v22, v24, v4
  v_and_b32 v23, v24, v5
  s_waitcnt vmcnt(11)
  v_mfma_f32_16x16x32_bf16 v[10:13], v[16:19], v[88:91], v[10:13]
  s_add_u32 s52, s54, 28672
  buffer_load_dwordx4 v[88:91], v1, s[12:15], s52 offen offset:0 nt
  v_lshlrev_b32 v24, 16, v38
  v_sub_f32 v24, v24, v14
  v_mul_f32 v24, s56, v24
  v_exp_f32 v24, v24
  s_nop 0
  v_cvt_pk_bf16_f32 v25, v24, v24
  v_and_b32 v25, 0xffff0000, v25
  v_sub_f32 v25, v24, v25
  v_cndmask_b32 v24, v24, v25, s[58:59]
  v_cvt_pk_bf16_f32 v24, v24, v24
  v_and_b32 v16, v24, v2
  v_and_b32 v17, v24, v3
  v_and_b32 v18, v24, v4
  v_and_b32 v19, v24, v5
  s_waitcnt vmcnt(11)
  v_mfma_f32_16x16x32_bf16 v[10:13], v[20:23], v[92:95], v[10:13]
  s_add_u32 s52, s54, 28672
  buffer_load_dwordx4 v[92:95], v1, s[12:15], s52 offen offset:1024 nt
  v_and_b32 v24, 0xffff0000, v37
  v_sub_f32 v24, v24, v14
  v_mul_f32 v24, s56, v24
  v_exp_f32 v24, v24
  s_nop 0
  v_cvt_pk_bf16_f32 v25, v24, v24
  v_and_b32 v25, 0xffff0000, v25
  v_sub_f32 v25, v24, v25
  v_cndmask_b32 v24, v24, v25, s[58:59]
  v_cvt_pk_bf16_f32 v24, v24, v24
  v_and_b32 v20, v24, v2
  v_and_b32 v21, v24, v3
  v_and_b32 v22, v24, v4
  v_and_b32 v23, v24, v5
  s_waitcnt vmcnt(11)
  v_mfma_f32_16x16x32_bf16 v[10:13], v[16:19], v[96:99], v[10:13]
  s_add_u32 s52, s54, 28672
  buffer_load_dwordx4 v[96:99], v1, s[12:15], s52 offen offset:2048 nt
  s_nop 5
L_final:
  s_lshl_b32 s74, s7, 8
  s_cmp_eq_u32 s72, 0
  s_cbranch_scc1 L_fin_y
  v_lshlrev_b32 v24, 16, v37
  v_sub_f32 v24, v24, v14
  v_mul_f32 v24, s56, v24
  v_exp_f32 v24, v24
  s_nop 0
  v_cvt_pk_bf16_f32 v25, v24, v24
  v_and_b32 v25, 0xffff0000, v25
  v_sub_f32 v25, v24, v25
  v_cndmask_b32 v24, v24, v25, s[58:59]
  v_cvt_pk_bf16_f32 v24, v24, v24
  v_and_b32 v16, v24, v2
  v_and_b32 v17, v24, v3
  v_and_b32 v18, v24, v4
  v_and_b32 v19, v24, v5
  s_waitcnt vmcnt(11)
  v_mfma_f32_16x16x32_bf16 v[10:13], v[20:23], v[52:55], v[10:13]
  v_and_b32 v24, 0xffff0000, v36
  v_sub_f32 v24, v24, v14
  v_mul_f32 v24, s56, v24
  v_exp_f32 v24, v24
  s_nop 0
  v_cvt_pk_bf16_f32 v25, v24, v24
  v_and_b32 v25, 0xffff0000, v25
  v_sub_f32 v25, v24, v25
  v_cndmask_b32 v24, v24, v25, s[58:59]
  v_cvt_pk_bf16_f32 v24, v24, v24
  v_and_b32 v20, v24, v2
  v_and_b32 v21, v24, v3
  v_and_b32 v22, v24, v4
  v_and_b32 v23, v24, v5
  s_waitcnt vmcnt(10)
  v_mfma_f32_16x16x32_bf16 v[10:13], v[16:19], v[56:59], v[10:13]
  v_lshlrev_b32 v24, 16, v36
  v_sub_f32 v24, v24, v14
  v_mul_f32 v24, s56, v24
  v_exp_f32 v24, v24
  s_nop 0
  v_cvt_pk_bf16_f32 v25, v24, v24
  v_and_b32 v25, 0xffff0000, v25
  v_sub_f32 v25, v24, v25
  v_cndmask_b32 v24, v24, v25, s[58:59]
  v_cvt_pk_bf16_f32 v24, v24, v24
  v_and_b32 v16, v24, v2
  v_and_b32 v17, v24, v3
  v_and_b32 v18, v24, v4
  v_and_b32 v19, v24, v5
  s_waitcnt vmcnt(9)
  v_mfma_f32_16x16x32_bf16 v[10:13], v[20:23], v[60:63], v[10:13]
  v_and_b32 v24, 0xffff0000, v35
  v_sub_f32 v24, v24, v14
  v_mul_f32 v24, s56, v24
  v_exp_f32 v24, v24
  s_nop 0
  v_cvt_pk_bf16_f32 v25, v24, v24
  v_and_b32 v25, 0xffff0000, v25
  v_sub_f32 v25, v24, v25
  v_cndmask_b32 v24, v24, v25, s[58:59]
  v_cvt_pk_bf16_f32 v24, v24, v24
  v_and_b32 v20, v24, v2
  v_and_b32 v21, v24, v3
  v_and_b32 v22, v24, v4
  v_and_b32 v23, v24, v5
  s_waitcnt vmcnt(8)
  v_mfma_f32_16x16x32_bf16 v[10:13], v[16:19], v[64:67], v[10:13]
  v_lshlrev_b32 v24, 16, v35
  v_sub_f32 v24, v24, v14
  v_mul_f32 v24, s56, v24
  v_exp_f32 v24, v24
  s_nop 0
  v_cvt_pk_bf16_f32 v25, v24, v24
  v_and_b32 v25, 0xffff0000, v25
  v_sub_f32 v25, v24, v25
  v_cndmask_b32 v24, v24, v25, s[58:59]
  v_cvt_pk_bf16_f32 v24, v24, v24
  v_and_b32 v16, v24, v2
  v_and_b32 v17, v24, v3
  v_and_b32 v18, v24, v4
  v_and_b32 v19, v24, v5
  s_waitcnt vmcnt(7)
  v_mfma_f32_16x16x32_bf16 v[10:13], v[20:23], v[68:71], v[10:13]
  v_and_b32 v24, 0xffff0000, v34
  v_sub_f32 v24, v24, v14
  v_mul_f32 v24, s56, v24
  v_exp_f32 v24, v24
  s_nop 0
  v_cvt_pk_bf16_f32 v25, v24, v24
  v_and_b32 v25, 0xffff0000, v25
  v_sub_f32 v25, v24, v25
  v_cndmask_b32 v24, v24, v25, s[58:59]
  v_cvt_pk_bf16_f32 v24, v24, v24
  v_and_b32 v20, v24, v2
  v_and_b32 v21, v24, v3
  v_and_b32 v22, v24, v4
  v_and_b32 v23, v24, v5
  s_waitcnt vmcnt(6)
  v_mfma_f32_16x16x32_bf16 v[10:13], v[16:19], v[72:75], v[10:13]
  v_lshlrev_b32 v24, 16, v34
  v_sub_f32 v24, v24, v14
  v_mul_f32 v24, s56, v24
  v_exp_f32 v24, v24
  s_nop 0
  v_cvt_pk_bf16_f32 v25, v24, v24
  v_and_b32 v25, 0xffff0000, v25
  v_sub_f32 v25, v24, v25
  v_cndmask_b32 v24, v24, v25, s[58:59]
  v_cvt_pk_bf16_f32 v24, v24, v24
  v_and_b32 v16, v24, v2
  v_and_b32 v17, v24, v3
  v_and_b32 v18, v24, v4
  v_and_b32 v19, v24, v5
  s_waitcnt vmcnt(5)
  v_mfma_f32_16x16x32_bf16 v[10:13], v[20:23], v[76:79], v[10:13]
  v_and_b32 v24, 0xffff0000, v33
  v_sub_f32 v24, v24, v14
  v_mul_f32 v24, s56, v24
  v_exp_f32 v24, v24
  s_nop 0
  v_cvt_pk_bf16_f32 v25, v24, v24
  v_and_b32 v25, 0xffff0000, v25
  v_sub_f32 v25, v24, v25
  v_cndmask_b32 v24, v24, v25, s[58:59]
  v_cvt_pk_bf16_f32 v24, v24, v24
  v_and_b32 v20, v24, v2
  v_and_b32 v21, v24, v3
  v_and_b32 v22, v24, v4
  v_and_b32 v23, v24, v5
  s_waitcnt vmcnt(4)
  v_mfma_f32_16x16x32_bf16 v[10:13], v[16:19], v[80:83], v[10:13]
  v_lshlrev_b32 v24, 16, v33
  v_sub_f32 v24, v24, v14
  v_mul_f32 v24, s56, v24
  v_exp_f32 v24, v24
  s_nop 0
  v_cvt_pk_bf16_f32 v25, v24, v24
  v_and_b32 v25, 0xffff0000, v25
  v_sub_f32 v25, v24, v25
  v_cndmask_b32 v24, v24, v25, s[58:59]
  v_cvt_pk_bf16_f32 v24, v24, v24
  v_and_b32 v16, v24, v2
  v_and_b32 v17, v24, v3
  v_and_b32 v18, v24, v4
  v_and_b32 v19, v24, v5
  s_waitcnt vmcnt(3)
  v_mfma_f32_16x16x32_bf16 v[10:13], v[20:23], v[84:87], v[10:13]
  v_and_b32 v24, 0xffff0000, v32
  v_sub_f32 v24, v24, v14
  v_mul_f32 v24, s56, v24
  v_exp_f32 v24, v24
  s_nop 0
  v_cvt_pk_bf16_f32 v25, v24, v24
  v_and_b32 v25, 0xffff0000, v25
  v_sub_f32 v25, v24, v25
  v_cndmask_b32 v24, v24, v25, s[58:59]
  v_cvt_pk_bf16_f32 v24, v24, v24
  v_and_b32 v20, v24, v2
  v_and_b32 v21, v24, v3
  v_and_b32 v22, v24, v4
  v_and_b32 v23, v24, v5
  s_waitcnt vmcnt(2)
  v_mfma_f32_16x16x32_bf16 v[10:13], v[16:19], v[88:91], v[10:13]
  v_lshlrev_b32 v24, 16, v32
  v_sub_f32 v24, v24, v14
  v_mul_f32 v24, s56, v24
  v_exp_f32 v24, v24
  s_nop 0
  v_cvt_pk_bf16_f32 v25, v24, v24
  v_and_b32 v25, 0xffff0000, v25
  v_sub_f32 v25, v24, v25
  v_cndmask_b32 v24, v24, v25, s[58:59]
  v_cvt_pk_bf16_f32 v24, v24, v24
  v_and_b32 v16, v24, v2
  v_and_b32 v17, v24, v3
  v_and_b32 v18, v24, v4
  v_and_b32 v19, v24, v5
  s_waitcnt vmcnt(1)
  v_mfma_f32_16x16x32_bf16 v[10:13], v[20:23], v[92:95], v[10:13]
  s_waitcnt vmcnt(0)
  v_mfma_f32_16x16x32_bf16 v[10:13], v[16:19], v[96:99], v[10:13]
  s_nop 7
  v_mov_b32 v16, v10
  v_mov_b32 v17, v11
  v_mov_b32 v18, v12
  v_mov_b32 v19, v13
  v_permlane32_swap_b32 v10, v16
  v_permlane32_swap_b32 v11, v17
  v_permlane32_swap_b32 v12, v18
  v_permlane32_swap_b32 v13, v19
  v_add_f32 v10, v10, v16
  v_add_f32 v11, v11, v17
  v_add_f32 v12, v12, v18
  v_add_f32 v13, v13, v19
  v_and_b32 v24, 15, v0
  v_lshlrev_b32 v24, 5, v24
  v_lshrrev_b32 v25, 4, v0
  v_lshl_add_u32 v24, v25, 4, v24
  s_lshl_b32 s52, s3, 9
  v_add_u32 v24, s52, v24
  s_mov_b32 exec_hi, 0
  ds_write_b128 v24, v[10:13] offset:4096
  s_mov_b32 exec_hi, -1
  v_lshrrev_b32 v33, 2, v0
  v_lshlrev_b32 v32, 9, v33
  v_lshlrev_b32 v33, 2, v33
  v_and_b32 v34, 3, v0
  v_lshl_add_u32 v32, v34, 3, v32
  s_lshl_b32 s52, s3, 5
  v_add_u32 v32, s52, v32
  s_lshl_b32 s52, s3, 2
  v_lshl_add_u32 v34, v34, 7, s52
  s_waitcnt lgkmcnt(0)
  s_barrier
  ds_read_b64 v[36:37], v32 offset:4096
  ds_read_b32 v38, v33 offset:3008
  s_waitcnt lgkmcnt(0)
  v_mul_f32 v36, v36, v38
  v_mul_f32 v37, v37, v38
  s_nop 0
  v_add_f32_dpp v36, v36, v36 row_ror:4 row_mask:0xf bank_mask:0xf
  v_add_f32_dpp v37, v37, v37 row_ror:4 row_mask:0xf bank_mask:0xf
  s_nop 0
  v_add_f32_dpp v36, v36, v36 row_ror:8 row_mask:0xf bank_mask:0xf
  v_add_f32_dpp v37, v37, v37 row_ror:8 row_mask:0xf bank_mask:0xf
  v_mov_b32 v38, v36
  v_mov_b32 v39, v37
  s_nop 0
  v_permlane16_swap_b32 v36, v38
  v_permlane16_swap_b32 v37, v39
  v_add_f32 v36, v36, v38
  v_add_f32 v37, v37, v39
  v_mov_b32 v38, v36
  v_mov_b32 v39, v37
  s_nop 0
  v_permlane32_swap_b32 v36, v38
  v_permlane32_swap_b32 v37, v39
  v_add_f32 v36, v36, v38
  v_add_f32 v37, v37, v39
  v_cvt_pk_bf16_f32 v36, v36, v36
  v_cvt_pk_bf16_f32 v37, v37, v37
  s_mov_b64 exec, 15
  ds_write_b32 v34, v36 offset:3072
  ds_write_b32 v34, v37 offset:3136
  s_mov_b64 exec, -1
  s_waitcnt lgkmcnt(0)
  s_barrier
  s_cmp_eq_u32 s72, 1
  s_cbranch_scc1 L_fin_red
  s_cmp_eq_u32 s72, 2
  s_cbranch_scc1 L_fin_ln
  s_cmp_eq_u32 s72, 3
  s_cbranch_scc1 L_fin_dn
  s_endpgm
L_fin_y:
  v_lshrrev_b32 v30, 3, v0
  s_movk_i32 s52, 1280
  v_mul_lo_u32 v30, v30, s52
  v_and_b32 v31, 7, v0
  v_lshl_add_u32 v30, v31, 4, v30
  s_mul_i32 s75, s5, 163840
  s_lshl_b32 s52, s3, 7
  s_add_u32 s75, s75, s52
  v_lshlrev_b32 v24, 16, v37
  v_sub_f32 v24, v24, v14
  v_mul_f32 v24, s56, v24
  v_exp_f32 v24, v24
  s_nop 0
  v_cvt_pk_bf16_f32 v25, v24, v24
  v_and_b32 v25, 0xffff0000, v25
  v_sub_f32 v25, v24, v25
  v_cndmask_b32 v24, v24, v25, s[58:59]
  v_cvt_pk_bf16_f32 v24, v24, v24
  v_and_b32 v16, v24, v2
  v_and_b32 v17, v24, v3
  v_and_b32 v18, v24, v4
  v_and_b32 v19, v24, v5
  s_waitcnt vmcnt(11)
  v_mfma_f32_16x16x32_bf16 v[10:13], v[20:23], v[52:55], v[10:13]
  s_add_u32 s52, s75, 0
  buffer_load_dwordx4 v[100:103], v30, s[20:23], s52 offen
  s_add_u32 s52, s75, 10240
  buffer_load_dwordx4 v[104:107], v30, s[20:23], s52 offen
  v_and_b32 v24, 0xffff0000, v36
  v_sub_f32 v24, v24, v14
  v_mul_f32 v24, s56, v24
  v_exp_f32 v24, v24
  s_nop 0
  v_cvt_pk_bf16_f32 v25, v24, v24
  v_and_b32 v25, 0xffff0000, v25
  v_sub_f32 v25, v24, v25
  v_cndmask_b32 v24, v24, v25, s[58:59]
  v_cvt_pk_bf16_f32 v24, v24, v24
  v_and_b32 v20, v24, v2
  v_and_b32 v21, v24, v3
  v_and_b32 v22, v24, v4
  v_and_b32 v23, v24, v5
  s_waitcnt vmcnt(12)
  v_mfma_f32_16x16x32_bf16 v[10:13], v[16:19], v[56:59], v[10:13]
  s_add_u32 s52, s75, 20480
  buffer_load_dwordx4 v[108:111], v30, s[20:23], s52 offen
  s_add_u32 s52, s75, 30720
  buffer_load_dwordx4 v[112:115], v30, s[20:23], s52 offen
  v_lshlrev_b32 v24, 16, v36
  v_sub_f32 v24, v24, v14
  v_mul_f32 v24, s56, v24
  v_exp_f32 v24, v24
  s_nop 0
  v_cvt_pk_bf16_f32 v25, v24, v24
  v_and_b32 v25, 0xffff0000, v25
  v_sub_f32 v25, v24, v25
  v_cndmask_b32 v24, v24, v25, s[58:59]
  v_cvt_pk_bf16_f32 v24, v24, v24
  v_and_b32 v16, v24, v2
  v_and_b32 v17, v24, v3
  v_and_b32 v18, v24, v4
  v_and_b32 v19, v24, v5
  s_waitcnt vmcnt(13)
  v_mfma_f32_16x16x32_bf16 v[10:13], v[20:23], v[60:63], v[10:13]
  s_add_u32 s52, s75, 40960
  buffer_load_dwordx4 v[52:55], v30, s[20:23], s52 offen
  s_add_u32 s52, s75, 51200
  buffer_load_dwordx4 v[56:59], v30, s[20:23], s52 offen
  v_and_b32 v24, 0xffff0000, v35
  v_sub_f32 v24, v24, v14
  v_mul_f32 v24, s56, v24
  v_exp_f32 v24, v24
  s_nop 0
  v_cvt_pk_bf16_f32 v25, v24, v24
  v_and_b32 v25, 0xffff0000, v25
  v_sub_f32 v25, v24, v25
  v_cndmask_b32 v24, v24, v25, s[58:59]
  v_cvt_pk_bf16_f32 v24, v24, v24
  v_and_b32 v20, v24, v2
  v_and_b32 v21, v24, v3
  v_and_b32 v22, v24, v4
  v_and_b32 v23, v24, v5
  s_waitcnt vmcnt(14)
  v_mfma_f32_16x16x32_bf16 v[10:13], v[16:19], v[64:67], v[10:13]
  s_add_u32 s52, s75, 61440
  buffer_load_dwordx4 v[60:63], v30, s[20:23], s52 offen
  s_add_u32 s52, s75, 71680
  buffer_load_dwordx4 v[64:67], v30, s[20:23], s52 offen
  v_lshlrev_b32 v24, 16, v35
  v_sub_f32 v24, v24, v14
  v_mul_f32 v24, s56, v24
  v_exp_f32 v24, v24
  s_nop 0
  v_cvt_pk_bf16_f32 v25, v24, v24
  v_and_b32 v25, 0xffff0000, v25
  v_sub_f32 v25, v24, v25
  v_cndmask_b32 v24, v24, v25, s[58:59]
  v_cvt_pk_bf16_f32 v24, v24, v24
  v_and_b32 v16, v24, v2
  v_and_b32 v17, v24, v3
  v_and_b32 v18, v24, v4
  v_and_b32 v19, v24, v5
  s_waitcnt vmcnt(15)
  v_mfma_f32_16x16x32_bf16 v[10:13], v[20:23], v[68:71], v[10:13]
  s_add_u32 s52, s75, 81920
  buffer_load_dwordx4 v[68:71], v30, s[20:23], s52 offen
  v_and_b32 v24, 0xffff0000, v34
  v_sub_f32 v24, v24, v14
  v_mul_f32 v24, s56, v24
  v_exp_f32 v24, v24
  s_nop 0
  v_cvt_pk_bf16_f32 v25, v24, v24
  v_and_b32 v25, 0xffff0000, v25
  v_sub_f32 v25, v24, v25
  v_cndmask_b32 v24, v24, v25, s[58:59]
  v_cvt_pk_bf16_f32 v24, v24, v24
  v_and_b32 v20, v24, v2
  v_and_b32 v21, v24, v3
  v_and_b32 v22, v24, v4
  v_and_b32 v23, v24, v5
  s_waitcnt vmcnt(15)
  v_mfma_f32_16x16x32_bf16 v[10:13], v[16:19], v[72:75], v[10:13]
  s_add_u32 s52, s75, 92160
  buffer_load_dwordx4 v[72:75], v30, s[20:23], s52 offen
  v_lshlrev_b32 v24, 16, v34
  v_sub_f32 v24, v24, v14
  v_mul_f32 v24, s56, v24
  v_exp_f32 v24, v24
  s_nop 0
  v_cvt_pk_bf16_f32 v25, v24, v24
  v_and_b32 v25, 0xffff0000, v25
  v_sub_f32 v25, v24, v25
  v_cndmask_b32 v24, v24, v25, s[58:59]
  v_cvt_pk_bf16_f32 v24, v24, v24
  v_and_b32 v16, v24, v2
  v_and_b32 v17, v24, v3
  v_and_b32 v18, v24, v4
  v_and_b32 v19, v24, v5
  s_waitcnt vmcnt(15)
  v_mfma_f32_16x16x32_bf16 v[10:13], v[20:23], v[76:79], v[10:13]
  s_add_u32 s52, s75, 102400
  buffer_load_dwordx4 v[76:79], v30, s[20:23], s52 offen
  v_and_b32 v24, 0xffff0000, v33
  v_sub_f32 v24, v24, v14
  v_mul_f32 v24, s56, v24
  v_exp_f32 v24, v24
  s_nop 0
  v_cvt_pk_bf16_f32 v25, v24, v24
  v_and_b32 v25, 0xffff0000, v25
  v_sub_f32 v25, v24, v25
  v_cndmask_b32 v24, v24, v25, s[58:59]
  v_cvt_pk_bf16_f32 v24, v24, v24
  v_and_b32 v20, v24, v2
  v_and_b32 v21, v24, v3
  v_and_b32 v22, v24, v4
  v_and_b32 v23, v24, v5
  s_waitcnt vmcnt(15)
  v_mfma_f32_16x16x32_bf16 v[10:13], v[16:19], v[80:83], v[10:13]
  s_add_u32 s52, s75, 112640
  buffer_load_dwordx4 v[80:83], v30, s[20:23], s52 offen
  v_lshlrev_b32 v24, 16, v33
  v_sub_f32 v24, v24, v14
  v_mul_f32 v24, s56, v24
  v_exp_f32 v24, v24
  s_nop 0
  v_cvt_pk_bf16_f32 v25, v24, v24
  v_and_b32 v25, 0xffff0000, v25
  v_sub_f32 v25, v24, v25
  v_cndmask_b32 v24, v24, v25, s[58:59]
  v_cvt_pk_bf16_f32 v24, v24, v24
  v_and_b32 v16, v24, v2
  v_and_b32 v17, v24, v3
  v_and_b32 v18, v24, v4
  v_and_b32 v19, v24, v5
  s_waitcnt vmcnt(15)
  v_mfma_f32_16x16x32_bf16 v[10:13], v[20:23], v[84:87], v[10:13]
  s_add_u32 s52, s75, 122880
  buffer_load_dwordx4 v[84:87], v30, s[20:23], s52 offen
  v_and_b32 v24, 0xffff0000, v32
  v_sub_f32 v24, v24, v14
  v_mul_f32 v24, s56, v24
  v_exp_f32 v24, v24
  s_nop 0
  v_cvt_pk_bf16_f32 v25, v24, v24
  v_and_b32 v25, 0xffff0000, v25
  v_sub_f32 v25, v24, v25
  v_cndmask_b32 v24, v24, v25, s[58:59]
  v_cvt_pk_bf16_f32 v24, v24, v24
  v_and_b32 v20, v24, v2
  v_and_b32 v21, v24, v3
  v_and_b32 v22, v24, v4
  v_and_b32 v23, v24, v5
  s_waitcnt vmcnt(15)
  v_mfma_f32_16x16x32_bf16 v[10:13], v[16:19], v[88:91], v[10:13]
  s_add_u32 s52, s75, 133120
  buffer_load_dwordx4 v[88:91], v30, s[20:23], s52 offen
  v_lshlrev_b32 v24, 16, v32
  v_sub_f32 v24, v24, v14
  v_mul_f32 v24, s56, v24
  v_exp_f32 v24, v24
  s_nop 0
  v_cvt_pk_bf16_f32 v25, v24, v24
  v_and_b32 v25, 0xffff0000, v25
  v_sub_f32 v25, v24, v25
  v_cndmask_b32 v24, v24, v25, s[58:59]
  v_cvt_pk_bf16_f32 v24, v24, v24
  v_and_b32 v16, v24, v2
  v_and_b32 v17, v24, v3
  v_and_b32 v18, v24, v4
  v_and_b32 v19, v24, v5
  s_waitcnt vmcnt(15)
  v_mfma_f32_16x16x32_bf16 v[10:13], v[20:23], v[92:95], v[10:13]
  s_add_u32 s52, s75, 143360
  buffer_load_dwordx4 v[92:95], v30, s[20:23], s52 offen
  s_waitcnt vmcnt(15)
  v_mfma_f32_16x16x32_bf16 v[10:13], v[16:19], v[96:99], v[10:13]
  s_add_u32 s52, s75, 153600
  buffer_load_dwordx4 v[96:99], v30, s[20:23], s52 offen
  s_nop 5
  v_mov_b32 v16, v10
  v_mov_b32 v17, v11
  v_mov_b32 v18, v12
  v_mov_b32 v19, v13
  v_permlane32_swap_b32 v10, v16
  v_permlane32_swap_b32 v11, v17
  v_permlane32_swap_b32 v12, v18
  v_permlane32_swap_b32 v13, v19
  v_add_f32 v10, v10, v16
  v_add_f32 v11, v11, v17
  v_add_f32 v12, v12, v18
  v_add_f32 v13, v13, v19
  v_and_b32 v24, 15, v0
  v_lshlrev_b32 v24, 5, v24
  v_lshrrev_b32 v25, 4, v0
  v_lshl_add_u32 v24, v25, 4, v24
  s_lshl_b32 s52, s3, 9
  v_add_u32 v24, s52, v24
  s_mov_b32 exec_hi, 0
  ds_write_b128 v24, v[10:13] offset:4096
  s_mov_b32 exec_hi, -1
  s_waitcnt vmcnt(0)
  v_bfe_u32 v48, v0, 2, 1
  v_lshlrev_b32 v48, 13, v48
  v_and_b32 v49, 3, v0
  v_lshl_add_u32 v48, v49, 5, v48
  v_lshrrev_b32 v49, 4, v0
  v_lshl_add_u32 v48, v49, 4, v48
  v_and_b32 v44, 31, v0
  v_lshlrev_b32 v44, 4, v44
  v_lshrrev_b32 v45, 5, v0
  v_lshl_add_u32 v44, v45, 12, v44
  v_lshlrev_b32 v45, 5, v45
  v_and_b32 v46, 1, v0
  v_lshlrev_b32 v46, 8, v46
  v_bfe_u32 v47, v0, 1, 4
  v_lshl_add_u32 v46, v47, 2, v46
  v_lshrrev_b32 v47, 3, v0
  v_lshlrev_b32 v47, 6, v47
  s_cmp_lg_u32 s3, 0
  s_nop 0
  s_cbranch_scc1 L_stg_21z
  v_mov_b32 v25, 2828
  s_mov_b32 s61, 0
  s_nop 0
L_lw_22r:
  ds_read_b32 v24, v25
  s_waitcnt lgkmcnt(0)
  v_readfirstlane_b32 s52, v24
  s_cmp_ge_u32 s52, 16
  s_nop 3
  s_cbranch_scc1 L_lw_22o
  s_sleep 16
  s_add_u32 s61, s61, 1
  s_cmp_lt_u32 s61, 300000
  s_cbranch_scc1 L_lw_22r
L_lw_22o:
  v_and_b32 v26, 15, v0
  v_lshlrev_b32 v26, 3, v26
  ds_read_b64 v[24:25], v26 offset:2880
  s_xor_b32 s52, s4, 1
  s_lshl_b32 s52, s52, 7
  s_add_u32 s74, s74, s52
  s_mov_b32 s61, 0
L_stp_23r:
  buffer_load_dwordx2 v[50:51], v26, s[48:51], s74 offen sc1
  s_waitcnt vmcnt(0) lgkmcnt(0)
  v_max_u32 v27, v50, v51
  v_cmp_eq_u32 vcc, -1, v27
  s_nop 4
  s_cbranch_vccz L_stp_23o
  s_sleep 4
  s_add_u32 s61, s61, 1
  s_cmp_lt_u32 s61, 300000
  s_cbranch_scc1 L_stp_23r
L_stp_23o:
  v_max_f32 v27, v50, v24
  s_nop 1
  v_max_f32_dpp v27, v27, v27 row_ror:8 row_mask:0xf bank_mask:0xf
  s_nop 1
  v_max_f32_dpp v27, v27, v27 row_ror:4 row_mask:0xf bank_mask:0xf
  s_nop 1
  v_max_f32_dpp v27, v27, v27 row_ror:2 row_mask:0xf bank_mask:0xf
  s_nop 1
  v_max_f32_dpp v27, v27, v27 row_ror:1 row_mask:0xf bank_mask:0xf
  v_sub_f32 v28, v50, v27
  v_sub_f32 v24, v24, v27
  v_mul_f32 v28, s56, v28
  v_mul_f32 v24, s56, v24
  v_exp_f32 v28, v28
  v_exp_f32 v24, v24
  v_mul_f32 v28, v28, v51
  v_mul_f32 v29, v24, v25
  s_cmp_eq_u32 s4, 0
  s_cselect_b64 vcc, -1, 0
  v_add_f32_dpp v28, v28, v28 row_ror:8 row_mask:0xf bank_mask:0xf
  v_add_f32_dpp v29, v29, v29 row_ror:8 row_mask:0xf bank_mask:0xf
  s_nop 0
  v_add_f32_dpp v28, v28, v28 row_ror:4 row_mask:0xf bank_mask:0xf
  v_add_f32_dpp v29, v29, v29 row_ror:4 row_mask:0xf bank_mask:0xf
  s_nop 0
  v_add_f32_dpp v28, v28, v28 row_ror:2 row_mask:0xf bank_mask:0xf
  v_add_f32_dpp v29, v29, v29 row_ror:2 row_mask:0xf bank_mask:0xf
  s_nop 0
  v_add_f32_dpp v28, v28, v28 row_ror:1 row_mask:0xf bank_mask:0xf
  v_add_f32_dpp v29, v29, v29 row_ror:1 row_mask:0xf bank_mask:0xf
  v_cndmask_b32 v27, v28, v29, vcc
  v_cndmask_b32 v28, v29, v28, vcc
  v_add_f32 v28, v27, v28
  v_rcp_f32 v28, v28
  v_lshrrev_b32 v26, 1, v26
  v_mul_f32 v24, v24, v28
  ds_write_b32 v26, v24 offset:3008
  s_nop 0
L_stg_21z:
  v_lshrrev_b32 v33, 2, v0
  v_lshlrev_b32 v32, 9, v33
  v_lshlrev_b32 v33, 2, v33
  v_and_b32 v34, 3, v0
  v_lshl_add_u32 v32, v34, 3, v32
  s_lshl_b32 s52, s3, 5
  v_add_u32 v32, s52, v32
  s_lshl_b32 s52, s3, 2
  v_lshl_add_u32 v34, v34, 7, s52
  s_waitcnt lgkmcnt(0)
  s_barrier
  ds_read_b64 v[36:37], v32 offset:4096
  ds_read_b32 v38, v33 offset:3008
  s_waitcnt lgkmcnt(0)
  v_mul_f32 v36, v36, v38
  v_mul_f32 v37, v37, v38
  s_nop 0
  v_add_f32_dpp v36, v36, v36 row_ror:4 row_mask:0xf bank_mask:0xf
  v_add_f32_dpp v37, v37, v37 row_ror:4 row_mask:0xf bank_mask:0xf
  s_nop 0
  v_add_f32_dpp v36, v36, v36 row_ror:8 row_mask:0xf bank_mask:0xf
  v_add_f32_dpp v37, v37, v37 row_ror:8 row_mask:0xf bank_mask:0xf
  v_mov_b32 v38, v36
  v_mov_b32 v39, v37
  s_nop 0
  v_permlane16_swap_b32 v36, v38
  v_permlane16_swap_b32 v37, v39
  v_add_f32 v36, v36, v38
  v_add_f32 v37, v37, v39
  v_mov_b32 v38, v36
  v_mov_b32 v39, v37
  s_nop 0
  v_permlane32_swap_b32 v36, v38
  v_permlane32_swap_b32 v37, v39
  v_add_f32 v36, v36, v38
  v_add_f32 v37, v37, v39
  v_cvt_pk_bf16_f32 v36, v36, v36
  v_cvt_pk_bf16_f32 v37, v37, v37
  s_mov_b64 exec, 15
  ds_write_b32 v34, v36 offset:3072
  ds_write_b32 v34, v37 offset:3136
  s_mov_b64 exec, -1
  s_waitcnt lgkmcnt(0)
  s_barrier
  ds_read_b128 v[28:31], v47 offset:3072
  ds_read_b128 v[32:35], v47 offset:3088
  ds_read_b128 v[36:39], v47 offset:3104
  ds_read_b128 v[40:43], v47 offset:3120
  v_mov_b32 v10, 0
  v_mov_b32 v11, 0
  v_mov_b32 v12, 0
  v_mov_b32 v13, 0
  v_mov_b32 v116, 0
  v_mov_b32 v117, 0
  v_mov_b32 v118, 0
  v_mov_b32 v119, 0
  s_waitcnt lgkmcnt(3)
  v_and_b32 v16, v28, v2
  v_and_b32 v17, v28, v3
  v_and_b32 v18, v28, v4
  v_and_b32 v19, v28, v5
  v_and_b32 v20, v29, v2
  v_and_b32 v21, v29, v3
  v_and_b32 v22, v29, v4
  v_and_b32 v23, v29, v5
  v_mfma_f32_16x16x32_bf16 v[10:13], v[16:19], v[100:103], v[10:13]
  v_and_b32 v24, v30, v2
  v_and_b32 v25, v30, v3
  v_and_b32 v26, v30, v4
  v_and_b32 v27, v30, v5
  v_mfma_f32_16x16x32_bf16 v[116:119], v[20:23], v[104:107], v[116:119]
  v_and_b32 v16, v31, v2
  v_and_b32 v17, v31, v3
  v_and_b32 v18, v31, v4
  v_and_b32 v19, v31, v5
  v_mfma_f32_16x16x32_bf16 v[10:13], v[24:27], v[108:111], v[10:13]
  s_waitcnt lgkmcnt(2)
  v_and_b32 v20, v32, v2
  v_and_b32 v21, v32, v3
  v_and_b32 v22, v32, v4
  v_and_b32 v23, v32, v5
  v_mfma_f32_16x16x32_bf16 v[116:119], v[16:19], v[112:115], v[116:119]
  v_and_b32 v24, v33, v2
  v_and_b32 v25, v33, v3
  v_and_b32 v26, v33, v4
  v_and_b32 v27, v33, v5
  v_mfma_f32_16x16x32_bf16 v[10:13], v[20:23], v[52:55], v[10:13]
  v_and_b32 v16, v34, v2
  v_and_b32 v17, v34, v3
  v_and_b32 v18, v34, v4
  v_and_b32 v19, v34, v5
  v_mfma_f32_16x16x32_bf16 v[116:119], v[24:27], v[56:59], v[116:119]
  v_and_b32 v20, v35, v2
  v_and_b32 v21, v35, v3
  v_and_b32 v22, v35, v4
  v_and_b32 v23, v35, v5
  v_mfma_f32_16x16x32_bf16 v[10:13], v[16:19], v[60:63], v[10:13]
  s_waitcnt lgkmcnt(1)
  v_and_b32 v24, v36, v2
  v_and_b32 v25, v36, v3
  v_and_b32 v26, v36, v4
  v_and_b32 v27, v36, v5
  v_mfma_f32_16x16x32_bf16 v[116:119], v[20:23], v[64:67], v[116:119]
  v_and_b32 v16, v37, v2
  v_and_b32 v17, v37, v3
  v_and_b32 v18, v37, v4
  v_and_b32 v19, v37, v5
  v_mfma_f32_16x16x32_bf16 v[10:13], v[24:27], v[68:71], v[10:13]
  v_and_b32 v20, v38, v2
  v_and_b32 v21, v38, v3
  v_and_b32 v22, v38, v4
  v_and_b32 v23, v38, v5
  v_mfma_f32_16x16x32_bf16 v[116:119], v[16:19], v[72:75], v[116:119]
  v_and_b32 v24, v39, v2
  v_and_b32 v25, v39, v3
  v_and_b32 v26, v39, v4
  v_and_b32 v27, v39, v5
  v_mfma_f32_16x16x32_bf16 v[10:13], v[20:23], v[76:79], v[10:13]
  s_waitcnt lgkmcnt(0)
  v_and_b32 v16, v40, v2
  v_and_b32 v17, v40, v3
  v_and_b32 v18, v40, v4
  v_and_b32 v19, v40, v5
  v_mfma_f32_16x16x32_bf16 v[116:119], v[24:27], v[80:83], v[116:119]
  v_and_b32 v20, v41, v2
  v_and_b32 v21, v41, v3
  v_and_b32 v22, v41, v4
  v_and_b32 v23, v41, v5
  v_mfma_f32_16x16x32_bf16 v[10:13], v[16:19], v[84:87], v[10:13]
  v_and_b32 v24, v42, v2
  v_and_b32 v25, v42, v3
  v_and_b32 v26, v42, v4
  v_and_b32 v27, v42, v5
  v_mfma_f32_16x16x32_bf16 v[116:119], v[20:23], v[88:91], v[116:119]
  v_and_b32 v16, v43, v2
  v_and_b32 v17, v43, v3
  v_and_b32 v18, v43, v4
  v_and_b32 v19, v43, v5
  v_mfma_f32_16x16x32_bf16 v[10:13], v[24:27], v[92:95], v[10:13]
  s_nop 0
  v_mfma_f32_16x16x32_bf16 v[116:119], v[16:19], v[96:99], v[116:119]
  s_nop 7
  v_add_f32 v10, v10, v116
  v_add_f32 v11, v11, v117
  v_add_f32 v12, v12, v118
  v_add_f32 v13, v13, v119
  v_mov_b32 v24, v10
  v_mov_b32 v25, v11
  v_mov_b32 v26, v12
  v_mov_b32 v27, v13
  v_permlane32_swap_b32 v10, v24
  v_permlane32_swap_b32 v11, v25
  v_permlane32_swap_b32 v12, v26
  v_permlane32_swap_b32 v13, v27
  v_add_f32_dpp v10, v24, v10 row_ror:8 row_mask:0xf bank_mask:0xf
  v_add_f32_dpp v11, v25, v11 row_ror:8 row_mask:0xf bank_mask:0xf
  v_add_f32_dpp v12, v26, v12 row_ror:8 row_mask:0xf bank_mask:0xf
  v_add_f32_dpp v13, v27, v13 row_ror:8 row_mask:0xf bank_mask:0xf
  v_min_u32 v10, 0xfffffffe, v10
  v_min_u32 v11, 0xfffffffe, v11
  v_min_u32 v12, 0xfffffffe, v12
  v_min_u32 v13, 0xfffffffe, v13
  s_mov_b32 exec_lo, 0x00ff00ff
  s_mov_b32 exec_hi, 0
  buffer_store_dwordx4 v[10:13], v48, s[48:51], s68 offen sc1
  s_mov_b64 exec, -1
  v_mov_b32 v24, 1
  v_mov_b32 v25, 2832
  s_mov_b64 exec, 1
  ds_add_u32 v25, v24
  s_mov_b64 exec, -1
  s_endpgm
L_fin_red:
  v_and_b32 v33, 7, v0
  v_lshlrev_b32 v33, 3, v33
  s_sub_u32 s75, s69, 720896
  buffer_load_dwordx2 v[34:35], v33, s[36:39], s75 offen
  s_lshl_b32 s75, s64, 13
  s_add_u32 s75, s75, 65536
  s_add_u32 s76, s75, 4096
  s_mov_b32 s61, 0
L_red_24r:
  buffer_load_dwordx4 v[64:67], v1, s[48:51], s75 offen offset:0 sc1
  buffer_load_dwordx4 v[68:71], v1, s[48:51], s75 offen offset:1024 sc1
  buffer_load_dwordx4 v[72:75], v1, s[48:51], s75 offen offset:2048 sc1
  buffer_load_dwordx4 v[76:79], v1, s[48:51], s75 offen offset:3072 sc1
  buffer_load_dwordx4 v[80:83], v1, s[48:51], s76 offen offset:0 sc1
  buffer_load_dwordx4 v[84:87], v1, s[48:51], s76 offen offset:1024 sc1
  buffer_load_dwordx4 v[88:91], v1, s[48:51], s76 offen offset:2048 sc1
  buffer_load_dwordx4 v[92:95], v1, s[48:51], s76 offen offset:3072 sc1
  s_waitcnt vmcnt(0)
  v_max3_u32 v32, v64, v65, v66
  v_max3_u32 v36, v67, v68, v69
  v_max3_u32 v32, v32, v70, v71
  v_max3_u32 v36, v36, v72, v73
  v_max3_u32 v32, v32, v74, v75
  v_max3_u32 v36, v36, v76, v77
  v_max3_u32 v32, v32, v78, v79
  v_max3_u32 v36, v36, v80, v81
  v_max3_u32 v32, v32, v82, v83
  v_max3_u32 v36, v36, v84, v85
  v_max3_u32 v32, v32, v86, v87
  v_max3_u32 v36, v36, v88, v89
  v_max3_u32 v32, v32, v90, v91
  v_max3_u32 v36, v36, v92, v93
  v_max3_u32 v32, v32, v94, v95
  v_max_u32 v32, v32, v36
  v_cmp_eq_u32 vcc, -1, v32
  s_nop 4
  s_cbranch_vccz L_red_24o
  s_sleep 1
  s_add_u32 s61, s61, 1
  s_cmp_lt_u32 s61, 300000
  s_cbranch_scc1 L_red_24r
L_red_24o:
  v_add_f32 v64, v64, v80
  v_add_f32 v65, v65, v81
  v_add_f32 v66, v66, v82
  v_add_f32 v67, v67, v83
  v_add_f32 v68, v68, v84
  v_add_f32 v69, v69, v85
  v_add_f32 v70, v70, v86
  v_add_f32 v71, v71, v87
  v_add_f32 v72, v72, v88
  v_add_f32 v73, v73, v89
  v_add_f32 v74, v74, v90
  v_add_f32 v75, v75, v91
  v_add_f32 v76, v76, v92
  v_add_f32 v77, v77, v93
  v_add_f32 v78, v78, v94
  v_add_f32 v79, v79, v95
  v_add_f32 v64, v64, v72
  v_add_f32 v65, v65, v73
  v_add_f32 v66, v66, v74
  v_add_f32 v67, v67, v75
  v_add_f32 v68, v68, v76
  v_add_f32 v69, v69, v77
  v_add_f32 v70, v70, v78
  v_add_f32 v71, v71, v79
  v_add_f32 v64, v64, v68
  v_add_f32 v65, v65, v69
  v_add_f32 v66, v66, v70
  v_add_f32 v67, v67, v71
  v_add_f32_dpp v64, v64, v64 row_ror:8 row_mask:0xf bank_mask:0xf
  v_add_f32_dpp v65, v65, v65 row_ror:8 row_mask:0xf bank_mask:0xf
  v_add_f32_dpp v66, v66, v66 row_ror:8 row_mask:0xf bank_mask:0xf
  v_add_f32_dpp v67, v67, v67 row_ror:8 row_mask:0xf bank_mask:0xf
  v_mov_b32 v68, v64
  v_mov_b32 v69, v65
  v_mov_b32 v70, v66
  v_mov_b32 v71, v67
  v_permlane16_swap_b32 v64, v68
  v_permlane16_swap_b32 v65, v69
  v_permlane16_swap_b32 v66, v70
  v_permlane16_swap_b32 v67, v71
  v_add_f32 v64, v64, v68
  v_add_f32 v65, v65, v69
  v_add_f32 v66, v66, v70
  v_add_f32 v67, v67, v71
  v_mov_b32 v68, v64
  v_mov_b32 v69, v65
  v_mov_b32 v70, v66
  v_mov_b32 v71, v67
  v_permlane32_swap_b32 v64, v68
  v_permlane32_swap_b32 v65, v69
  v_permlane32_swap_b32 v66, v70
  v_permlane32_swap_b32 v67, v71
  v_add_f32 v64, v64, v68
  v_add_f32 v65, v65, v69
  v_add_f32 v66, v66, v70
  v_add_f32 v67, v67, v71
  v_cvt_pk_bf16_f32 v68, v64, v65
  v_cvt_pk_bf16_f32 v69, v66, v67
  v_lshlrev_b32 v64, 16, v68
  v_and_b32 v65, 0xffff0000, v68
  v_lshlrev_b32 v66, 16, v69
  v_and_b32 v67, 0xffff0000, v69
  v_lshlrev_b32 v72, 16, v34
  v_and_b32 v73, 0xffff0000, v34
  v_lshlrev_b32 v74, 16, v35
  v_and_b32 v75, 0xffff0000, v35
  v_add_f32 v64, v64, v72
  v_add_f32 v65, v65, v73
  v_add_f32 v66, v66, v74
  v_add_f32 v67, v67, v75
  v_cvt_pk_bf16_f32 v68, v64, v65
  v_cvt_pk_bf16_f32 v69, v66, v67
  v_min_u32 v68, 0xfffffffe, v68
  v_min_u32 v69, 0xfffffffe, v69
  v_lshrrev_b32 v32, 3, v0
  v_lshl_add_u32 v33, v32, 13, v33
  v_mov_b32_dpp v70, v68 row_shl:1 row_mask:0xf bank_mask:0xf
  v_mov_b32_dpp v71, v69 row_shl:1 row_mask:0xf bank_mask:0xf
  s_mov_b32 exec_lo, 0x55555555
  s_mov_b32 exec_hi, 0x55555555
  buffer_store_dwordx4 v[68:71], v33, s[48:51], s69 offen sc1
  s_mov_b64 exec, -1
  v_mov_b32 v36, 1
  v_mov_b32 v37, 2840
  s_mov_b64 exec, 1
  ds_add_u32 v37, v36
  s_mov_b64 exec, -1
  s_endpgm
L_fin_ln:
  s_movk_i32 s52, 3456
  v_mul_lo_u32 v30, v0, s52
  s_and_b32 s76, s71, 1
  s_mul_i32 s76, s76, 1105920
  s_lshl_b32 s52, s62, 4
  s_add_u32 s76, s76, s52
  s_mul_i32 s77, s71, 5120
  s_add_u32 s77, s77, 18432
  s_cmp_lt_u32 s71, 2
  s_cbranch_scc1 L_early_25
  v_mov_b32 v17, 2832
  s_mov_b32 s61, 0
  s_nop 0
L_lw_26r:
  ds_read_b32 v16, v17
  s_waitcnt lgkmcnt(0)
  v_readfirstlane_b32 s52, v16
  s_cmp_ge_u32 s52, 10
  s_nop 3
  s_cbranch_scc1 L_lw_26o
  s_sleep 1
  s_add_u32 s61, s61, 1
  s_cmp_lt_u32 s61, 4800000
  s_cbranch_scc1 L_lw_26r
L_lw_26o:
L_early_25:
  s_cmp_ge_u32 s71, 2
  s_cbranch_scc1 L_stage_27u
  s_add_u32 m0, s77, 0
  s_add_u32 s52, s76, 0
  buffer_load_dwordx4 v30, s[24:27], s52 offen  lds
  s_add_u32 m0, s77, 1024
  s_add_u32 s52, s76, 221184
  buffer_load_dwordx4 v30, s[24:27], s52 offen  lds
  s_add_u32 m0, s77, 2048
  s_add_u32 s52, s76, 442368
  buffer_load_dwordx4 v30, s[24:27], s52 offen  lds
  s_add_u32 m0, s77, 3072
  s_add_u32 s52, s76, 663552
  buffer_load_dwordx4 v30, s[24:27], s52 offen  lds
  s_add_u32 m0, s77, 4096
  s_add_u32 s52, s76, 884736
  buffer_load_dwordx4 v30, s[24:27], s52 offen  lds
  s_branch L_stage_27z
L_stage_27u:
  s_add_u32 m0, s77, 0
  s_add_u32 s52, s76, 0
  buffer_load_dwordx4 v30, s[28:31], s52 offen  lds
  s_add_u32 m0, s77, 1024
  s_add_u32 s52, s76, 221184
  buffer_load_dwordx4 v30, s[28:31], s52 offen  lds
  s_add_u32 m0, s77, 2048
  s_add_u32 s52, s76, 442368
  buffer_load_dwordx4 v30, s[28:31], s52 offen  lds
  s_add_u32 m0, s77, 3072
  s_add_u32 s52, s76, 663552
  buffer_load_dwordx4 v30, s[28:31], s52 offen  lds
  s_add_u32 m0, s77, 4096
  s_add_u32 s52, s76, 884736
  buffer_load_dwordx4 v30, s[28:31], s52 offen  lds
L_stage_27z:
  s_waitcnt vmcnt(0)
  v_mov_b32 v16, 1
  v_mov_b32 v17, 2836
  s_mov_b64 exec, 1
  ds_add_u32 v17, v16
  s_mov_b64 exec, -1
  v_mov_b32 v17, 2836
  s_mov_b32 s61, 0
  s_nop 0
L_lw_28r:
  ds_read_b32 v16, v17
  s_waitcnt lgkmcnt(0)
  v_readfirstlane_b32 s52, v16
  s_cmp_ge_u32 s52, 4
  s_nop 3
  s_cbranch_scc1 L_lw_28o
  s_sleep 1
  s_add_u32 s61, s61, 1
  s_cmp_lt_u32 s61, 4800000
  s_cbranch_scc1 L_lw_28r
L_lw_28o:
  v_bfe_u32 v18, v0, 1, 1
  s_movk_i32 s52, 10240
  v_mul_lo_u32 v18, v18, s52
  v_lshrrev_b32 v17, 4, v0
  v_lshl_add_u32 v18, v17, 7, v18
  v_bfe_u32 v17, v0, 2, 2
  v_lshl_add_u32 v18, v17, 4, v18
  v_and_b32 v17, 1, v0
  v_lshl_add_u32 v18, v17, 3, v18
  ds_read_b64_tr_b16 v[48:49], v18 offset:18432
  ds_read_b64_tr_b16 v[50:51], v18 offset:18496
  ds_read_b64_tr_b16 v[52:53], v18 offset:18944
  ds_read_b64_tr_b16 v[54:55], v18 offset:19008
  ds_read_b64_tr_b16 v[56:57], v18 offset:19456
  ds_read_b64_tr_b16 v[58:59], v18 offset:19520
  ds_read_b64_tr_b16 v[60:61], v18 offset:19968
  ds_read_b64_tr_b16 v[62:63], v18 offset:20032
  s_waitcnt lgkmcnt(0)
  ds_read_b64_tr_b16 v[64:65], v18 offset:20480
  ds_read_b64_tr_b16 v[66:67], v18 offset:20544
  ds_read_b64_tr_b16 v[68:69], v18 offset:20992
  ds_read_b64_tr_b16 v[70:71], v18 offset:21056
  ds_read_b64_tr_b16 v[72:73], v18 offset:21504
  ds_read_b64_tr_b16 v[74:75], v18 offset:21568
  ds_read_b64_tr_b16 v[76:77], v18 offset:22016
  ds_read_b64_tr_b16 v[78:79], v18 offset:22080
  s_waitcnt lgkmcnt(0)
  ds_read_b64_tr_b16 v[80:81], v18 offset:22528
  ds_read_b64_tr_b16 v[82:83], v18 offset:22592
  ds_read_b64_tr_b16 v[84:85], v18 offset:23040
  ds_read_b64_tr_b16 v[86:87], v18 offset:23104
  ds_read_b64_tr_b16 v[88:89], v18 offset:23552
  ds_read_b64_tr_b16 v[90:91], v18 offset:23616
  ds_read_b64_tr_b16 v[92:93], v18 offset:24064
  ds_read_b64_tr_b16 v[94:95], v18 offset:24128
  s_waitcnt lgkmcnt(0)
  ds_read_b64_tr_b16 v[96:97], v18 offset:24576
  ds_read_b64_tr_b16 v[98:99], v18 offset:24640
  ds_read_b64_tr_b16 v[100:101], v18 offset:25088
  ds_read_b64_tr_b16 v[102:103], v18 offset:25152
  ds_read_b64_tr_b16 v[104:105], v18 offset:25600
  ds_read_b64_tr_b16 v[106:107], v18 offset:25664
  ds_read_b64_tr_b16 v[108:109], v18 offset:26112
  ds_read_b64_tr_b16 v[110:111], v18 offset:26176
  s_waitcnt lgkmcnt(0)
  ds_read_b64_tr_b16 v[112:113], v18 offset:26624
  ds_read_b64_tr_b16 v[114:115], v18 offset:26688
  ds_read_b64_tr_b16 v[116:117], v18 offset:27136
  ds_read_b64_tr_b16 v[118:119], v18 offset:27200
  ds_read_b64_tr_b16 v[120:121], v18 offset:27648
  ds_read_b64_tr_b16 v[122:123], v18 offset:27712
  ds_read_b64_tr_b16 v[124:125], v18 offset:28160
  ds_read_b64_tr_b16 v[126:127], v18 offset:28224
  s_waitcnt lgkmcnt(0)
  s_cmp_ge_u32 s64, 80
  s_cbranch_scc1 L_gate_29
  v_mov_b32 v17, 2840
  s_mov_b32 s61, 0
  s_nop 0
L_lw_30r:
  ds_read_b32 v16, v17
  s_waitcnt lgkmcnt(0)
  v_readfirstlane_b32 s52, v16
  s_cmp_ge_u32 s52, 1
  s_nop 3
  s_cbranch_scc1 L_lw_30o
  s_sleep 1
  s_add_u32 s61, s61, 1
  s_cmp_lt_u32 s61, 4800000
  s_cbranch_scc1 L_lw_30r
L_lw_30o:
L_gate_29:
  v_lshlrev_b32 v16, 2, v0
  s_mul_i32 s75, s71, 1280
  s_add_u32 s76, s75, 720896
  s_and_b32 s52, s2, 7
  s_lshl_b32 s52, s52, 13
  s_add_u32 s76, s76, s52
  s_mov_b32 s61, 0
L_hp_31r:
  buffer_load_dword v18, v16, s[48:51], s76 offen offset:0 sc1
  buffer_load_dword v19, v16, s[48:51], s76 offen offset:256 sc1
  buffer_load_dword v20, v16, s[48:51], s76 offen offset:512 sc1
  buffer_load_dword v21, v16, s[48:51], s76 offen offset:768 sc1
  buffer_load_dword v22, v16, s[48:51], s76 offen offset:1024 sc1
  s_waitcnt vmcnt(0)
  v_max3_u32 v17, v18, v19, v20
  v_max3_u32 v17, v17, v21, v22
  v_cmp_eq_u32 vcc, -1, v17
  s_nop 4
  s_cbranch_vccz L_hp_31o
  s_sleep 1
  s_add_u32 s61, s61, 1
  s_cmp_lt_u32 s61, 300000
  s_cbranch_scc1 L_hp_31r
L_hp_31o:
  v_dot2_f32_bf16 v23, v18, s57, 0
  v_dot2_f32_bf16 v23, v19, s57, v23
  v_dot2_f32_bf16 v23, v20, s57, v23
  v_dot2_f32_bf16 v23, v21, s57, v23
  v_dot2_f32_bf16 v23, v22, s57, v23
  v_lshlrev_b32 v28, 16, v18
  v_and_b32 v29, 0xffff0000, v18
  v_lshlrev_b32 v30, 16, v19
  v_and_b32 v31, 0xffff0000, v19
  v_lshlrev_b32 v32, 16, v20
  v_and_b32 v33, 0xffff0000, v20
  v_lshlrev_b32 v34, 16, v21
  v_and_b32 v35, 0xffff0000, v21
  v_lshlrev_b32 v36, 16, v22
  v_and_b32 v37, 0xffff0000, v22
  v_add_f32_dpp v23, v23, v23 row_ror:8 row_mask:0xf bank_mask:0xf
  s_nop 1
  v_add_f32_dpp v23, v23, v23 row_ror:4 row_mask:0xf bank_mask:0xf
  s_nop 1
  v_add_f32_dpp v23, v23, v23 row_ror:2 row_mask:0xf bank_mask:0xf
  s_nop 1
  v_add_f32_dpp v23, v23, v23 row_ror:1 row_mask:0xf bank_mask:0xf
  v_mov_b32 v24, v23
  s_nop 1
  v_permlane16_swap_b32 v23, v24
  v_add_f32 v23, v23, v24
  v_mov_b32 v24, v23
  s_nop 1
  v_permlane32_swap_b32 v23, v24
  v_add_f32 v23, v23, v24
  v_mul_f32 v23, 0x3acccccd, v23
  v_cvt_pk_bf16_f32 v24, v23, v23
  v_and_b32 v24, 0xffff0000, v24
  v_sub_f32 v23, v23, v24
  v_sub_f32 v28, v28, v24
  v_sub_f32 v29, v29, v24
  v_sub_f32 v30, v30, v24
  v_sub_f32 v31, v31, v24
  v_sub_f32 v32, v32, v24
  v_sub_f32 v33, v33, v24
  v_sub_f32 v34, v34, v24
  v_sub_f32 v35, v35, v24
  v_sub_f32 v36, v36, v24
  v_sub_f32 v37, v37, v24
  v_mul_f32 v25, v28, v28
  v_mul_f32 v26, v29, v29
  v_fmac_f32 v25, v30, v30
  v_fmac_f32 v26, v31, v31
  v_fmac_f32 v25, v32, v32
  v_fmac_f32 v26, v33, v33
  v_fmac_f32 v25, v34, v34
  v_fmac_f32 v26, v35, v35
  v_fmac_f32 v25, v36, v36
  v_fmac_f32 v26, v37, v37
  v_add_f32 v25, v25, v26
  v_cvt_pk_bf16_f32 v18, v28, v29
  v_cvt_pk_bf16_f32 v19, v30, v31
  v_cvt_pk_bf16_f32 v20, v32, v33
  v_cvt_pk_bf16_f32 v21, v34, v35
  v_cvt_pk_bf16_f32 v22, v36, v37
  v_add_f32_dpp v25, v25, v25 row_ror:8 row_mask:0xf bank_mask:0xf
  s_nop 1
  v_add_f32_dpp v25, v25, v25 row_ror:4 row_mask:0xf bank_mask:0xf
  s_nop 1
  v_add_f32_dpp v25, v25, v25 row_ror:2 row_mask:0xf bank_mask:0xf
  s_nop 1
  v_add_f32_dpp v25, v25, v25 row_ror:1 row_mask:0xf bank_mask:0xf
  v_mov_b32 v24, v25
  s_nop 1
  v_permlane16_swap_b32 v25, v24
  v_add_f32 v25, v25, v24
  v_mov_b32 v24, v25
  s_nop 1
  v_permlane32_swap_b32 v25, v24
  v_add_f32 v25, v25, v24
  v_mul_f32 v25, 0x3acccccd, v25
  v_fma_f32 v25, -v23, v23, v25
  v_max_f32 v25, 0, v25
  v_cvt_pk_bf16_f32 v25, v25, v25
  v_and_b32 v25, 0xffff0000, v25
  v_add_f32 v25, 0x3727c5ac, v25
  v_cvt_pk_bf16_f32 v25, v25, v25
  v_and_b32 v25, 0xffff0000, v25
  v_sqrt_f32 v25, v25
  v_lshlrev_b32 v28, 16, v18
  v_and_b32 v29, 0xffff0000, v18
  v_lshlrev_b32 v30, 16, v19
  v_and_b32 v31, 0xffff0000, v19
  v_lshlrev_b32 v32, 16, v20
  v_and_b32 v33, 0xffff0000, v20
  v_lshlrev_b32 v34, 16, v21
  v_and_b32 v35, 0xffff0000, v21
  v_lshlrev_b32 v36, 16, v22
  v_and_b32 v37, 0xffff0000, v22
  v_cvt_pk_bf16_f32 v25, v25, v25
  v_and_b32 v25, 0xffff0000, v25
  v_rcp_f32 v25, v25
  s_nop 0
  v_mul_f32 v28, v28, v25
  v_mul_f32 v29, v29, v25
  v_mul_f32 v30, v30, v25
  v_mul_f32 v31, v31, v25
  v_mul_f32 v32, v32, v25
  v_mul_f32 v33, v33, v25
  v_mul_f32 v34, v34, v25
  v_mul_f32 v35, v35, v25
  v_mul_f32 v36, v36, v25
  v_mul_f32 v37, v37, v25
  s_add_u32 s75, s75, 12288
  v_add_u32 v16, s75, v16
  v_cvt_pk_bf16_f32 v18, v28, v29
  ds_write_b32 v16, v18 offset:0
  v_cvt_pk_bf16_f32 v19, v30, v31
  ds_write_b32 v16, v19 offset:256
  v_cvt_pk_bf16_f32 v20, v32, v33
  ds_write_b32 v16, v20 offset:512
  v_cvt_pk_bf16_f32 v21, v34, v35
  ds_write_b32 v16, v21 offset:768
  v_cvt_pk_bf16_f32 v22, v36, v37
  ds_write_b32 v16, v22 offset:1024
  v_lshrrev_b32 v17, 4, v0
  v_lshlrev_b32 v17, 4, v17
  v_add_u32 v17, s75, v17
  v_mov_b32 v10, 0
  v_mov_b32 v11, 0
  v_mov_b32 v12, 0
  v_mov_b32 v13, 0
  s_waitcnt lgkmcnt(0)
  ds_read_b128 v[20:23], v17 offset:0
  ds_read_b128 v[24:27], v17 offset:64
  ds_read_b128 v[28:31], v17 offset:128
  ds_read_b128 v[32:35], v17 offset:192
  ds_read_b128 v[36:39], v17 offset:256
  ds_read_b128 v[40:43], v17 offset:320
  ds_read_b128 v[44:47], v17 offset:384
  v_mov_b32 v6, 0
  v_mov_b32 v7, 0
  v_mov_b32 v8, 0
  v_mov_b32 v9, 0
  s_waitcnt lgkmcnt(6)
  v_mfma_f32_16x16x32_bf16 v[10:13], v[20:23], v[48:51], v[10:13]
  ds_read_b128 v[20:23], v17 offset:448
  s_waitcnt lgkmcnt(6)
  v_mfma_f32_16x16x32_bf16 v[6:9], v[24:27], v[52:55], v[6:9]
  ds_read_b128 v[24:27], v17 offset:512
  s_waitcnt lgkmcnt(6)
  v_mfma_f32_16x16x32_bf16 v[10:13], v[28:31], v[56:59], v[10:13]
  ds_read_b128 v[28:31], v17 offset:576
  s_waitcnt lgkmcnt(6)
  v_mfma_f32_16x16x32_bf16 v[6:9], v[32:35], v[60:63], v[6:9]
  ds_read_b128 v[32:35], v17 offset:640
  s_waitcnt lgkmcnt(6)
  v_mfma_f32_16x16x32_bf16 v[10:13], v[36:39], v[64:67], v[10:13]
  ds_read_b128 v[36:39], v17 offset:704
  s_waitcnt lgkmcnt(6)
  v_mfma_f32_16x16x32_bf16 v[6:9], v[40:43], v[68:71], v[6:9]
  ds_read_b128 v[40:43], v17 offset:768
  s_waitcnt lgkmcnt(6)
  v_mfma_f32_16x16x32_bf16 v[10:13], v[44:47], v[72:75], v[10:13]
  ds_read_b128 v[44:47], v17 offset:832
  s_waitcnt lgkmcnt(6)
  v_mfma_f32_16x16x32_bf16 v[6:9], v[20:23], v[76:79], v[6:9]
  ds_read_b128 v[20:23], v17 offset:896
  s_waitcnt lgkmcnt(6)
  v_mfma_f32_16x16x32_bf16 v[10:13], v[24:27], v[80:83], v[10:13]
  ds_read_b128 v[24:27], v17 offset:960
  s_waitcnt lgkmcnt(6)
  v_mfma_f32_16x16x32_bf16 v[6:9], v[28:31], v[84:87], v[6:9]
  ds_read_b128 v[28:31], v17 offset:1024
  s_waitcnt lgkmcnt(6)
  v_mfma_f32_16x16x32_bf16 v[10:13], v[32:35], v[88:91], v[10:13]
  ds_read_b128 v[32:35], v17 offset:1088
  s_waitcnt lgkmcnt(6)
  v_mfma_f32_16x16x32_bf16 v[6:9], v[36:39], v[92:95], v[6:9]
  ds_read_b128 v[36:39], v17 offset:1152
  s_waitcnt lgkmcnt(6)
  v_mfma_f32_16x16x32_bf16 v[10:13], v[40:43], v[96:99], v[10:13]
  ds_read_b128 v[40:43], v17 offset:1216
  s_waitcnt lgkmcnt(6)
  v_mfma_f32_16x16x32_bf16 v[6:9], v[44:47], v[100:103], v[6:9]
  s_waitcnt lgkmcnt(5)
  v_mfma_f32_16x16x32_bf16 v[10:13], v[20:23], v[104:107], v[10:13]
  s_waitcnt lgkmcnt(4)
  v_mfma_f32_16x16x32_bf16 v[6:9], v[24:27], v[108:111], v[6:9]
  s_waitcnt lgkmcnt(3)
  v_mfma_f32_16x16x32_bf16 v[10:13], v[28:31], v[112:115], v[10:13]
  s_waitcnt lgkmcnt(2)
  v_mfma_f32_16x16x32_bf16 v[6:9], v[32:35], v[116:119], v[6:9]
  s_waitcnt lgkmcnt(1)
  v_mfma_f32_16x16x32_bf16 v[10:13], v[36:39], v[120:123], v[10:13]
  s_waitcnt lgkmcnt(0)
  v_mfma_f32_16x16x32_bf16 v[6:9], v[40:43], v[124:127], v[6:9]
  s_nop 7
  v_add_f32 v10, v10, v6
  v_cvt_pk_bf16_f32 v16, v10, v10
  v_and_b32 v16, 0xffff0000, v16
  s_nop 1
  v_mov_b32_dpp v17, v16 row_ror:8 row_mask:0xf bank_mask:0xf
  v_mul_f32 v18, v16, v16
  v_mul_f32 v18, v18, v16
  v_mov_b32 v19, 0x3d372713
  v_fma_f32 v19, v19, v18, v16
  v_mul_f32 v19, 0x3f4c422a, v19
  v_mul_f32 v19, 0xc038aa3b, v19
  v_exp_f32 v19, v19
  s_nop 0
  v_add_f32 v19, 1.0, v19
  v_rcp_f32 v19, v19
  s_nop 0
  v_mul_f32 v19, v16, v19
  v_cvt_pk_bf16_f32 v19, v19, v19
  v_and_b32 v19, 0xffff0000, v19
  v_mul_f32 v19, v19, v17
  s_nop 1
  v_mov_b32_dpp v18, v19 row_shl:1 row_mask:0xf bank_mask:0xf
  v_cvt_pk_bf16_f32 v19, v19, v18
  v_min_u32 v20, 0xfffffffe, v19
  v_lshrrev_b32 v17, 4, v0
  v_lshlrev_b32 v16, 14, v17
  v_mov_b32_dpp v21, v20 row_shl:2 row_mask:0xf bank_mask:0xf
  v_mov_b32_dpp v22, v20 row_shl:4 row_mask:0xf bank_mask:0xf
  v_mov_b32_dpp v23, v20 row_shl:6 row_mask:0xf bank_mask:0xf
  s_lshl_b32 s52, s71, 4
  v_mov_b32 v24, s52
  s_mov_b64 exec, 1
  ds_write_b128 v24, v[20:23] offset:17408
  s_mov_b64 exec, -1
  s_waitcnt lgkmcnt(0)
  v_mov_b32 v24, 1
  v_mov_b32 v25, 2816
  s_mov_b64 exec, 1
  ds_add_rtn_u32 v24, v25, v24
  s_mov_b64 exec, -1
  v_and_b32 v26, 3, v0
  v_lshlrev_b32 v26, 4, v26
  v_lshrrev_b32 v27, 2, v0
  v_lshl_add_u32 v27, v27, 14, v26
  s_waitcnt lgkmcnt(0)
  v_readfirstlane_b32 s52, v24
  s_cmp_lg_u32 s52, 3
  s_nop 3
  s_cbranch_scc1 L_end
  ds_read_b128 v[20:23], v26 offset:17408
  s_mov_b64 exec, 0xffff
  s_waitcnt lgkmcnt(0)
  buffer_store_dwordx4 v[20:23], v27, s[48:51], s60 offen sc1
  s_mov_b64 exec, -1
  s_endpgm
L_fin_dn:
  s_lshl_b32 s75, s71, 2
  s_cmp_eq_u32 s71, 3
  s_cselect_b32 s52, 1, 0
  s_sub_u32 s75, s75, s52
  v_lshrrev_b32 v2, 1, v0
  s_movk_i32 s52, 1280
  v_mul_lo_u32 v2, v2, s52
  v_and_b32 v3, 1, v0
  v_lshl_add_u32 v2, v3, 4, v2
  s_mul_i32 s76, s75, 163840
  s_lshl_b32 s52, s63, 5
  s_add_u32 s76, s76, s52
  s_lshl_b32 s77, s71, 14
  s_add_u32 s77, s77, 18432
  s_cmp_lt_u32 s71, 1
  s_cbranch_scc1 L_early_32
  v_mov_b32 v5, 2832
  s_mov_b32 s61, 0
  s_nop 0
L_lw_33r:
  ds_read_b32 v4, v5
  s_waitcnt lgkmcnt(0)
  v_readfirstlane_b32 s52, v4
  s_cmp_ge_u32 s52, 10
  s_nop 3
  s_cbranch_scc1 L_lw_33o
  s_sleep 1
  s_add_u32 s61, s61, 1
  s_cmp_lt_u32 s61, 4800000
  s_cbranch_scc1 L_lw_33r
L_lw_33o:
L_early_32:
  s_add_u32 m0, s77, 0
  s_add_u32 s52, s76, 0
  buffer_load_dwordx4 v2, s[32:35], s52 offen  lds
  s_add_u32 m0, s77, 1024
  s_add_u32 s52, s76, 40960
  buffer_load_dwordx4 v2, s[32:35], s52 offen  lds
  s_add_u32 m0, s77, 2048
  s_add_u32 s52, s76, 81920
  buffer_load_dwordx4 v2, s[32:35], s52 offen  lds
  s_add_u32 m0, s77, 3072
  s_add_u32 s52, s76, 122880
  buffer_load_dwordx4 v2, s[32:35], s52 offen  lds
  s_add_u32 m0, s77, 4096
  s_add_u32 s52, s76, 163840
  buffer_load_dwordx4 v2, s[32:35], s52 offen  lds
  s_add_u32 m0, s77, 5120
  s_add_u32 s52, s76, 204800
  buffer_load_dwordx4 v2, s[32:35], s52 offen  lds
  s_add_u32 m0, s77, 6144
  s_add_u32 s52, s76, 245760
  buffer_load_dwordx4 v2, s[32:35], s52 offen  lds
  s_add_u32 m0, s77, 7168
  s_add_u32 s52, s76, 286720
  buffer_load_dwordx4 v2, s[32:35], s52 offen  lds
  s_add_u32 m0, s77, 8192
  s_add_u32 s52, s76, 327680
  buffer_load_dwordx4 v2, s[32:35], s52 offen  lds
  s_add_u32 m0, s77, 9216
  s_add_u32 s52, s76, 368640
  buffer_load_dwordx4 v2, s[32:35], s52 offen  lds
  s_add_u32 m0, s77, 10240
  s_add_u32 s52, s76, 409600
  buffer_load_dwordx4 v2, s[32:35], s52 offen  lds
  s_add_u32 m0, s77, 11264
  s_add_u32 s52, s76, 450560
  buffer_load_dwordx4 v2, s[32:35], s52 offen  lds
  s_cmp_ge_u32 s71, 2
  s_cbranch_scc1 L_dst_34
  s_add_u32 m0, s77, 12288
  s_add_u32 s52, s76, 491520
  buffer_load_dwordx4 v2, s[32:35], s52 offen  lds
  s_add_u32 m0, s77, 13312
  s_add_u32 s52, s76, 532480
  buffer_load_dwordx4 v2, s[32:35], s52 offen  lds
  s_add_u32 m0, s77, 14336
  s_add_u32 s52, s76, 573440
  buffer_load_dwordx4 v2, s[32:35], s52 offen  lds
  s_add_u32 m0, s77, 15360
  s_add_u32 s52, s76, 614400
  buffer_load_dwordx4 v2, s[32:35], s52 offen  lds
L_dst_34:
  v_lshrrev_b32 v3, 4, v0
  v_lshlrev_b32 v3, 8, v3
  v_bfe_u32 v4, v0, 2, 2
  v_lshl_add_u32 v3, v4, 5, v3
  v_and_b32 v4, 3, v0
  v_lshl_add_u32 v3, v4, 3, v3
  v_add_u32 v3, s77, v3
  s_lshl_b32 s78, s75, 10
  s_add_u32 s78, s78, 786432
  s_bfe_u32 s52, s2, 0x20001
  s_and_b32 s52, s52, 3
  s_lshl_b32 s52, s52, 14
  s_add_u32 s78, s78, s52
  v_and_b32 v5, 14, v0
  v_lshlrev_b32 v5, 1, v5
  s_lshl_b32 s76, s63, 5
  s_add_u32 s79, s76, 720896
  s_and_b32 s52, s2, 7
  s_lshl_b32 s52, s52, 13
  s_add_u32 s79, s79, s52
  v_mov_b32 v24, 0
  v_mov_b32 v25, 0
  v_mov_b32 v26, 0
  v_mov_b32 v27, 0
  v_mov_b32 v28, 0
  v_mov_b32 v29, 0
  v_mov_b32 v30, 0
  v_mov_b32 v31, 0
  s_cmp_eq_u32 s71, 3
  s_cselect_b32 s80, 0x00ff00ff, -1
  s_waitcnt vmcnt(0)
  ds_read_b64_tr_b16 v[64:65], v3 offset:0
  ds_read_b64_tr_b16 v[66:67], v3 offset:128
  ds_read_b64_tr_b16 v[68:69], v3 offset:1024
  ds_read_b64_tr_b16 v[70:71], v3 offset:1152
  ds_read_b64_tr_b16 v[72:73], v3 offset:2048
  ds_read_b64_tr_b16 v[74:75], v3 offset:2176
  ds_read_b64_tr_b16 v[76:77], v3 offset:3072
  ds_read_b64_tr_b16 v[78:79], v3 offset:3200
  s_waitcnt lgkmcnt(0)
  ds_read_b64_tr_b16 v[80:81], v3 offset:4096
  ds_read_b64_tr_b16 v[82:83], v3 offset:4224
  ds_read_b64_tr_b16 v[84:85], v3 offset:5120
  ds_read_b64_tr_b16 v[86:87], v3 offset:5248
  ds_read_b64_tr_b16 v[88:89], v3 offset:6144
  ds_read_b64_tr_b16 v[90:91], v3 offset:6272
  ds_read_b64_tr_b16 v[92:93], v3 offset:7168
  ds_read_b64_tr_b16 v[94:95], v3 offset:7296
  s_waitcnt lgkmcnt(0)
  ds_read_b64_tr_b16 v[96:97], v3 offset:8192
  ds_read_b64_tr_b16 v[98:99], v3 offset:8320
  ds_read_b64_tr_b16 v[100:101], v3 offset:9216
  ds_read_b64_tr_b16 v[102:103], v3 offset:9344
  ds_read_b64_tr_b16 v[104:105], v3 offset:10240
  ds_read_b64_tr_b16 v[106:107], v3 offset:10368
  ds_read_b64_tr_b16 v[108:109], v3 offset:11264
  ds_read_b64_tr_b16 v[110:111], v3 offset:11392
  s_waitcnt lgkmcnt(0)
  ds_read_b64_tr_b16 v[112:113], v3 offset:12288
  ds_read_b64_tr_b16 v[114:115], v3 offset:12416
  ds_read_b64_tr_b16 v[116:117], v3 offset:13312
  ds_read_b64_tr_b16 v[118:119], v3 offset:13440
  ds_read_b64_tr_b16 v[120:121], v3 offset:14336
  ds_read_b64_tr_b16 v[122:123], v3 offset:14464
  ds_read_b64_tr_b16 v[124:125], v3 offset:15360
  ds_read_b64_tr_b16 v[126:127], v3 offset:15488
  s_waitcnt lgkmcnt(0)
  s_mov_b32 s61, 0
L_dh_35r:
  buffer_load_dword v6, v5, s[48:51], s79 offen offset:0 sc1
  buffer_load_dword v7, v5, s[48:51], s79 offen offset:1280 sc1
  buffer_load_dword v8, v5, s[48:51], s79 offen offset:2560 sc1
  buffer_load_dword v9, v5, s[48:51], s79 offen offset:3840 sc1
  s_waitcnt vmcnt(0)
  v_max3_u32 v14, v6, v7, v8
  v_max_u32 v14, v14, v9
  v_cmp_eq_u32 vcc, -1, v14
  s_nop 4
  s_cbranch_vccz L_dh_35o
  s_sleep 4
  s_add_u32 s61, s61, 1
  s_cmp_lt_u32 s61, 300000
  s_cbranch_scc1 L_dh_35r
L_dh_35o:
  s_mov_b32 s61, 0
L_ap_36r:
  buffer_load_dwordx4 v[16:19], v1, s[48:51], s78 offen offset:0 sc1
  buffer_load_dwordx4 v[20:23], v1, s[48:51], s78 offen offset:1024 sc1
  s_mov_b32 exec_lo, s80
  s_mov_b32 exec_hi, s80
  buffer_load_dwordx4 v[24:27], v1, s[48:51], s78 offen offset:2048 sc1
  s_mov_b64 exec, -1
  s_cmp_ge_u32 s71, 2
  s_cbranch_scc1 L_ap_36s
  buffer_load_dwordx4 v[28:31], v1, s[48:51], s78 offen offset:3072 sc1
L_ap_36s:
  s_waitcnt vmcnt(0)
  v_max3_u32 v14, v16, v17, v18
  v_max3_u32 v15, v19, v20, v21
  v_max3_u32 v14, v14, v22, v23
  v_max3_u32 v15, v15, v24, v25
  v_max3_u32 v14, v14, v26, v27
  v_max3_u32 v15, v15, v28, v29
  v_max3_u32 v14, v14, v30, v31
  v_max_u32 v14, v14, v15
  v_cmp_eq_u32 vcc, -1, v14
  s_nop 4
  s_cbranch_vccz L_ap_36o
  s_sleep 1
  s_add_u32 s61, s61, 1
  s_cmp_lt_u32 s61, 300000
  s_cbranch_scc1 L_ap_36r
L_ap_36o:
  v_mov_b32 v10, 0
  v_mov_b32 v11, 0
  v_mov_b32 v12, 0
  v_mov_b32 v13, 0
  v_mov_b32 v40, 0
  v_mov_b32 v41, 0
  v_mov_b32 v42, 0
  v_mov_b32 v43, 0
  v_mfma_f32_16x16x32_bf16 v[10:13], v[16:19], v[64:67], v[10:13]
  v_mov_b32_dpp v36, v16 row_shl:4 row_mask:0xf bank_mask:0xf
  v_mov_b32_dpp v37, v17 row_shl:4 row_mask:0xf bank_mask:0xf
  v_mov_b32_dpp v38, v18 row_shl:4 row_mask:0xf bank_mask:0xf
  v_mov_b32_dpp v39, v19 row_shl:4 row_mask:0xf bank_mask:0xf
  s_nop 1
  v_mfma_f32_16x16x32_bf16 v[40:43], v[36:39], v[68:71], v[40:43]
  v_mov_b32_dpp v32, v16 row_shl:8 row_mask:0xf bank_mask:0xf
  v_mov_b32_dpp v33, v17 row_shl:8 row_mask:0xf bank_mask:0xf
  v_mov_b32_dpp v34, v18 row_shl:8 row_mask:0xf bank_mask:0xf
  v_mov_b32_dpp v35, v19 row_shl:8 row_mask:0xf bank_mask:0xf
  s_nop 1
  v_mfma_f32_16x16x32_bf16 v[10:13], v[32:35], v[72:75], v[10:13]
  v_mov_b32_dpp v36, v16 row_shl:12 row_mask:0xf bank_mask:0xf
  v_mov_b32_dpp v37, v17 row_shl:12 row_mask:0xf bank_mask:0xf
  v_mov_b32_dpp v38, v18 row_shl:12 row_mask:0xf bank_mask:0xf
  v_mov_b32_dpp v39, v19 row_shl:12 row_mask:0xf bank_mask:0xf
  s_nop 1
  v_mfma_f32_16x16x32_bf16 v[40:43], v[36:39], v[76:79], v[40:43]
  v_mfma_f32_16x16x32_bf16 v[10:13], v[20:23], v[80:83], v[10:13]
  v_mov_b32_dpp v36, v20 row_shl:4 row_mask:0xf bank_mask:0xf
  v_mov_b32_dpp v37, v21 row_shl:4 row_mask:0xf bank_mask:0xf
  v_mov_b32_dpp v38, v22 row_shl:4 row_mask:0xf bank_mask:0xf
  v_mov_b32_dpp v39, v23 row_shl:4 row_mask:0xf bank_mask:0xf
  s_nop 1
  v_mfma_f32_16x16x32_bf16 v[40:43], v[36:39], v[84:87], v[40:43]
  v_mov_b32_dpp v32, v20 row_shl:8 row_mask:0xf bank_mask:0xf
  v_mov_b32_dpp v33, v21 row_shl:8 row_mask:0xf bank_mask:0xf
  v_mov_b32_dpp v34, v22 row_shl:8 row_mask:0xf bank_mask:0xf
  v_mov_b32_dpp v35, v23 row_shl:8 row_mask:0xf bank_mask:0xf
  s_nop 1
  v_mfma_f32_16x16x32_bf16 v[10:13], v[32:35], v[88:91], v[10:13]
  v_mov_b32_dpp v36, v20 row_shl:12 row_mask:0xf bank_mask:0xf
  v_mov_b32_dpp v37, v21 row_shl:12 row_mask:0xf bank_mask:0xf
  v_mov_b32_dpp v38, v22 row_shl:12 row_mask:0xf bank_mask:0xf
  v_mov_b32_dpp v39, v23 row_shl:12 row_mask:0xf bank_mask:0xf
  s_nop 1
  v_mfma_f32_16x16x32_bf16 v[40:43], v[36:39], v[92:95], v[40:43]
  v_mfma_f32_16x16x32_bf16 v[10:13], v[24:27], v[96:99], v[10:13]
  v_mov_b32_dpp v36, v24 row_shl:4 row_mask:0xf bank_mask:0xf
  v_mov_b32_dpp v37, v25 row_shl:4 row_mask:0xf bank_mask:0xf
  v_mov_b32_dpp v38, v26 row_shl:4 row_mask:0xf bank_mask:0xf
  v_mov_b32_dpp v39, v27 row_shl:4 row_mask:0xf bank_mask:0xf
  s_nop 1
  v_mfma_f32_16x16x32_bf16 v[40:43], v[36:39], v[100:103], v[40:43]
  v_mov_b32_dpp v32, v24 row_shl:8 row_mask:0xf bank_mask:0xf
  v_mov_b32_dpp v33, v25 row_shl:8 row_mask:0xf bank_mask:0xf
  v_mov_b32_dpp v34, v26 row_shl:8 row_mask:0xf bank_mask:0xf
  v_mov_b32_dpp v35, v27 row_shl:8 row_mask:0xf bank_mask:0xf
  s_nop 1
  v_mfma_f32_16x16x32_bf16 v[10:13], v[32:35], v[104:107], v[10:13]
  v_mov_b32_dpp v36, v24 row_shl:12 row_mask:0xf bank_mask:0xf
  v_mov_b32_dpp v37, v25 row_shl:12 row_mask:0xf bank_mask:0xf
  v_mov_b32_dpp v38, v26 row_shl:12 row_mask:0xf bank_mask:0xf
  v_mov_b32_dpp v39, v27 row_shl:12 row_mask:0xf bank_mask:0xf
  s_nop 1
  v_mfma_f32_16x16x32_bf16 v[40:43], v[36:39], v[108:111], v[40:43]
  s_cmp_ge_u32 s71, 2
  s_nop 6
  s_cbranch_scc1 L_dsk_37
  v_mfma_f32_16x16x32_bf16 v[10:13], v[28:31], v[112:115], v[10:13]
  v_mov_b32_dpp v36, v28 row_shl:4 row_mask:0xf bank_mask:0xf
  v_mov_b32_dpp v37, v29 row_shl:4 row_mask:0xf bank_mask:0xf
  v_mov_b32_dpp v38, v30 row_shl:4 row_mask:0xf bank_mask:0xf
  v_mov_b32_dpp v39, v31 row_shl:4 row_mask:0xf bank_mask:0xf
  s_nop 1
  v_mfma_f32_16x16x32_bf16 v[40:43], v[36:39], v[116:119], v[40:43]
  v_mov_b32_dpp v32, v28 row_shl:8 row_mask:0xf bank_mask:0xf
  v_mov_b32_dpp v33, v29 row_shl:8 row_mask:0xf bank_mask:0xf
  v_mov_b32_dpp v34, v30 row_shl:8 row_mask:0xf bank_mask:0xf
  v_mov_b32_dpp v35, v31 row_shl:8 row_mask:0xf bank_mask:0xf
  s_nop 1
  v_mfma_f32_16x16x32_bf16 v[10:13], v[32:35], v[120:123], v[10:13]
  v_mov_b32_dpp v36, v28 row_shl:12 row_mask:0xf bank_mask:0xf
  v_mov_b32_dpp v37, v29 row_shl:12 row_mask:0xf bank_mask:0xf
  v_mov_b32_dpp v38, v30 row_shl:12 row_mask:0xf bank_mask:0xf
  v_mov_b32_dpp v39, v31 row_shl:12 row_mask:0xf bank_mask:0xf
  s_nop 1
  v_mfma_f32_16x16x32_bf16 v[40:43], v[36:39], v[124:127], v[40:43]
  s_nop 7
L_dsk_37:
  v_add_f32 v10, v10, v40
  v_add_f32 v11, v11, v41
  v_add_f32 v12, v12, v42
  v_add_f32 v13, v13, v43
  v_and_b32 v14, 1, v0
  v_cmp_eq_u32 vcc, 1, v14
  v_lshlrev_b32 v15, 16, v6
  v_and_b32 v6, 0xffff0000, v6
  v_cndmask_b32 v6, v15, v6, vcc
  v_lshlrev_b32 v15, 16, v7
  v_and_b32 v7, 0xffff0000, v7
  v_cndmask_b32 v7, v15, v7, vcc
  v_lshlrev_b32 v15, 16, v8
  v_and_b32 v8, 0xffff0000, v8
  v_cndmask_b32 v8, v15, v8, vcc
  v_lshlrev_b32 v15, 16, v9
  v_and_b32 v9, 0xffff0000, v9
  v_cndmask_b32 v9, v15, v9, vcc
  v_and_b32 v2, 15, v0
  v_lshlrev_b32 v2, 4, v2
  s_lshl_b32 s52, s71, 8
  v_add_u32 v3, s52, v2
  v_mov_b32 v14, 1
  v_mov_b32 v15, 2816
  s_mov_b64 exec, 0xffff
  ds_write_b128 v3, v[10:13] offset:17408
  s_waitcnt lgkmcnt(0)
  s_mov_b64 exec, 1
  ds_add_rtn_u32 v14, v15, v14
  s_mov_b64 exec, -1
  s_waitcnt lgkmcnt(0)
  v_readfirstlane_b32 s52, v14
  s_cmp_lg_u32 s52, 3
  s_nop 3
  s_cbranch_scc1 L_end
  ds_read_b128 v[64:67], v2 offset:17408
  ds_read_b128 v[68:71], v2 offset:17664
  ds_read_b128 v[72:75], v2 offset:17920
  ds_read_b128 v[76:79], v2 offset:18176
  s_waitcnt lgkmcnt(0)
  v_add_f32 v64, v64, v68
  v_add_f32 v65, v65, v69
  v_add_f32 v66, v66, v70
  v_add_f32 v67, v67, v71
  v_add_f32 v64, v64, v72
  v_add_f32 v65, v65, v73
  v_add_f32 v66, v66, v74
  v_add_f32 v67, v67, v75
  v_add_f32 v64, v64, v76
  v_add_f32 v65, v65, v77
  v_add_f32 v66, v66, v78
  v_add_f32 v67, v67, v79
  v_cvt_pk_bf16_f32 v64, v64, v64
  v_cvt_pk_bf16_f32 v65, v65, v65
  v_cvt_pk_bf16_f32 v66, v66, v66
  v_cvt_pk_bf16_f32 v67, v67, v67
  v_and_b32 v64, 0xffff0000, v64
  v_and_b32 v65, 0xffff0000, v65
  v_and_b32 v66, 0xffff0000, v66
  v_and_b32 v67, 0xffff0000, v67
  v_add_f32 v64, v64, v6
  v_add_f32 v65, v65, v7
  v_add_f32 v66, v66, v8
  v_add_f32 v67, v67, v9
  v_cvt_pk_bf16_f32 v64, v64, v64
  v_cvt_pk_bf16_f32 v65, v65, v65
  v_cvt_pk_bf16_f32 v66, v66, v66
  v_cvt_pk_bf16_f32 v67, v67, v67
  v_lshlrev_b32 v2, 1, v0
  s_mov_b64 exec, 0xffff
  buffer_store_short v64, v2, s[40:43], s76 offen offset:0
  buffer_store_short v65, v2, s[40:43], s76 offen offset:1280
  buffer_store_short v66, v2, s[40:43], s76 offen offset:2560
  buffer_store_short v67, v2, s[40:43], s76 offen offset:3840
  s_mov_b64 exec, -1
  s_endpgm
L_end:
  s_endpgm
.section .rodata,"a"
.p2align 6
.amdhsa_kernel sequential_preLN__gqa_block_cached__geglu_ffn__decode_kernel
  .amdhsa_next_free_vgpr 128
  .amdhsa_next_free_sgpr 96
  .amdhsa_accum_offset 128
  .amdhsa_group_segment_fixed_size 0
  .amdhsa_kernarg_size 96
  .amdhsa_user_sgpr_count 2
  .amdhsa_user_sgpr_kernarg_segment_ptr 1
  .amdhsa_system_sgpr_workgroup_id_x 1
  .amdhsa_float_denorm_mode_32 3
.end_amdhsa_kernel
```
